```python
import torch

def _softmax(x, axis=-1):
    return torch.softmax(x, dim=axis)

def _gelu(x):
    return torch.nn.functional.gelu(x, approximate='tanh')

def _silu(x):
    return torch.nn.functional.silu(x)

def _sigmoid(x):
    return torch.sigmoid(x)

def _layernorm(x, axis=-1, eps=1e-05):
    m = x.mean(dim=axis, keepdim=True)
    v = x.var(dim=axis, keepdim=True, unbiased=False)
    return (x - m) / torch.sqrt(v + eps)

def _scatter_add(tgt, idx, src, axis=0):
    return tgt.clone().index_add_(axis, idx, src)

def _segment_sum(src, seg, n):
    out = torch.zeros((n,) + src.shape[1:], dtype=src.dtype)
    return out.index_add_(0, seg, src)

def _pad(x, pw):
    flat = tuple((v for pair in reversed(pw) for v in pair))
    return torch.nn.functional.pad(x, flat)
kernel_name = 'sequential_preLN__memory_aug_recurrent_mem_tr__glu_gated_bilinear__prompt'

def setup_inputs():

    _w = lambda a: (lambda t: t.to(torch.bfloat16) if t.is_floating_point() else t)(torch.as_tensor(a))

    def _A_setup():
        B, S, Dm = (1, 2048, 576)
        H, Dh = (32, 128)
        M, seg = (8, 32)
        seg = min(seg, S)
        S = S // seg * seg
        return {'x': _w((lambda *s: torch.randn(*s, dtype=torch.bfloat16) * 0.05)(B, S, Dm)), 'mem0': _w((lambda *s: torch.randn(*s, dtype=torch.bfloat16) * 0.2)(B, M, Dm)), 'Wq': _w((lambda *s: torch.randn(*s, dtype=torch.bfloat16) * 1.6)(Dm, H, Dh) * Dm ** (-0.5)), 'Wk': _w((lambda *s: torch.randn(*s, dtype=torch.bfloat16) * 1.6)(Dm, H, Dh) * Dm ** (-0.5)), 'Wv': _w((lambda *s: torch.randn(*s, dtype=torch.bfloat16) * 0.2)(Dm, H, Dh) * Dm ** (-0.5)), 'Wo': _w((lambda *s: torch.randn(*s, dtype=torch.bfloat16) * 0.2)(H, Dh, Dm) * (H * Dh) ** (-0.5)), 'seg_len': seg}
    _A_in = _A_setup()

    def _B_setup():
        B, S, D, F = (1, 2048, 576, 4608)
        return {'x': _w((lambda *s: torch.randn(*s, dtype=torch.bfloat16) * 0.05)(B, S, D)), 'w_gate': _w((lambda *s: torch.randn(*s, dtype=torch.bfloat16) * 0.2)(D, F) * D ** (-0.5)), 'w_up': _w((lambda *s: torch.randn(*s, dtype=torch.bfloat16) * 0.2)(D, F) * D ** (-0.5)), 'w_down': _w((lambda *s: torch.randn(*s, dtype=torch.bfloat16) * 0.2)(F, D) * F ** (-0.5))}
    _B_in = _B_setup()
    return {'A_x': _A_in['x'], 'A_mem0': _A_in['mem0'], 'A_Wq': _A_in['Wq'], 'A_Wk': _A_in['Wk'], 'A_Wv': _A_in['Wv'], 'A_Wo': _A_in['Wo'], 'A_seg_len': _A_in['seg_len'], 'B_x': _B_in['x'], 'B_w_gate': _B_in['w_gate'], 'B_w_up': _B_in['w_up'], 'B_w_down': _B_in['w_down']}

def reference(A_x, A_mem0, A_Wq, A_Wk, A_Wv, A_Wo, A_seg_len, B_x, B_w_gate, B_w_up, B_w_down):

    def _A_ref(x, mem0, Wq, Wk, Wv, Wo, seg_len):
        B, S, Dm = x.shape
        H, Dh = (Wq.shape[1], Wq.shape[2])
        M = mem0.shape[1]
        scale = Dh ** (-0.5)
        n_seg = S // seg_len
        L = M + seg_len
        idx = torch.arange(L)
        mask = (idx[:, None] < M) | (idx[:, None] >= idx[None, :])
        mem = mem0
        outs = []
        for s in range(n_seg):
            xs = x[:, s * seg_len:(s + 1) * seg_len, :].clone()
            h = torch.concatenate([mem, xs], axis=1)
            q = torch.einsum('btd,dhe->bhte', h, Wq)
            k = torch.einsum('btd,dhe->bhte', h, Wk)
            v = torch.einsum('btd,dhe->bhte', h, Wv)
            scores = torch.einsum('bhqe,bhke->bhqk', q, k) * scale
            scores = torch.where(mask[None, None], scores, -1000000000.0)
            p = _softmax(scores, axis=-1)
            o = torch.einsum('bhqk,bhke->bhqe', p, v)
            o = torch.einsum('bhte,hed->btd', o, Wo)
            mem = o[:, :M, :].clone()
            outs.append(o[:, M:, :])
        return torch.concatenate(outs, axis=1)

    def _B_ref(x, w_gate, w_up, w_down):
        g = torch.einsum('bsd,df->bsf', x, w_gate)
        u = torch.einsum('bsd,df->bsf', x, w_up)
        h = g * u
        return torch.einsum('bsf,fd->bsd', h, w_down)
    x = A_x
    h = x + _A_ref(_layernorm(x, axis=-1), A_mem0, A_Wq, A_Wk, A_Wv, A_Wo, A_seg_len)
    h2 = h + _B_ref(_layernorm(h, axis=-1), B_w_gate, B_w_up, B_w_down)
    return h2
```

```asm
; @launch grid=(256,1,1) block=(256,1,1) lds=163840
.amdgcn_target "amdgcn-amd-amdhsa--gfx950"
.text
.globl sequential_preLN__memory_aug_recurrent_mem_tr__glu_gated_bilinear__prompt_kernel
.p2align 8
.type sequential_preLN__memory_aug_recurrent_mem_tr__glu_gated_bilinear__prompt_kernel,@function
sequential_preLN__memory_aug_recurrent_mem_tr__glu_gated_bilinear__prompt_kernel:
	s_cmp_ge_u32 s2, 256
	s_cbranch_scc1 all_exit
	s_and_b32 s3, s2, 7
	s_cmp_eq_u32 s3, 0
	s_cbranch_scc1 chain_entry
	s_getpc_b64 s[64:65]
role_pc:
	s_add_u32 s64, s64, role_tbl-role_pc
	s_addc_u32 s65, s65, 0
	s_lshl_b32 s3, s2, 2
	s_load_dword s42, s[64:65], s3
	s_load_dwordx2 s[4:5], s[0:1], 104
	s_load_dwordx2 s[24:25], s[0:1], 96
	s_load_dwordx2 s[16:17], s[0:1], 0
	v_lshrrev_b32 v8, 6, v0
	s_nop 0
	v_readfirstlane_b32 s26, v8
	v_and_b32 v0, 63, v0
	v_lshlrev_b32 v0, 4, v0
	s_mov_b32 s6, 0x10000000
	s_mov_b32 s7, 0x00020000
	s_mov_b32 s18, 2359296
	s_mov_b32 s19, 0x00020000
	s_mov_b32 s34, 0x40000
	s_lshl_b32 s44, s26, 12
	s_waitcnt lgkmcnt(0)
	s_bfe_u32 s27, s42, 0x80008
	s_bfe_u32 s41, s42, 0x80010
	s_and_b32 s42, s42, 255
	s_cmp_eq_u32 s42, 1
	s_cbranch_scc1 kv_entry
	s_cmp_eq_u32 s42, 2
	s_cbranch_scc1 q_entry
	s_cmp_eq_u32 s42, 6
	s_cbranch_scc1 gu_entry
	s_cmp_eq_u32 s42, 4
	s_cbranch_scc1 wo_entry
	s_cmp_eq_u32 s42, 7
	s_cbranch_scc1 dn_entry
	s_branch ln_entry
role_off:
	s_mov_b32 s42, 9
	s_branch ln_entry
chain_entry:
	s_load_dwordx2 s[4:5], s[0:1], 104
	s_load_dwordx2 s[8:9], s[0:1], 16
	s_load_dwordx2 s[12:13], s[0:1], 24
	s_load_dwordx2 s[16:17], s[0:1], 32
	s_load_dwordx2 s[20:21], s[0:1], 40
	s_load_dwordx2 s[80:81], s[0:1], 8
	s_load_dwordx2 s[24:25], s[0:1], 96
	v_lshrrev_b32 v8, 6, v0
	s_nop 0
	v_readfirstlane_b32 s26, v8
	v_and_b32 v0, 63, v0
	v_lshlrev_b32 v0, 4, v0
	s_lshr_b32 s27, s2, 3
	s_getpc_b64 s[64:65]
chain_pc:
	s_add_u32 s64, s64, chain_tbl-chain_pc
	s_addc_u32 s65, s65, 0
	s_mul_i32 s44, s26, 7168
	v_add_u32 v8, s44, v0
	v_add_u32 v9, 4096, v8
	v_and_b32 v41, 0x70, v0
	v_lshrrev_b32 v43, 7, v0
	v_mul_u32_u24 v42, 0x480, v43
	v_or_b32 v42, v42, v41
	v_lshl_or_b32 v40, v43, 13, v41
	v_lshrrev_b32 v41, 4, v0
	v_and_b32 v41, 32, v41
	v_xor_b32 v40, v40, v41
	v_xor_b32 v41, 64, v40
	v_xor_b32 v43, 64, v42
	global_load_dwordx4 v[44:47], v8, s[64:65] offset:3072
	global_load_dwordx4 v[16:19], v8, s[64:65] offset:1024
	global_load_dwordx4 v[24:27], v9, s[64:65] offset:2048
	global_load_dwordx4 v[12:15], v8, s[64:65]
	global_load_dwordx4 v[48:51], v9, s[64:65]
	global_load_dwordx4 v[20:23], v9, s[64:65] offset:1024
	s_mul_i32 s60, s26, 39424
	s_add_u32 s60, s60, 6144
	s_xor_b32 s74, s26, 1
	s_mul_i32 s61, s74, 39424
	s_add_u32 s61, s61, 6144
	s_min_u32 s62, s60, s61
	s_max_u32 s63, s60, s61
	s_lshl_b32 s74, s27, 8
	s_lshr_b32 s75, s26, 1
	s_lshl_b32 s75, s75, 7
	s_add_u32 s74, s74, s75
	s_lshl_b32 s75, s26, 18
	s_add_u32 s66, s74, s75
	s_xor_b32 s67, s66, 524288
	s_and_b32 s75, s75, 262144
	s_add_u32 s68, s74, s75
	s_add_u32 s68, s68, 4194304
	s_mul_i32 s74, s27, 147456
	s_lshl_b32 s75, s26, 7
	s_add_u32 s75, s75, s74
	s_xor_b32 s76, s26, 0
	s_mul_i32 s76, s76, 36864
	s_add_u32 s70, s75, s76
	s_add_u32 s69, s74, s76
	s_add_u32 s69, s69, 1024
	s_xor_b32 s76, s26, 1
	s_mul_i32 s76, s76, 36864
	s_add_u32 s71, s75, s76
	s_xor_b32 s76, s26, 2
	s_mul_i32 s76, s76, 36864
	s_add_u32 s72, s75, s76
	s_xor_b32 s76, s26, 3
	s_mul_i32 s76, s76, 36864
	s_add_u32 s73, s75, s76
	s_waitcnt lgkmcnt(0)
	s_mov_b32 s6, 0x10000000
	s_mov_b32 s7, 0x00020000
	s_mov_b32 s10, 0x480000
	s_mov_b32 s11, 0x00020000
	s_mov_b32 s14, 0x480000
	s_mov_b32 s15, 0x00020000
	s_mov_b32 s18, 0x480000
	s_mov_b32 s19, 0x00020000
	s_mov_b32 s22, 0x480000
	s_mov_b32 s23, 0x00020000
	s_mov_b32 s82, 0x2400
	s_mov_b32 s83, 0x00020000
	s_and_b32 s44, s27, 3
	s_cmp_eq_u32 s44, 1
	s_cbranch_scc1 chain_wide
	s_add_u32 s44, s71, 0
	s_add_u32 m0, s60, 0
	s_nop 0
	buffer_load_dwordx4 v42, s[20:23], s44 offen nt lds
	s_add_u32 s44, s71, 9216
	s_add_u32 m0, s60, 1024
	s_nop 0
	buffer_load_dwordx4 v42, s[20:23], s44 offen nt lds
	s_add_u32 s44, s71, 18432
	s_add_u32 m0, s60, 2048
	s_nop 0
	buffer_load_dwordx4 v43, s[20:23], s44 offen nt lds
	s_add_u32 s44, s71, 27648
	s_add_u32 m0, s60, 3072
	s_nop 0
	buffer_load_dwordx4 v43, s[20:23], s44 offen nt lds
	s_add_u32 s44, s72, 0
	s_add_u32 m0, s60, 4096
	s_nop 0
	buffer_load_dwordx4 v42, s[20:23], s44 offen nt lds
	s_add_u32 s44, s72, 9216
	s_add_u32 m0, s60, 5120
	s_nop 0
	buffer_load_dwordx4 v42, s[20:23], s44 offen nt lds
	s_add_u32 s44, s72, 18432
	s_add_u32 m0, s60, 6144
	s_nop 0
	buffer_load_dwordx4 v43, s[20:23], s44 offen nt lds
	s_add_u32 s44, s72, 27648
	s_add_u32 m0, s60, 7168
	s_nop 0
	buffer_load_dwordx4 v43, s[20:23], s44 offen nt lds
	s_add_u32 s44, s73, 0
	s_add_u32 m0, s60, 8192
	s_nop 0
	buffer_load_dwordx4 v42, s[20:23], s44 offen nt lds
	s_add_u32 s44, s73, 9216
	s_add_u32 m0, s60, 9216
	s_nop 0
	buffer_load_dwordx4 v42, s[20:23], s44 offen nt lds
	s_add_u32 s44, s73, 18432
	s_add_u32 m0, s60, 10240
	s_nop 0
	buffer_load_dwordx4 v43, s[20:23], s44 offen nt lds
	s_add_u32 s44, s73, 27648
	s_add_u32 m0, s60, 11264
	s_nop 0
	buffer_load_dwordx4 v43, s[20:23], s44 offen nt lds
	s_add_u32 s44, s70, 512
	s_add_u32 m0, s60, 12288
	s_nop 0
	buffer_load_dwordx4 v42, s[20:23], s44 offen nt lds
	s_add_u32 s44, s70, 9728
	s_add_u32 m0, s60, 13312
	s_nop 0
	buffer_load_dwordx4 v42, s[20:23], s44 offen nt lds
	s_add_u32 s44, s70, 18944
	s_add_u32 m0, s60, 14336
	s_nop 0
	buffer_load_dwordx4 v43, s[20:23], s44 offen nt lds
	s_add_u32 s44, s70, 28160
	s_add_u32 m0, s60, 15360
	s_nop 0
	buffer_load_dwordx4 v43, s[20:23], s44 offen nt lds
	s_add_u32 s44, s72, 512
	s_add_u32 m0, s60, 16384
	s_nop 0
	buffer_load_dwordx4 v42, s[20:23], s44 offen nt lds
	s_add_u32 s44, s72, 9728
	s_add_u32 m0, s60, 17408
	s_nop 0
	buffer_load_dwordx4 v42, s[20:23], s44 offen nt lds
	s_add_u32 s44, s72, 18944
	s_add_u32 m0, s60, 18432
	s_nop 0
	buffer_load_dwordx4 v43, s[20:23], s44 offen nt lds
	s_add_u32 s44, s72, 28160
	s_add_u32 m0, s60, 19456
	s_nop 0
	buffer_load_dwordx4 v43, s[20:23], s44 offen nt lds
	s_add_u32 s44, s73, 512
	s_add_u32 m0, s60, 20480
	s_nop 0
	buffer_load_dwordx4 v42, s[20:23], s44 offen nt lds
	s_add_u32 s44, s73, 9728
	s_add_u32 m0, s60, 21504
	s_nop 0
	buffer_load_dwordx4 v42, s[20:23], s44 offen nt lds
	s_add_u32 s44, s73, 18944
	s_add_u32 m0, s60, 22528
	s_nop 0
	buffer_load_dwordx4 v43, s[20:23], s44 offen nt lds
	s_add_u32 s44, s73, 28160
	s_add_u32 m0, s60, 23552
	s_nop 0
	buffer_load_dwordx4 v43, s[20:23], s44 offen nt lds
	s_add_u32 s44, s67, 2097152
	s_add_u32 m0, s60, 24576
	s_nop 0
	buffer_load_dwordx4 v40, s[16:19], s44 offen nt lds
	s_add_u32 s44, s67, 2162688
	s_add_u32 m0, s60, 25600
	s_nop 0
	buffer_load_dwordx4 v40, s[16:19], s44 offen nt lds
	s_add_u32 s44, s67, 2228224
	s_add_u32 m0, s60, 26624
	s_nop 0
	buffer_load_dwordx4 v41, s[16:19], s44 offen nt lds
	s_add_u32 s44, s67, 2293760
	s_add_u32 m0, s60, 27648
	s_nop 0
	buffer_load_dwordx4 v41, s[16:19], s44 offen nt lds
	s_add_u32 s44, s67, 3145728
	s_add_u32 m0, s60, 28672
	s_nop 0
	buffer_load_dwordx4 v40, s[16:19], s44 offen nt lds
	s_add_u32 s44, s67, 3211264
	s_add_u32 m0, s60, 29696
	s_nop 0
	buffer_load_dwordx4 v40, s[16:19], s44 offen nt lds
	s_add_u32 s44, s67, 3276800
	s_add_u32 m0, s60, 30720
	s_nop 0
	buffer_load_dwordx4 v41, s[16:19], s44 offen nt lds
	s_add_u32 s44, s67, 3342336
	s_add_u32 m0, s60, 31744
	s_nop 0
	buffer_load_dwordx4 v41, s[16:19], s44 offen nt lds
	s_add_u32 s44, s68, 0
	s_add_u32 m0, s60, 32768
	s_nop 0
	buffer_load_dwordx4 v40, s[16:19], s44 offen nt lds
	s_add_u32 s44, s68, 65536
	s_add_u32 m0, s60, 33792
	s_nop 0
	buffer_load_dwordx4 v41, s[16:19], s44 offen nt lds
	s_add_u32 s44, s68, 131072
	s_add_u32 m0, s60, 34816
	s_nop 0
	buffer_load_dwordx4 v40, s[16:19], s44 offen nt lds
	s_add_u32 s44, s68, 196608
	s_add_u32 m0, s60, 35840
	s_nop 0
	buffer_load_dwordx4 v41, s[16:19], s44 offen nt lds
	s_movk_i32 s28, 0
	s_movk_i32 s59, 0
	s_movk_i32 s41, 0
	s_mov_b32 s33, 0x3000000
	s_bfe_u32 s45, s27, 0x20003
	s_mul_i32 s45, s45, 2560
	s_add_u32 s33, s33, s45
	s_bfe_u32 s45, s26, 0x10001
	s_mul_i32 s45, s45, 1024
	s_add_u32 s33, s33, s45
	s_bfe_u32 s45, s27, 0x30000
	s_mul_i32 s45, s45, 128
	s_add_u32 s33, s33, s45
	s_mov_b32 s34, 0x3000800
	s_bfe_u32 s45, s27, 0x20002
	s_mul_i32 s45, s45, 2560
	s_add_u32 s34, s34, s45
	s_bfe_u32 s45, s27, 0x20000
	s_mul_i32 s45, s45, 128
	s_add_u32 s34, s34, s45
	s_mov_b32 s32, 0x3000000
	s_bfe_u32 s45, s27, 0x50000
	s_mul_i32 s45, s45, 10368
	s_add_u32 s32, s32, s45
	s_bfe_u32 s45, s26, 0x20000
	s_mul_i32 s45, s45, 2560
	s_add_u32 s32, s32, s45
	s_mov_b32 s35, 0x3102000
	s_bfe_u32 s45, s27, 0x20002
	s_mul_i32 s45, s45, 256
	s_add_u32 s35, s35, s45
	s_bfe_u32 s45, s27, 0x10001
	s_mul_i32 s45, s45, 128
	s_add_u32 s35, s35, s45
	s_bfe_u32 s45, s27, 0x10000
	s_mul_i32 s45, s45, 8
	s_add_u32 s35, s35, s45
	s_mov_b32 s78, 0x400
	s_bfe_u32 s45, s27, 0x20002
	s_mul_i32 s45, s45, 32
	s_add_u32 s78, s78, s45
	s_bfe_u32 s45, s27, 0x20000
	s_mul_i32 s45, s45, 8
	s_add_u32 s78, s78, s45
	s_mov_b32 s94, 0x3100000
	s_bfe_u32 s45, s26, 0x20000
	s_mul_i32 s45, s45, 1024
	s_add_u32 s94, s94, s45
	s_mov_b32 s56, 0x3102000
	s_bfe_u32 s45, s27, 0x20000
	s_mul_i32 s45, s45, 1024
	s_add_u32 s56, s56, s45
	s_mov_b32 s92, 0x3100000
	s_bfe_u32 s45, s27, 0x10003
	s_mul_i32 s45, s45, 2048
	s_add_u32 s92, s92, s45
	s_bfe_u32 s45, s27, 0x10002
	s_mul_i32 s45, s45, 1024
	s_add_u32 s92, s92, s45
	s_bfe_u32 s45, s26, 0x10001
	s_mul_i32 s45, s45, 4096
	s_add_u32 s92, s92, s45
	s_bfe_u32 s45, s27, 0x10001
	s_mul_i32 s45, s45, 64
	s_add_u32 s92, s92, s45
	s_bfe_u32 s45, s27, 0x10004
	s_mul_i32 s45, s45, 512
	s_add_u32 s92, s92, s45
	s_bfe_u32 s45, s27, 0x10000
	s_mul_i32 s45, s45, 256
	s_add_u32 s92, s92, s45
	s_mov_b32 s79, 0x0
	s_bfe_u32 s45, s26, 0x10001
	s_mul_i32 s45, s45, 512
	s_add_u32 s79, s79, s45
	s_bfe_u32 s45, s27, 0x20003
	s_mul_i32 s45, s45, 128
	s_add_u32 s79, s79, s45
	s_bfe_u32 s45, s27, 0x10002
	s_mul_i32 s45, s45, 64
	s_add_u32 s79, s79, s45
	s_bfe_u32 s45, s27, 0x10000
	s_mul_i32 s45, s45, 16
	s_add_u32 s79, s79, s45
	s_bfe_u32 s45, s27, 0x10001
	s_mul_i32 s45, s45, 4608
	s_add_u32 s79, s79, s45
	s_cmp_eq_u32 s26, 1
	s_cselect_b32 s33, s34, s33
	s_cselect_b32 s92, s35, s92
	s_cselect_b32 s44, s27, 0
	s_cmp_gt_u32 s44, 15
	s_cselect_b32 s93, 3, s26
	s_add_u32 s34, s33, 82944
	s_add_u32 s35, s33, 165888
	s_add_u32 s38, s33, 248832
	s_mov_b32 s36, 0x1000
	s_bfe_u32 s45, s26, 0x20000
	s_mul_i32 s45, s45, 256
	s_add_u32 s36, s36, s45
	s_mov_b32 s39, s94
	s_mov_b32 s40, s56
	s_add_u32 s57, s94, 3072
	s_waitcnt vmcnt(40)
	buffer_load_ushort v28, v19, s[80:83], s79 offen
	buffer_load_ushort v30, v19, s[80:83], s79 offen offset:32
	buffer_load_dword v29, v19, s[80:83], s78 offen
	s_lshl_b32 s29, s27, 14
	s_lshl_b32 s44, s26, 12
	s_add_u32 s29, s29, s44
	s_lshl_b32 s30, s27, 13
	s_lshl_b32 s44, s26, 11
	s_add_u32 s30, s30, s44
	s_add_u32 s30, s30, 0x2000000
	s_add_u32 s58, s60, 4096
	s_add_u32 s97, s60, 36864
	s_add_u32 s31, s60, 2048
	s_mov_b32 s42, 0x80000
	s_mov_b32 s43, 0x3e0293ee
	s_lshl_b32 s44, s27, 7
	s_lshl_b32 s45, s26, 2
	s_add_u32 s44, s44, s45
	s_add_u32 s96, s44, 0x3301f00
	s_mov_b32 s98, 0x3f803f80
	s_mov_b32 s100, 0x3f003f00
	s_mov_b32 s99, 0x3f803f80
	s_mov_b32 s101, 0x3f003f00
	s_waitcnt vmcnt(41)
	v_mov_b32 v1, v12
	v_mov_b32 v2, v13
	v_mov_b32 v3, v14
	v_mov_b32 v4, v15
	v_mov_b32 v5, v16
	v_mov_b32 v6, v17
	s_cmp_eq_u32 s93, 3
	s_cselect_b32 s44, 0x80000000, 0
	v_or_b32 v18, s44, v18
	v_or_b32 v25, s44, v25
	ds_write_b32 v6, v18 offset:5120
	s_lshl_b32 s44, s26, 10
	v_add_u32 v8, s44, v0
	s_waitcnt vmcnt(39)
	ds_write_b128 v8, v[20:23]
	v_mov_b64 v[32:33], -1
	v_mov_b64 v[34:35], -1
	s_add_u32 s44, s33, 0x0
	buffer_store_dwordx4 v[32:35], v25, s[4:7], s44 offen sc1
	s_add_u32 s44, s34, 0x0
	buffer_store_dwordx4 v[32:35], v25, s[4:7], s44 offen sc1
	s_add_u32 s44, s35, 0x0
	buffer_store_dwordx4 v[32:35], v25, s[4:7], s44 offen sc1
	s_add_u32 s44, s38, 0x0
	buffer_store_dwordx4 v[32:35], v25, s[4:7], s44 offen sc1
	s_add_u32 s44, s33, 0x80000
	buffer_store_dwordx4 v[32:35], v25, s[4:7], s44 offen sc1
	s_add_u32 s44, s34, 0x80000
	buffer_store_dwordx4 v[32:35], v25, s[4:7], s44 offen sc1
	s_add_u32 s44, s35, 0x80000
	buffer_store_dwordx4 v[32:35], v25, s[4:7], s44 offen sc1
	s_add_u32 s44, s38, 0x80000
	buffer_store_dwordx4 v[32:35], v25, s[4:7], s44 offen sc1
	s_add_u32 s44, s92, 0x4000
	buffer_store_dword v32, v18, s[4:7], s44 offen sc1
	s_add_u32 s44, s92, 0x8000
	buffer_store_dword v32, v18, s[4:7], s44 offen sc1
	s_add_u32 s44, s92, 0xc000
	buffer_store_dword v32, v18, s[4:7], s44 offen sc1
	s_waitcnt vmcnt(12)
	v_lshl_or_b32 v28, v30, 16, v28
	s_cmp_eq_u32 s26, 1
	s_cselect_b64 vcc, -1, 0
	s_waitcnt vmcnt(11)
	v_cndmask_b32 v28, v28, v29, vcc
	buffer_store_dword v28, v18, s[4:7], s92 offen sc1
	s_waitcnt lgkmcnt(0)
	s_barrier
	v_add_u32 v52, s60, v48
	v_xor_b32 v53, 32, v52
	ds_read_b64_tr_b16 a[160:161], v52 offset:0
	ds_read_b64_tr_b16 a[162:163], v52 offset:256
	ds_read_b64_tr_b16 a[164:165], v52 offset:1024
	ds_read_b64_tr_b16 a[166:167], v52 offset:1280
	ds_read_b64_tr_b16 a[184:185], v53 offset:0
	ds_read_b64_tr_b16 a[186:187], v53 offset:256
	ds_read_b64_tr_b16 a[188:189], v53 offset:1024
	ds_read_b64_tr_b16 a[190:191], v53 offset:1280
	s_waitcnt lgkmcnt(0)
	s_barrier
	s_add_u32 s44, s66, 2097152
	s_add_u32 m0, s60, 0
	s_nop 0
	buffer_load_dwordx4 v40, s[8:11], s44 offen nt lds
	s_add_u32 s44, s66, 2162688
	s_add_u32 m0, s60, 1024
	s_nop 0
	buffer_load_dwordx4 v40, s[8:11], s44 offen nt lds
	s_add_u32 s44, s66, 2228224
	s_add_u32 m0, s60, 2048
	s_nop 0
	buffer_load_dwordx4 v41, s[8:11], s44 offen nt lds
	s_add_u32 s44, s66, 2293760
	s_add_u32 m0, s60, 3072
	s_nop 0
	buffer_load_dwordx4 v41, s[8:11], s44 offen nt lds
	v_add_u32 v52, s60, v48
	v_xor_b32 v53, 32, v52
	ds_read_b64_tr_b16 a[168:169], v52 offset:4096
	ds_read_b64_tr_b16 a[170:171], v52 offset:4352
	ds_read_b64_tr_b16 a[172:173], v52 offset:5120
	ds_read_b64_tr_b16 a[174:175], v52 offset:5376
	ds_read_b64_tr_b16 a[192:193], v53 offset:4096
	ds_read_b64_tr_b16 a[194:195], v53 offset:4352
	ds_read_b64_tr_b16 a[196:197], v53 offset:5120
	ds_read_b64_tr_b16 a[198:199], v53 offset:5376
	s_waitcnt lgkmcnt(0)
	s_barrier
	s_add_u32 s44, s66, 3145728
	s_add_u32 m0, s60, 4096
	s_nop 0
	buffer_load_dwordx4 v40, s[8:11], s44 offen nt lds
	s_add_u32 s44, s66, 3211264
	s_add_u32 m0, s60, 5120
	s_nop 0
	buffer_load_dwordx4 v40, s[8:11], s44 offen nt lds
	s_add_u32 s44, s66, 3276800
	s_add_u32 m0, s60, 6144
	s_nop 0
	buffer_load_dwordx4 v41, s[8:11], s44 offen nt lds
	s_add_u32 s44, s66, 3342336
	s_add_u32 m0, s60, 7168
	s_nop 0
	buffer_load_dwordx4 v41, s[8:11], s44 offen nt lds
	v_add_u32 v52, s60, v48
	v_xor_b32 v53, 32, v52
	ds_read_b64_tr_b16 a[176:177], v52 offset:8192
	ds_read_b64_tr_b16 a[178:179], v52 offset:8448
	ds_read_b64_tr_b16 a[180:181], v52 offset:9216
	ds_read_b64_tr_b16 a[182:183], v52 offset:9472
	ds_read_b64_tr_b16 a[200:201], v53 offset:8192
	ds_read_b64_tr_b16 a[202:203], v53 offset:8448
	ds_read_b64_tr_b16 a[204:205], v53 offset:9216
	ds_read_b64_tr_b16 a[206:207], v53 offset:9472
	s_waitcnt lgkmcnt(0)
	s_barrier
	s_add_u32 s44, s67, 2097152
	s_add_u32 m0, s60, 8192
	s_nop 0
	buffer_load_dwordx4 v40, s[8:11], s44 offen nt lds
	s_add_u32 s44, s67, 2162688
	s_add_u32 m0, s60, 9216
	s_nop 0
	buffer_load_dwordx4 v40, s[8:11], s44 offen nt lds
	s_add_u32 s44, s67, 2228224
	s_add_u32 m0, s60, 10240
	s_nop 0
	buffer_load_dwordx4 v41, s[8:11], s44 offen nt lds
	s_add_u32 s44, s67, 2293760
	s_add_u32 m0, s60, 11264
	s_nop 0
	buffer_load_dwordx4 v41, s[8:11], s44 offen nt lds
	v_mov_b32 v7, 0
	global_load_dword v6, v7, s[24:25] offset:8 sc1
	v_add_u32 v52, s60, v48
	v_xor_b32 v53, 32, v52
	ds_read_b64_tr_b16 a[208:209], v52 offset:12288
	ds_read_b64_tr_b16 a[210:211], v52 offset:12544
	ds_read_b64_tr_b16 a[212:213], v52 offset:13312
	ds_read_b64_tr_b16 a[214:215], v52 offset:13568
	ds_read_b64_tr_b16 a[232:233], v53 offset:12288
	ds_read_b64_tr_b16 a[234:235], v53 offset:12544
	ds_read_b64_tr_b16 a[236:237], v53 offset:13312
	ds_read_b64_tr_b16 a[238:239], v53 offset:13568
	s_waitcnt lgkmcnt(0)
	s_barrier
	s_add_u32 s44, s67, 3145728
	s_add_u32 m0, s60, 12288
	s_nop 0
	buffer_load_dwordx4 v40, s[8:11], s44 offen nt lds
	s_add_u32 s44, s67, 3211264
	s_add_u32 m0, s60, 13312
	s_nop 0
	buffer_load_dwordx4 v40, s[8:11], s44 offen nt lds
	s_add_u32 s44, s67, 3276800
	s_add_u32 m0, s60, 14336
	s_nop 0
	buffer_load_dwordx4 v41, s[8:11], s44 offen nt lds
	s_add_u32 s44, s67, 3342336
	s_add_u32 m0, s60, 15360
	s_nop 0
	buffer_load_dwordx4 v41, s[8:11], s44 offen nt lds
	v_add_u32 v52, s60, v48
	v_xor_b32 v53, 32, v52
	ds_read_b64_tr_b16 a[216:217], v52 offset:16384
	ds_read_b64_tr_b16 a[218:219], v52 offset:16640
	ds_read_b64_tr_b16 a[220:221], v52 offset:17408
	ds_read_b64_tr_b16 a[222:223], v52 offset:17664
	ds_read_b64_tr_b16 a[240:241], v53 offset:16384
	ds_read_b64_tr_b16 a[242:243], v53 offset:16640
	ds_read_b64_tr_b16 a[244:245], v53 offset:17408
	ds_read_b64_tr_b16 a[246:247], v53 offset:17664
	s_waitcnt lgkmcnt(0)
	s_barrier
	s_add_u32 s44, s66, 2097152
	s_add_u32 m0, s60, 16384
	s_nop 0
	buffer_load_dwordx4 v40, s[12:15], s44 offen nt lds
	s_add_u32 s44, s66, 2162688
	s_add_u32 m0, s60, 17408
	s_nop 0
	buffer_load_dwordx4 v40, s[12:15], s44 offen nt lds
	s_add_u32 s44, s66, 2228224
	s_add_u32 m0, s60, 18432
	s_nop 0
	buffer_load_dwordx4 v41, s[12:15], s44 offen nt lds
	s_add_u32 s44, s66, 2293760
	s_add_u32 m0, s60, 19456
	s_nop 0
	buffer_load_dwordx4 v41, s[12:15], s44 offen nt lds
	v_add_u32 v52, s60, v48
	v_xor_b32 v53, 32, v52
	ds_read_b64_tr_b16 a[224:225], v52 offset:20480
	ds_read_b64_tr_b16 a[226:227], v52 offset:20736
	ds_read_b64_tr_b16 a[228:229], v52 offset:21504
	ds_read_b64_tr_b16 a[230:231], v52 offset:21760
	ds_read_b64_tr_b16 a[248:249], v53 offset:20480
	ds_read_b64_tr_b16 a[250:251], v53 offset:20736
	ds_read_b64_tr_b16 a[252:253], v53 offset:21504
	ds_read_b64_tr_b16 a[254:255], v53 offset:21760
	s_waitcnt vmcnt(21)
	s_waitcnt lgkmcnt(0)
	s_barrier
	s_cmp_lg_u32 s26, 0
	s_cbranch_scc1 chain_nosign
	s_getreg_b32 s44, hwreg(HW_REG_XCC_ID)
	s_and_b32 s44, s44, 15
	s_mul_i32 s45, s44, s44
	s_lshl_b32 s45, s45, 16
	s_lshl_b32 s44, s44, 6
	s_add_u32 s44, s44, s45
	s_add_u32 s44, s44, 1
	s_mov_b64 exec, 1
	v_mov_b32 v8, s44
	v_mov_b32 v9, 0
	global_atomic_add v9, v8, s[24:25] sc1
	s_mov_b64 exec, -1
chain_nosign:
	s_add_u32 s44, s66, 3145728
	s_add_u32 m0, s60, 20480
	s_nop 0
	buffer_load_dwordx4 v40, s[12:15], s44 offen nt lds
	s_add_u32 s44, s66, 3211264
	s_add_u32 m0, s60, 21504
	s_nop 0
	buffer_load_dwordx4 v40, s[12:15], s44 offen nt lds
	s_add_u32 s44, s66, 3276800
	s_add_u32 m0, s60, 22528
	s_nop 0
	buffer_load_dwordx4 v41, s[12:15], s44 offen nt lds
	s_add_u32 s44, s66, 3342336
	s_add_u32 m0, s60, 23552
	s_nop 0
	buffer_load_dwordx4 v41, s[12:15], s44 offen nt lds
	v_add_u32 v52, s60, v47
	v_add_u32 v53, s61, v47
	v_xor_b32 v54, 32, v52
	v_xor_b32 v55, 32, v53
	ds_read_b64_tr_b16 a[96:97], v52 offset:24576
	ds_read_b64_tr_b16 a[98:99], v52 offset:24704
	ds_read_b64_tr_b16 a[100:101], v52 offset:28672
	ds_read_b64_tr_b16 a[102:103], v52 offset:28800
	ds_read_b64_tr_b16 a[104:105], v54 offset:24576
	ds_read_b64_tr_b16 a[106:107], v54 offset:24704
	ds_read_b64_tr_b16 a[108:109], v54 offset:28672
	ds_read_b64_tr_b16 a[110:111], v54 offset:28800
	ds_read_b64_tr_b16 a[128:129], v53 offset:24576
	ds_read_b64_tr_b16 a[130:131], v53 offset:24704
	ds_read_b64_tr_b16 a[132:133], v53 offset:28672
	ds_read_b64_tr_b16 a[134:135], v53 offset:28800
	ds_read_b64_tr_b16 a[136:137], v55 offset:24576
	ds_read_b64_tr_b16 a[138:139], v55 offset:24704
	ds_read_b64_tr_b16 a[140:141], v55 offset:28672
	ds_read_b64_tr_b16 a[142:143], v55 offset:28800
	s_waitcnt lgkmcnt(0)
	s_barrier
	s_add_u32 s44, s67, 2097152
	s_add_u32 m0, s60, 24576
	s_nop 0
	buffer_load_dwordx4 v40, s[12:15], s44 offen nt lds
	s_add_u32 s44, s67, 2162688
	s_add_u32 m0, s60, 25600
	s_nop 0
	buffer_load_dwordx4 v40, s[12:15], s44 offen nt lds
	s_add_u32 s44, s67, 2228224
	s_add_u32 m0, s60, 26624
	s_nop 0
	buffer_load_dwordx4 v41, s[12:15], s44 offen nt lds
	s_add_u32 s44, s67, 2293760
	s_add_u32 m0, s60, 27648
	s_nop 0
	buffer_load_dwordx4 v41, s[12:15], s44 offen nt lds
	s_add_u32 s44, s67, 3145728
	s_add_u32 m0, s60, 28672
	s_nop 0
	buffer_load_dwordx4 v40, s[12:15], s44 offen nt lds
	s_add_u32 s44, s67, 3211264
	s_add_u32 m0, s60, 29696
	s_nop 0
	buffer_load_dwordx4 v40, s[12:15], s44 offen nt lds
	s_add_u32 s44, s67, 3276800
	s_add_u32 m0, s60, 30720
	s_nop 0
	buffer_load_dwordx4 v41, s[12:15], s44 offen nt lds
	s_add_u32 s44, s67, 3342336
	s_add_u32 m0, s60, 31744
	s_nop 0
	buffer_load_dwordx4 v41, s[12:15], s44 offen nt lds
	v_add_u32 v52, s62, v51
	v_add_u32 v53, s63, v51
	v_xor_b32 v54, 32, v52
	v_xor_b32 v55, 32, v53
	ds_read_b64_tr_b16 a[144:145], v52 offset:32768
	ds_read_b64_tr_b16 a[146:147], v52 offset:33024
	ds_read_b64_tr_b16 a[148:149], v53 offset:32768
	ds_read_b64_tr_b16 a[150:151], v53 offset:33024
	ds_read_b64_tr_b16 a[152:153], v54 offset:32768
	ds_read_b64_tr_b16 a[154:155], v54 offset:33024
	ds_read_b64_tr_b16 a[156:157], v55 offset:32768
	ds_read_b64_tr_b16 a[158:159], v55 offset:33024
	s_waitcnt vmcnt(25)
	s_waitcnt lgkmcnt(0)
	s_barrier
	s_add_u32 s44, s68, 0
	s_add_u32 m0, s60, 32768
	s_nop 0
	buffer_load_dwordx4 v40, s[8:11], s44 offen nt lds
	s_add_u32 s44, s68, 65536
	s_add_u32 m0, s60, 33792
	s_nop 0
	buffer_load_dwordx4 v41, s[8:11], s44 offen nt lds
	s_add_u32 s44, s68, 131072
	s_add_u32 m0, s60, 34816
	s_nop 0
	buffer_load_dwordx4 v40, s[8:11], s44 offen nt lds
	s_add_u32 s44, s68, 196608
	s_add_u32 m0, s60, 35840
	s_nop 0
	buffer_load_dwordx4 v41, s[8:11], s44 offen nt lds
	v_add_u32 v52, s60, v46
	v_add_u32 v53, s61, v46
	ds_read_b64_tr_b16 v[56:57], v52 offset:0
	ds_read_b64_tr_b16 v[58:59], v52 offset:128
	ds_read_b64_tr_b16 v[60:61], v52 offset:4096
	ds_read_b64_tr_b16 v[62:63], v52 offset:4224
	ds_read_b64_tr_b16 v[64:65], v52 offset:16
	ds_read_b64_tr_b16 v[66:67], v52 offset:144
	ds_read_b64_tr_b16 v[68:69], v52 offset:4112
	ds_read_b64_tr_b16 v[70:71], v52 offset:4240
	ds_read_b64_tr_b16 v[72:73], v53 offset:0
	ds_read_b64_tr_b16 v[74:75], v53 offset:128
	ds_read_b64_tr_b16 v[76:77], v53 offset:4096
	ds_read_b64_tr_b16 v[78:79], v53 offset:4224
	ds_read_b64_tr_b16 v[80:81], v53 offset:16
	ds_read_b64_tr_b16 v[82:83], v53 offset:144
	ds_read_b64_tr_b16 v[84:85], v53 offset:4112
	ds_read_b64_tr_b16 v[86:87], v53 offset:4240
	s_waitcnt vmcnt(20)
	s_waitcnt lgkmcnt(0)
	s_barrier
	s_add_u32 s44, s67, 0
	s_add_u32 m0, s60, 0
	s_nop 0
	buffer_load_dwordx4 v40, s[12:15], s44 offen nt lds
	s_add_u32 s44, s67, 65536
	s_add_u32 m0, s60, 1024
	s_nop 0
	buffer_load_dwordx4 v40, s[12:15], s44 offen nt lds
	s_add_u32 s44, s67, 131072
	s_add_u32 m0, s60, 2048
	s_nop 0
	buffer_load_dwordx4 v41, s[12:15], s44 offen nt lds
	s_add_u32 s44, s67, 196608
	s_add_u32 m0, s60, 3072
	s_nop 0
	buffer_load_dwordx4 v41, s[12:15], s44 offen nt lds
	s_add_u32 s44, s67, 1048576
	s_add_u32 m0, s60, 4096
	s_nop 0
	buffer_load_dwordx4 v40, s[12:15], s44 offen nt lds
	s_add_u32 s44, s67, 1114112
	s_add_u32 m0, s60, 5120
	s_nop 0
	buffer_load_dwordx4 v40, s[12:15], s44 offen nt lds
	s_add_u32 s44, s67, 1179648
	s_add_u32 m0, s60, 6144
	s_nop 0
	buffer_load_dwordx4 v41, s[12:15], s44 offen nt lds
	s_add_u32 s44, s67, 1245184
	s_add_u32 m0, s60, 7168
	s_nop 0
	buffer_load_dwordx4 v41, s[12:15], s44 offen nt lds
	v_readfirstlane_b32 s44, v6
	s_cmp_lg_u32 s44, 0
	s_cbranch_scc1 chain_clrn
chain_clrnl:
	global_load_dword v6, v7, s[24:25] offset:8 sc1
	s_sub_u32 s42, s42, 1
	s_cbranch_scc1 chain_end
	s_waitcnt vmcnt(0)
	v_readfirstlane_b32 s44, v6
	s_cmp_lg_u32 s44, 0
	s_cbranch_scc0 chain_clrnl
chain_clrn:
	buffer_load_dword v6, off, s[4:7], s96 offset:256 sc1
	v_add_u32 v52, s60, v46
	v_add_u32 v53, s61, v46
	ds_read_b64_tr_b16 v[88:89], v52 offset:8192
	ds_read_b64_tr_b16 v[90:91], v52 offset:8320
	ds_read_b64_tr_b16 v[92:93], v52 offset:12288
	ds_read_b64_tr_b16 v[94:95], v52 offset:12416
	ds_read_b64_tr_b16 v[96:97], v52 offset:8208
	ds_read_b64_tr_b16 v[98:99], v52 offset:8336
	ds_read_b64_tr_b16 v[100:101], v52 offset:12304
	ds_read_b64_tr_b16 v[102:103], v52 offset:12432
	ds_read_b64_tr_b16 v[104:105], v53 offset:8192
	ds_read_b64_tr_b16 v[106:107], v53 offset:8320
	ds_read_b64_tr_b16 v[108:109], v53 offset:12288
	ds_read_b64_tr_b16 v[110:111], v53 offset:12416
	ds_read_b64_tr_b16 v[112:113], v53 offset:8208
	ds_read_b64_tr_b16 v[114:115], v53 offset:8336
	ds_read_b64_tr_b16 v[116:117], v53 offset:12304
	ds_read_b64_tr_b16 v[118:119], v53 offset:12432
	s_waitcnt vmcnt(21)
	s_waitcnt lgkmcnt(0)
	s_barrier
	s_add_u32 s44, s66, 0
	s_add_u32 m0, s60, 8192
	s_nop 0
	buffer_load_dwordx4 v40, s[16:19], s44 offen nt lds
	s_add_u32 s44, s66, 65536
	s_add_u32 m0, s60, 9216
	s_nop 0
	buffer_load_dwordx4 v40, s[16:19], s44 offen nt lds
	s_add_u32 s44, s66, 131072
	s_add_u32 m0, s60, 10240
	s_nop 0
	buffer_load_dwordx4 v41, s[16:19], s44 offen nt lds
	s_add_u32 s44, s66, 196608
	s_add_u32 m0, s60, 11264
	s_nop 0
	buffer_load_dwordx4 v41, s[16:19], s44 offen nt lds
	s_add_u32 s44, s66, 1048576
	s_add_u32 m0, s60, 12288
	s_nop 0
	buffer_load_dwordx4 v40, s[16:19], s44 offen nt lds
	s_add_u32 s44, s66, 1114112
	s_add_u32 m0, s60, 13312
	s_nop 0
	buffer_load_dwordx4 v40, s[16:19], s44 offen nt lds
	s_add_u32 s44, s66, 1179648
	s_add_u32 m0, s60, 14336
	s_nop 0
	buffer_load_dwordx4 v41, s[16:19], s44 offen nt lds
	s_add_u32 s44, s66, 1245184
	s_add_u32 m0, s60, 15360
	s_nop 0
	buffer_load_dwordx4 v41, s[16:19], s44 offen nt lds
	v_add_u32 v52, s60, v46
	v_add_u32 v53, s61, v46
	ds_read_b64_tr_b16 v[144:145], v52 offset:16384
	ds_read_b64_tr_b16 v[146:147], v52 offset:16512
	ds_read_b64_tr_b16 v[148:149], v52 offset:20480
	ds_read_b64_tr_b16 v[150:151], v52 offset:20608
	ds_read_b64_tr_b16 v[152:153], v52 offset:16400
	ds_read_b64_tr_b16 v[154:155], v52 offset:16528
	ds_read_b64_tr_b16 v[156:157], v52 offset:20496
	ds_read_b64_tr_b16 v[158:159], v52 offset:20624
	ds_read_b64_tr_b16 v[176:177], v53 offset:16384
	ds_read_b64_tr_b16 v[178:179], v53 offset:16512
	ds_read_b64_tr_b16 v[180:181], v53 offset:20480
	ds_read_b64_tr_b16 v[182:183], v53 offset:20608
	ds_read_b64_tr_b16 v[184:185], v53 offset:16400
	ds_read_b64_tr_b16 v[186:187], v53 offset:16528
	ds_read_b64_tr_b16 v[188:189], v53 offset:20496
	ds_read_b64_tr_b16 v[190:191], v53 offset:20624
	s_waitcnt vmcnt(21)
	s_waitcnt lgkmcnt(0)
	s_barrier
	s_add_u32 s44, s67, 0
	s_add_u32 m0, s60, 16384
	s_nop 0
	buffer_load_dwordx4 v40, s[16:19], s44 offen nt lds
	s_add_u32 s44, s67, 65536
	s_add_u32 m0, s60, 17408
	s_nop 0
	buffer_load_dwordx4 v40, s[16:19], s44 offen nt lds
	s_add_u32 s44, s67, 131072
	s_add_u32 m0, s60, 18432
	s_nop 0
	buffer_load_dwordx4 v41, s[16:19], s44 offen nt lds
	s_add_u32 s44, s67, 196608
	s_add_u32 m0, s60, 19456
	s_nop 0
	buffer_load_dwordx4 v41, s[16:19], s44 offen nt lds
	s_add_u32 s44, s67, 1048576
	s_add_u32 m0, s60, 20480
	s_nop 0
	buffer_load_dwordx4 v40, s[16:19], s44 offen nt lds
	s_add_u32 s44, s67, 1114112
	s_add_u32 m0, s60, 21504
	s_nop 0
	buffer_load_dwordx4 v40, s[16:19], s44 offen nt lds
	s_add_u32 s44, s67, 1179648
	s_add_u32 m0, s60, 22528
	s_nop 0
	buffer_load_dwordx4 v41, s[16:19], s44 offen nt lds
	s_add_u32 s44, s67, 1245184
	s_add_u32 m0, s60, 23552
	s_nop 0
	buffer_load_dwordx4 v41, s[16:19], s44 offen nt lds
	v_add_u32 v52, s60, v46
	v_add_u32 v53, s61, v46
	ds_read_b64_tr_b16 v[208:209], v52 offset:24576
	ds_read_b64_tr_b16 v[210:211], v52 offset:24704
	ds_read_b64_tr_b16 v[212:213], v52 offset:28672
	ds_read_b64_tr_b16 v[214:215], v52 offset:28800
	ds_read_b64_tr_b16 v[216:217], v52 offset:24592
	ds_read_b64_tr_b16 v[218:219], v52 offset:24720
	ds_read_b64_tr_b16 v[220:221], v52 offset:28688
	ds_read_b64_tr_b16 v[222:223], v52 offset:28816
	ds_read_b64_tr_b16 v[240:241], v53 offset:24576
	ds_read_b64_tr_b16 v[242:243], v53 offset:24704
	ds_read_b64_tr_b16 v[244:245], v53 offset:28672
	ds_read_b64_tr_b16 v[246:247], v53 offset:28800
	ds_read_b64_tr_b16 v[248:249], v53 offset:24592
	ds_read_b64_tr_b16 v[250:251], v53 offset:24720
	ds_read_b64_tr_b16 v[252:253], v53 offset:28688
	ds_read_b64_tr_b16 v[254:255], v53 offset:28816
	s_waitcnt vmcnt(25)
	s_waitcnt lgkmcnt(0)
	s_barrier
	s_cmp_lg_u32 s26, 0
	s_cbranch_scc1 chain_nosig2n
	s_mov_b64 exec, 1
	v_mov_b32 v52, 1
	v_mov_b32 v53, 0
	global_atomic_add v53, v52, s[24:25] offset:128 sc1
	s_mov_b64 exec, -1
chain_nosig2n:
	s_add_u32 s44, s66, 2097152
	s_add_u32 m0, s60, 24576
	s_nop 0
	buffer_load_dwordx4 v40, s[16:19], s44 offen nt lds
	s_add_u32 s44, s66, 2162688
	s_add_u32 m0, s60, 25600
	s_nop 0
	buffer_load_dwordx4 v40, s[16:19], s44 offen nt lds
	s_add_u32 s44, s66, 2228224
	s_add_u32 m0, s60, 26624
	s_nop 0
	buffer_load_dwordx4 v41, s[16:19], s44 offen nt lds
	s_add_u32 s44, s66, 2293760
	s_add_u32 m0, s60, 27648
	s_nop 0
	buffer_load_dwordx4 v41, s[16:19], s44 offen nt lds
	s_add_u32 s44, s66, 3145728
	s_add_u32 m0, s60, 28672
	s_nop 0
	buffer_load_dwordx4 v40, s[16:19], s44 offen nt lds
	s_add_u32 s44, s66, 3211264
	s_add_u32 m0, s60, 29696
	s_nop 0
	buffer_load_dwordx4 v40, s[16:19], s44 offen nt lds
	s_add_u32 s44, s66, 3276800
	s_add_u32 m0, s60, 30720
	s_nop 0
	buffer_load_dwordx4 v41, s[16:19], s44 offen nt lds
	s_add_u32 s44, s66, 3342336
	s_add_u32 m0, s60, 31744
	s_nop 0
	buffer_load_dwordx4 v41, s[16:19], s44 offen nt lds
	v_add_u32 v52, s62, v50
	v_add_u32 v53, s63, v50
	ds_read_b64_tr_b16 v[120:121], v52 offset:32768
	ds_read_b64_tr_b16 v[122:123], v52 offset:33024
	ds_read_b64_tr_b16 v[124:125], v53 offset:32768
	ds_read_b64_tr_b16 v[126:127], v53 offset:33024
	ds_read_b64_tr_b16 v[128:129], v52 offset:32784
	ds_read_b64_tr_b16 v[130:131], v52 offset:33040
	ds_read_b64_tr_b16 v[132:133], v53 offset:32784
	ds_read_b64_tr_b16 v[134:135], v53 offset:33040
	s_waitcnt vmcnt(25)
	s_waitcnt lgkmcnt(0)
	s_barrier
	s_add_u32 s44, s68, 0
	s_add_u32 m0, s60, 32768
	s_nop 0
	buffer_load_dwordx4 v40, s[12:15], s44 offen nt lds
	s_add_u32 s44, s68, 65536
	s_add_u32 m0, s60, 33792
	s_nop 0
	buffer_load_dwordx4 v41, s[12:15], s44 offen nt lds
	s_add_u32 s44, s68, 131072
	s_add_u32 m0, s60, 34816
	s_nop 0
	buffer_load_dwordx4 v40, s[12:15], s44 offen nt lds
	s_add_u32 s44, s68, 196608
	s_add_u32 m0, s60, 35840
	s_nop 0
	buffer_load_dwordx4 v41, s[12:15], s44 offen nt lds
	v_add_u32 v52, s60, v46
	v_add_u32 v53, s61, v46
	ds_read_b64_tr_b16 v[192:193], v52 offset:0
	ds_read_b64_tr_b16 v[194:195], v52 offset:128
	ds_read_b64_tr_b16 v[196:197], v52 offset:4096
	ds_read_b64_tr_b16 v[198:199], v52 offset:4224
	ds_read_b64_tr_b16 v[200:201], v52 offset:16
	ds_read_b64_tr_b16 v[202:203], v52 offset:144
	ds_read_b64_tr_b16 v[204:205], v52 offset:4112
	ds_read_b64_tr_b16 v[206:207], v52 offset:4240
	ds_read_b64_tr_b16 v[224:225], v53 offset:0
	ds_read_b64_tr_b16 v[226:227], v53 offset:128
	ds_read_b64_tr_b16 v[228:229], v53 offset:4096
	ds_read_b64_tr_b16 v[230:231], v53 offset:4224
	ds_read_b64_tr_b16 v[232:233], v53 offset:16
	ds_read_b64_tr_b16 v[234:235], v53 offset:144
	ds_read_b64_tr_b16 v[236:237], v53 offset:4112
	ds_read_b64_tr_b16 v[238:239], v53 offset:4240
	s_waitcnt vmcnt(20)
	s_waitcnt lgkmcnt(0)
	s_barrier
	s_add_u32 s44, s66, 0
	s_add_u32 m0, s60, 0
	s_nop 0
	buffer_load_dwordx4 v40, s[12:15], s44 offen nt lds
	s_add_u32 s44, s66, 65536
	s_add_u32 m0, s60, 1024
	s_nop 0
	buffer_load_dwordx4 v40, s[12:15], s44 offen nt lds
	s_add_u32 s44, s66, 131072
	s_add_u32 m0, s60, 2048
	s_nop 0
	buffer_load_dwordx4 v41, s[12:15], s44 offen nt lds
	s_add_u32 s44, s66, 196608
	s_add_u32 m0, s60, 3072
	s_nop 0
	buffer_load_dwordx4 v41, s[12:15], s44 offen nt lds
	s_add_u32 s44, s66, 1048576
	s_add_u32 m0, s60, 4096
	s_nop 0
	buffer_load_dwordx4 v40, s[12:15], s44 offen nt lds
	s_add_u32 s44, s66, 1114112
	s_add_u32 m0, s60, 5120
	s_nop 0
	buffer_load_dwordx4 v40, s[12:15], s44 offen nt lds
	s_add_u32 s44, s66, 1179648
	s_add_u32 m0, s60, 6144
	s_nop 0
	buffer_load_dwordx4 v41, s[12:15], s44 offen nt lds
	s_add_u32 s44, s66, 1245184
	s_add_u32 m0, s60, 7168
	s_nop 0
	buffer_load_dwordx4 v41, s[12:15], s44 offen nt lds
	v_add_u32 v52, s60, v47
	v_add_u32 v53, s61, v47
	v_xor_b32 v54, 32, v52
	v_xor_b32 v55, 32, v53
	ds_read_b64_tr_b16 a[16:17], v52 offset:8192
	ds_read_b64_tr_b16 a[18:19], v52 offset:8320
	ds_read_b64_tr_b16 a[20:21], v52 offset:12288
	ds_read_b64_tr_b16 a[22:23], v52 offset:12416
	ds_read_b64_tr_b16 a[24:25], v54 offset:8192
	ds_read_b64_tr_b16 a[26:27], v54 offset:8320
	ds_read_b64_tr_b16 a[28:29], v54 offset:12288
	ds_read_b64_tr_b16 a[30:31], v54 offset:12416
	ds_read_b64_tr_b16 a[48:49], v53 offset:8192
	ds_read_b64_tr_b16 a[50:51], v53 offset:8320
	ds_read_b64_tr_b16 a[52:53], v53 offset:12288
	ds_read_b64_tr_b16 a[54:55], v53 offset:12416
	ds_read_b64_tr_b16 a[56:57], v55 offset:8192
	ds_read_b64_tr_b16 a[58:59], v55 offset:8320
	ds_read_b64_tr_b16 a[60:61], v55 offset:12288
	ds_read_b64_tr_b16 a[62:63], v55 offset:12416
	s_waitcnt vmcnt(20)
	s_waitcnt lgkmcnt(0)
	s_barrier
	s_add_u32 s44, s66, 0
	s_add_u32 m0, s60, 8192
	s_nop 0
	buffer_load_dwordx4 v40, s[8:11], s44 offen nt lds
	s_add_u32 s44, s66, 65536
	s_add_u32 m0, s60, 9216
	s_nop 0
	buffer_load_dwordx4 v40, s[8:11], s44 offen nt lds
	s_add_u32 s44, s66, 131072
	s_add_u32 m0, s60, 10240
	s_nop 0
	buffer_load_dwordx4 v41, s[8:11], s44 offen nt lds
	s_add_u32 s44, s66, 196608
	s_add_u32 m0, s60, 11264
	s_nop 0
	buffer_load_dwordx4 v41, s[8:11], s44 offen nt lds
	s_add_u32 s44, s66, 1048576
	s_add_u32 m0, s60, 12288
	s_nop 0
	buffer_load_dwordx4 v40, s[8:11], s44 offen nt lds
	s_add_u32 s44, s66, 1114112
	s_add_u32 m0, s60, 13312
	s_nop 0
	buffer_load_dwordx4 v40, s[8:11], s44 offen nt lds
	s_add_u32 s44, s66, 1179648
	s_add_u32 m0, s60, 14336
	s_nop 0
	buffer_load_dwordx4 v41, s[8:11], s44 offen nt lds
	s_add_u32 s44, s66, 1245184
	s_add_u32 m0, s60, 15360
	s_nop 0
	buffer_load_dwordx4 v41, s[8:11], s44 offen nt lds
	v_add_u32 v52, s60, v47
	v_add_u32 v53, s61, v47
	v_xor_b32 v54, 32, v52
	v_xor_b32 v55, 32, v53
	ds_read_b64_tr_b16 a[80:81], v52 offset:16384
	ds_read_b64_tr_b16 a[82:83], v52 offset:16512
	ds_read_b64_tr_b16 a[84:85], v52 offset:20480
	ds_read_b64_tr_b16 a[86:87], v52 offset:20608
	ds_read_b64_tr_b16 a[88:89], v54 offset:16384
	ds_read_b64_tr_b16 a[90:91], v54 offset:16512
	ds_read_b64_tr_b16 a[92:93], v54 offset:20480
	ds_read_b64_tr_b16 a[94:95], v54 offset:20608
	ds_read_b64_tr_b16 a[112:113], v53 offset:16384
	ds_read_b64_tr_b16 a[114:115], v53 offset:16512
	ds_read_b64_tr_b16 a[116:117], v53 offset:20480
	ds_read_b64_tr_b16 a[118:119], v53 offset:20608
	ds_read_b64_tr_b16 a[120:121], v55 offset:16384
	ds_read_b64_tr_b16 a[122:123], v55 offset:16512
	ds_read_b64_tr_b16 a[124:125], v55 offset:20480
	ds_read_b64_tr_b16 a[126:127], v55 offset:20608
	s_waitcnt vmcnt(20)
	s_waitcnt lgkmcnt(0)
	s_barrier
	s_add_u32 s44, s67, 0
	s_add_u32 m0, s60, 16384
	s_nop 0
	buffer_load_dwordx4 v40, s[8:11], s44 offen nt lds
	s_add_u32 s44, s67, 65536
	s_add_u32 m0, s60, 17408
	s_nop 0
	buffer_load_dwordx4 v40, s[8:11], s44 offen nt lds
	s_add_u32 s44, s67, 131072
	s_add_u32 m0, s60, 18432
	s_nop 0
	buffer_load_dwordx4 v41, s[8:11], s44 offen nt lds
	s_add_u32 s44, s67, 196608
	s_add_u32 m0, s60, 19456
	s_nop 0
	buffer_load_dwordx4 v41, s[8:11], s44 offen nt lds
	s_add_u32 s44, s67, 1048576
	s_add_u32 m0, s60, 20480
	s_nop 0
	buffer_load_dwordx4 v40, s[8:11], s44 offen nt lds
	s_add_u32 s44, s67, 1114112
	s_add_u32 m0, s60, 21504
	s_nop 0
	buffer_load_dwordx4 v40, s[8:11], s44 offen nt lds
	s_add_u32 s44, s67, 1179648
	s_add_u32 m0, s60, 22528
	s_nop 0
	buffer_load_dwordx4 v41, s[8:11], s44 offen nt lds
	s_add_u32 s44, s67, 1245184
	s_add_u32 m0, s60, 23552
	s_nop 0
	buffer_load_dwordx4 v41, s[8:11], s44 offen nt lds
	v_add_u32 v52, s60, v47
	v_add_u32 v53, s61, v47
	v_xor_b32 v54, 32, v52
	v_xor_b32 v55, 32, v53
	ds_read_b64_tr_b16 a[32:33], v52 offset:24576
	ds_read_b64_tr_b16 a[34:35], v52 offset:24704
	ds_read_b64_tr_b16 a[36:37], v52 offset:28672
	ds_read_b64_tr_b16 a[38:39], v52 offset:28800
	ds_read_b64_tr_b16 a[40:41], v54 offset:24576
	ds_read_b64_tr_b16 a[42:43], v54 offset:24704
	ds_read_b64_tr_b16 a[44:45], v54 offset:28672
	ds_read_b64_tr_b16 a[46:47], v54 offset:28800
	ds_read_b64_tr_b16 a[64:65], v53 offset:24576
	ds_read_b64_tr_b16 a[66:67], v53 offset:24704
	ds_read_b64_tr_b16 a[68:69], v53 offset:28672
	ds_read_b64_tr_b16 a[70:71], v53 offset:28800
	ds_read_b64_tr_b16 a[72:73], v55 offset:24576
	ds_read_b64_tr_b16 a[74:75], v55 offset:24704
	ds_read_b64_tr_b16 a[76:77], v55 offset:28672
	ds_read_b64_tr_b16 a[78:79], v55 offset:28800
	s_waitcnt vmcnt(24)
	s_waitcnt lgkmcnt(0)
	s_barrier
	s_add_u32 s44, s70, 0
	s_add_u32 m0, s60, 24576
	s_nop 0
	buffer_load_dwordx4 v42, s[20:23], s44 offen nt lds
	s_add_u32 s44, s70, 9216
	s_add_u32 m0, s60, 25600
	s_nop 0
	buffer_load_dwordx4 v42, s[20:23], s44 offen nt lds
	s_add_u32 s44, s70, 18432
	s_add_u32 m0, s60, 26624
	s_nop 0
	buffer_load_dwordx4 v43, s[20:23], s44 offen nt lds
	s_add_u32 s44, s70, 27648
	s_add_u32 m0, s60, 27648
	s_nop 0
	buffer_load_dwordx4 v43, s[20:23], s44 offen nt lds
	s_add_u32 s44, s71, 512
	s_add_u32 m0, s60, 28672
	s_nop 0
	buffer_load_dwordx4 v42, s[20:23], s44 offen nt lds
	s_add_u32 s44, s71, 9728
	s_add_u32 m0, s60, 29696
	s_nop 0
	buffer_load_dwordx4 v42, s[20:23], s44 offen nt lds
	s_add_u32 s44, s71, 18944
	s_add_u32 m0, s60, 30720
	s_nop 0
	buffer_load_dwordx4 v43, s[20:23], s44 offen nt lds
	s_add_u32 s44, s71, 28160
	s_add_u32 m0, s60, 31744
	s_nop 0
	buffer_load_dwordx4 v43, s[20:23], s44 offen nt lds
	v_add_u32 v52, s62, v50
	v_add_u32 v53, s63, v50
	ds_read_b64_tr_b16 a[0:1], v52 offset:32768
	ds_read_b64_tr_b16 a[2:3], v52 offset:33024
	ds_read_b64_tr_b16 a[4:5], v53 offset:32768
	ds_read_b64_tr_b16 a[6:7], v53 offset:33024
	ds_read_b64_tr_b16 a[8:9], v52 offset:32784
	ds_read_b64_tr_b16 a[10:11], v52 offset:33040
	ds_read_b64_tr_b16 a[12:13], v53 offset:32784
	ds_read_b64_tr_b16 a[14:15], v53 offset:33040
	s_waitcnt vmcnt(24)
	s_waitcnt lgkmcnt(0)
	s_barrier
	s_add_u32 s44, s69, 0
	s_add_u32 m0, s60, 32768
	s_nop 0
	buffer_load_dwordx4 v44, s[20:23], s44 offen nt lds
	s_add_u32 s44, s69, 9216
	s_add_u32 m0, s60, 33792
	s_nop 0
	buffer_load_dwordx4 v44, s[20:23], s44 offen nt lds
	s_add_u32 s44, s69, 18432
	s_add_u32 m0, s60, 34816
	s_nop 0
	buffer_load_dwordx4 v45, s[20:23], s44 offen nt lds
	s_add_u32 s44, s69, 27648
	s_add_u32 m0, s60, 35840
	s_nop 0
	buffer_load_dwordx4 v45, s[20:23], s44 offen nt lds
	v_add_u32 v52, s60, v46
	v_add_u32 v53, s61, v46
	ds_read_b64_tr_b16 v[8:9], v52 offset:0
	ds_read_b64_tr_b16 v[10:11], v52 offset:128
	ds_read_b64_tr_b16 v[12:13], v52 offset:4096
	ds_read_b64_tr_b16 v[14:15], v52 offset:4224
	ds_read_b64_tr_b16 v[136:137], v52 offset:16
	ds_read_b64_tr_b16 v[138:139], v52 offset:144
	ds_read_b64_tr_b16 v[140:141], v52 offset:4112
	ds_read_b64_tr_b16 v[142:143], v52 offset:4240
	ds_read_b64_tr_b16 v[160:161], v53 offset:0
	ds_read_b64_tr_b16 v[162:163], v53 offset:128
	ds_read_b64_tr_b16 v[164:165], v53 offset:4096
	ds_read_b64_tr_b16 v[166:167], v53 offset:4224
	ds_read_b64_tr_b16 v[168:169], v53 offset:16
	ds_read_b64_tr_b16 v[170:171], v53 offset:144
	ds_read_b64_tr_b16 v[172:173], v53 offset:4112
	ds_read_b64_tr_b16 v[174:175], v53 offset:4240
	s_waitcnt vmcnt(20)
	s_waitcnt lgkmcnt(0)
	s_barrier
	ds_write_b128 v2, v[8:11] offset:0
	ds_write_b128 v2, v[12:15] offset:1024
	v_readfirstlane_b32 s95, v6
	s_cmp_lg_u32 s95, 0
	s_cbranch_scc1 chain_kv0n
chain_kv0nl:
	buffer_load_dword v6, off, s[4:7], s96 offset:256 sc1
	s_sub_u32 s42, s42, 1
	s_cbranch_scc1 chain_end
	s_waitcnt vmcnt(0)
	v_readfirstlane_b32 s95, v6
	s_cmp_lg_u32 s95, 0
	s_cbranch_scc0 chain_kv0nl
chain_kv0n:
	s_mov_b32 m0, s58
	s_nop 0
	buffer_load_dwordx4 v0, s[4:7], s29 offen offset:0 sc1 lds
	buffer_load_dwordx4 v0, s[4:7], s29 offen offset:1024 sc1 lds
	buffer_load_dwordx4 v0, s[4:7], s29 offen offset:2048 sc1 lds
	buffer_load_dwordx4 v0, s[4:7], s29 offen offset:3072 sc1 lds
	v_add_u32 v52, s60, v46
	v_add_u32 v53, s61, v46
	ds_read_b64_tr_b16 v[8:9], v52 offset:8192
	ds_read_b64_tr_b16 v[10:11], v52 offset:8320
	ds_read_b64_tr_b16 v[12:13], v52 offset:12288
	ds_read_b64_tr_b16 v[14:15], v52 offset:12416
	ds_read_b64_tr_b16 v[16:17], v52 offset:8208
	ds_read_b64_tr_b16 v[18:19], v52 offset:8336
	ds_read_b64_tr_b16 v[20:21], v52 offset:12304
	ds_read_b64_tr_b16 v[22:23], v52 offset:12432
	ds_read_b64_tr_b16 v[24:25], v53 offset:8192
	ds_read_b64_tr_b16 v[26:27], v53 offset:8320
	ds_read_b64_tr_b16 v[28:29], v53 offset:12288
	ds_read_b64_tr_b16 v[30:31], v53 offset:12416
	ds_read_b64_tr_b16 v[32:33], v53 offset:8208
	ds_read_b64_tr_b16 v[34:35], v53 offset:8336
	ds_read_b64_tr_b16 v[36:37], v53 offset:12304
	ds_read_b64_tr_b16 v[38:39], v53 offset:12432
	s_waitcnt vmcnt(16)
	s_waitcnt lgkmcnt(0)
	s_barrier
	ds_write_b128 v2, v[8:11] offset:8192
	ds_write_b128 v2, v[12:15] offset:9216
	ds_write_b128 v2, v[16:19] offset:10240
	ds_write_b128 v2, v[20:23] offset:11264
	ds_write_b128 v2, v[24:27] offset:12288
	ds_write_b128 v2, v[28:31] offset:13312
	ds_write_b128 v2, v[32:35] offset:14336
	ds_write_b128 v2, v[36:39] offset:15360
	v_add_u32 v52, s60, v46
	v_add_u32 v53, s61, v46
	ds_read_b64_tr_b16 v[8:9], v52 offset:16384
	ds_read_b64_tr_b16 v[10:11], v52 offset:16512
	ds_read_b64_tr_b16 v[12:13], v52 offset:20480
	ds_read_b64_tr_b16 v[14:15], v52 offset:20608
	ds_read_b64_tr_b16 v[16:17], v52 offset:16400
	ds_read_b64_tr_b16 v[18:19], v52 offset:16528
	ds_read_b64_tr_b16 v[20:21], v52 offset:20496
	ds_read_b64_tr_b16 v[22:23], v52 offset:20624
	ds_read_b64_tr_b16 v[24:25], v53 offset:16384
	ds_read_b64_tr_b16 v[26:27], v53 offset:16512
	ds_read_b64_tr_b16 v[28:29], v53 offset:20480
	ds_read_b64_tr_b16 v[30:31], v53 offset:20608
	ds_read_b64_tr_b16 v[32:33], v53 offset:16400
	ds_read_b64_tr_b16 v[34:35], v53 offset:16528
	ds_read_b64_tr_b16 v[36:37], v53 offset:20496
	ds_read_b64_tr_b16 v[38:39], v53 offset:20624
	s_waitcnt vmcnt(12)
	s_waitcnt lgkmcnt(0)
	s_barrier
	ds_write_b128 v2, v[8:11] offset:16384
	ds_write_b128 v2, v[12:15] offset:17408
	ds_write_b128 v2, v[16:19] offset:18432
	ds_write_b128 v2, v[20:23] offset:19456
	ds_write_b128 v2, v[24:27] offset:20480
	ds_write_b128 v2, v[28:31] offset:21504
	ds_write_b128 v2, v[32:35] offset:22528
	ds_write_b128 v2, v[36:39] offset:23552
	v_add_u32 v52, s60, v48
	v_xor_b32 v53, 32, v52
	ds_read_b64_tr_b16 v[8:9], v52 offset:24576
	ds_read_b64_tr_b16 v[10:11], v52 offset:24832
	ds_read_b64_tr_b16 v[12:13], v52 offset:25600
	ds_read_b64_tr_b16 v[14:15], v52 offset:25856
	ds_read_b64_tr_b16 v[16:17], v53 offset:24576
	ds_read_b64_tr_b16 v[18:19], v53 offset:24832
	ds_read_b64_tr_b16 v[20:21], v53 offset:25600
	ds_read_b64_tr_b16 v[22:23], v53 offset:25856
	s_waitcnt vmcnt(8)
	s_waitcnt lgkmcnt(0)
	s_barrier
	ds_write_b128 v2, v[8:11] offset:24576
	ds_write_b128 v2, v[12:15] offset:25600
	ds_write_b128 v2, v[16:19] offset:26624
	ds_write_b128 v2, v[20:23] offset:27648
	v_add_u32 v52, s60, v48
	v_xor_b32 v53, 32, v52
	ds_read_b64_tr_b16 v[8:9], v52 offset:28672
	ds_read_b64_tr_b16 v[10:11], v52 offset:28928
	ds_read_b64_tr_b16 v[12:13], v52 offset:29696
	ds_read_b64_tr_b16 v[14:15], v52 offset:29952
	ds_read_b64_tr_b16 v[16:17], v53 offset:28672
	ds_read_b64_tr_b16 v[18:19], v53 offset:28928
	ds_read_b64_tr_b16 v[20:21], v53 offset:29696
	ds_read_b64_tr_b16 v[22:23], v53 offset:29952
	s_waitcnt vmcnt(4)
	s_waitcnt lgkmcnt(0)
	s_barrier
	ds_write_b128 v2, v[8:11] offset:28672
	ds_write_b128 v2, v[12:15] offset:29696
	ds_write_b128 v2, v[16:19] offset:30720
	ds_write_b128 v2, v[20:23] offset:31744
	v_mov_b32 v52, v49
	v_add_u32 v53, 78848, v52
	ds_read_b64_tr_b16 v[8:9], v52 offset:32768
	ds_read_b64_tr_b16 v[10:11], v52 offset:33024
	ds_read_b64_tr_b16 v[12:13], v52 offset:33792
	ds_read_b64_tr_b16 v[14:15], v52 offset:34048
	ds_read_b64_tr_b16 v[16:17], v53 offset:32768
	ds_read_b64_tr_b16 v[18:19], v53 offset:33024
	ds_read_b64_tr_b16 v[20:21], v53 offset:33792
	ds_read_b64_tr_b16 v[22:23], v53 offset:34048
	s_waitcnt lgkmcnt(0)
	s_barrier
	ds_write_b128 v2, v[8:11] offset:32768
	ds_write_b128 v2, v[12:15] offset:33792
	ds_write_b128 v2, v[16:19] offset:34816
	ds_write_b128 v2, v[20:23] offset:35840
	v_mov_b32 v6, s95
	s_mov_b64 exec, 1
	ds_write_b32 v2, v6 offset:37120
	s_mov_b64 exec, -1
	s_lshl_b32 s44, s26, 8
	v_lshrrev_b32 v6, 2, v0
	v_add_u32 v6, s44, v6
	s_add_u32 s29, s29, 524288
	s_waitcnt vmcnt(0) lgkmcnt(0)
	s_branch chain_both
chain_wide:
	s_add_u32 s44, s66, 2097152
	s_add_u32 m0, s60, 0
	s_nop 0
	buffer_load_dwordx4 v40, s[8:11], s44 offen nt lds
	s_add_u32 s44, s66, 2162688
	s_add_u32 m0, s60, 1024
	s_nop 0
	buffer_load_dwordx4 v40, s[8:11], s44 offen nt lds
	s_add_u32 s44, s66, 2228224
	s_add_u32 m0, s60, 2048
	s_nop 0
	buffer_load_dwordx4 v41, s[8:11], s44 offen nt lds
	s_add_u32 s44, s66, 2293760
	s_add_u32 m0, s60, 3072
	s_nop 0
	buffer_load_dwordx4 v41, s[8:11], s44 offen nt lds
	s_add_u32 s44, s66, 3145728
	s_add_u32 m0, s60, 4096
	s_nop 0
	buffer_load_dwordx4 v40, s[8:11], s44 offen nt lds
	s_add_u32 s44, s66, 3211264
	s_add_u32 m0, s60, 5120
	s_nop 0
	buffer_load_dwordx4 v40, s[8:11], s44 offen nt lds
	s_add_u32 s44, s66, 3276800
	s_add_u32 m0, s60, 6144
	s_nop 0
	buffer_load_dwordx4 v41, s[8:11], s44 offen nt lds
	s_add_u32 s44, s66, 3342336
	s_add_u32 m0, s60, 7168
	s_nop 0
	buffer_load_dwordx4 v41, s[8:11], s44 offen nt lds
	s_add_u32 s44, s67, 2097152
	s_add_u32 m0, s60, 8192
	s_nop 0
	buffer_load_dwordx4 v40, s[8:11], s44 offen nt lds
	s_add_u32 s44, s67, 2162688
	s_add_u32 m0, s60, 9216
	s_nop 0
	buffer_load_dwordx4 v40, s[8:11], s44 offen nt lds
	s_add_u32 s44, s67, 2228224
	s_add_u32 m0, s60, 10240
	s_nop 0
	buffer_load_dwordx4 v41, s[8:11], s44 offen nt lds
	s_add_u32 s44, s67, 2293760
	s_add_u32 m0, s60, 11264
	s_nop 0
	buffer_load_dwordx4 v41, s[8:11], s44 offen nt lds
	s_add_u32 s44, s67, 3145728
	s_add_u32 m0, s60, 12288
	s_nop 0
	buffer_load_dwordx4 v40, s[8:11], s44 offen nt lds
	s_add_u32 s44, s67, 3211264
	s_add_u32 m0, s60, 13312
	s_nop 0
	buffer_load_dwordx4 v40, s[8:11], s44 offen nt lds
	s_add_u32 s44, s67, 3276800
	s_add_u32 m0, s60, 14336
	s_nop 0
	buffer_load_dwordx4 v41, s[8:11], s44 offen nt lds
	s_add_u32 s44, s67, 3342336
	s_add_u32 m0, s60, 15360
	s_nop 0
	buffer_load_dwordx4 v41, s[8:11], s44 offen nt lds
	s_add_u32 s44, s66, 2097152
	s_add_u32 m0, s60, 16384
	s_nop 0
	buffer_load_dwordx4 v40, s[12:15], s44 offen nt lds
	s_add_u32 s44, s66, 2162688
	s_add_u32 m0, s60, 17408
	s_nop 0
	buffer_load_dwordx4 v40, s[12:15], s44 offen nt lds
	s_add_u32 s44, s66, 2228224
	s_add_u32 m0, s60, 18432
	s_nop 0
	buffer_load_dwordx4 v41, s[12:15], s44 offen nt lds
	s_add_u32 s44, s66, 2293760
	s_add_u32 m0, s60, 19456
	s_nop 0
	buffer_load_dwordx4 v41, s[12:15], s44 offen nt lds
	s_add_u32 s44, s66, 3145728
	s_add_u32 m0, s60, 20480
	s_nop 0
	buffer_load_dwordx4 v40, s[12:15], s44 offen nt lds
	s_add_u32 s44, s66, 3211264
	s_add_u32 m0, s60, 21504
	s_nop 0
	buffer_load_dwordx4 v40, s[12:15], s44 offen nt lds
	s_add_u32 s44, s66, 3276800
	s_add_u32 m0, s60, 22528
	s_nop 0
	buffer_load_dwordx4 v41, s[12:15], s44 offen nt lds
	s_add_u32 s44, s66, 3342336
	s_add_u32 m0, s60, 23552
	s_nop 0
	buffer_load_dwordx4 v41, s[12:15], s44 offen nt lds
	s_add_u32 s44, s67, 2097152
	s_add_u32 m0, s60, 24576
	s_nop 0
	buffer_load_dwordx4 v40, s[12:15], s44 offen nt lds
	s_add_u32 s44, s67, 2162688
	s_add_u32 m0, s60, 25600
	s_nop 0
	buffer_load_dwordx4 v40, s[12:15], s44 offen nt lds
	s_add_u32 s44, s67, 2228224
	s_add_u32 m0, s60, 26624
	s_nop 0
	buffer_load_dwordx4 v41, s[12:15], s44 offen nt lds
	s_add_u32 s44, s67, 2293760
	s_add_u32 m0, s60, 27648
	s_nop 0
	buffer_load_dwordx4 v41, s[12:15], s44 offen nt lds
	s_add_u32 s44, s67, 3145728
	s_add_u32 m0, s60, 28672
	s_nop 0
	buffer_load_dwordx4 v40, s[12:15], s44 offen nt lds
	s_add_u32 s44, s67, 3211264
	s_add_u32 m0, s60, 29696
	s_nop 0
	buffer_load_dwordx4 v40, s[12:15], s44 offen nt lds
	s_add_u32 s44, s67, 3276800
	s_add_u32 m0, s60, 30720
	s_nop 0
	buffer_load_dwordx4 v41, s[12:15], s44 offen nt lds
	s_add_u32 s44, s67, 3342336
	s_add_u32 m0, s60, 31744
	s_nop 0
	buffer_load_dwordx4 v41, s[12:15], s44 offen nt lds
	s_add_u32 s44, s68, 0
	s_add_u32 m0, s60, 32768
	s_nop 0
	buffer_load_dwordx4 v40, s[8:11], s44 offen nt lds
	s_add_u32 s44, s68, 65536
	s_add_u32 m0, s60, 33792
	s_nop 0
	buffer_load_dwordx4 v41, s[8:11], s44 offen nt lds
	s_add_u32 s44, s68, 131072
	s_add_u32 m0, s60, 34816
	s_nop 0
	buffer_load_dwordx4 v40, s[8:11], s44 offen nt lds
	s_add_u32 s44, s68, 196608
	s_add_u32 m0, s60, 35840
	s_nop 0
	buffer_load_dwordx4 v41, s[8:11], s44 offen nt lds
	s_movk_i32 s28, 0
	s_movk_i32 s59, 0
	s_movk_i32 s41, 0
	s_mov_b32 s33, 0x3000000
	s_bfe_u32 s45, s27, 0x20003
	s_mul_i32 s45, s45, 2560
	s_add_u32 s33, s33, s45
	s_bfe_u32 s45, s26, 0x10001
	s_mul_i32 s45, s45, 1024
	s_add_u32 s33, s33, s45
	s_bfe_u32 s45, s27, 0x30000
	s_mul_i32 s45, s45, 128
	s_add_u32 s33, s33, s45
	s_mov_b32 s34, 0x3000800
	s_bfe_u32 s45, s27, 0x20002
	s_mul_i32 s45, s45, 2560
	s_add_u32 s34, s34, s45
	s_bfe_u32 s45, s27, 0x20000
	s_mul_i32 s45, s45, 128
	s_add_u32 s34, s34, s45
	s_mov_b32 s32, 0x3000000
	s_bfe_u32 s45, s27, 0x50000
	s_mul_i32 s45, s45, 10368
	s_add_u32 s32, s32, s45
	s_bfe_u32 s45, s26, 0x20000
	s_mul_i32 s45, s45, 2560
	s_add_u32 s32, s32, s45
	s_mov_b32 s35, 0x3102000
	s_bfe_u32 s45, s27, 0x20002
	s_mul_i32 s45, s45, 256
	s_add_u32 s35, s35, s45
	s_bfe_u32 s45, s27, 0x10001
	s_mul_i32 s45, s45, 128
	s_add_u32 s35, s35, s45
	s_bfe_u32 s45, s27, 0x10000
	s_mul_i32 s45, s45, 8
	s_add_u32 s35, s35, s45
	s_mov_b32 s78, 0x400
	s_bfe_u32 s45, s27, 0x20002
	s_mul_i32 s45, s45, 32
	s_add_u32 s78, s78, s45
	s_bfe_u32 s45, s27, 0x20000
	s_mul_i32 s45, s45, 8
	s_add_u32 s78, s78, s45
	s_mov_b32 s94, 0x3100000
	s_bfe_u32 s45, s26, 0x20000
	s_mul_i32 s45, s45, 1024
	s_add_u32 s94, s94, s45
	s_mov_b32 s56, 0x3102000
	s_bfe_u32 s45, s27, 0x20000
	s_mul_i32 s45, s45, 1024
	s_add_u32 s56, s56, s45
	s_mov_b32 s92, 0x3100000
	s_bfe_u32 s45, s27, 0x10003
	s_mul_i32 s45, s45, 2048
	s_add_u32 s92, s92, s45
	s_bfe_u32 s45, s27, 0x10002
	s_mul_i32 s45, s45, 1024
	s_add_u32 s92, s92, s45
	s_bfe_u32 s45, s26, 0x10001
	s_mul_i32 s45, s45, 4096
	s_add_u32 s92, s92, s45
	s_bfe_u32 s45, s27, 0x10001
	s_mul_i32 s45, s45, 64
	s_add_u32 s92, s92, s45
	s_bfe_u32 s45, s27, 0x10004
	s_mul_i32 s45, s45, 512
	s_add_u32 s92, s92, s45
	s_bfe_u32 s45, s27, 0x10000
	s_mul_i32 s45, s45, 256
	s_add_u32 s92, s92, s45
	s_mov_b32 s79, 0x0
	s_bfe_u32 s45, s26, 0x10001
	s_mul_i32 s45, s45, 512
	s_add_u32 s79, s79, s45
	s_bfe_u32 s45, s27, 0x20003
	s_mul_i32 s45, s45, 128
	s_add_u32 s79, s79, s45
	s_bfe_u32 s45, s27, 0x10002
	s_mul_i32 s45, s45, 64
	s_add_u32 s79, s79, s45
	s_bfe_u32 s45, s27, 0x10000
	s_mul_i32 s45, s45, 16
	s_add_u32 s79, s79, s45
	s_bfe_u32 s45, s27, 0x10001
	s_mul_i32 s45, s45, 4608
	s_add_u32 s79, s79, s45
	s_cmp_eq_u32 s26, 1
	s_cselect_b32 s33, s34, s33
	s_cselect_b32 s92, s35, s92
	s_cselect_b32 s44, s27, 0
	s_cmp_gt_u32 s44, 15
	s_cselect_b32 s93, 3, s26
	s_add_u32 s34, s33, 82944
	s_add_u32 s35, s33, 165888
	s_add_u32 s38, s33, 248832
	s_mov_b32 s36, 0x1000
	s_bfe_u32 s45, s26, 0x20000
	s_mul_i32 s45, s45, 256
	s_add_u32 s36, s36, s45
	s_mov_b32 s39, s94
	s_mov_b32 s40, s56
	s_add_u32 s57, s94, 3072
	s_waitcnt vmcnt(40)
	buffer_load_ushort v28, v19, s[80:83], s79 offen
	buffer_load_ushort v30, v19, s[80:83], s79 offen offset:32
	buffer_load_dword v29, v19, s[80:83], s78 offen
	s_lshl_b32 s29, s27, 14
	s_lshl_b32 s44, s26, 12
	s_add_u32 s29, s29, s44
	s_lshl_b32 s30, s27, 13
	s_lshl_b32 s44, s26, 11
	s_add_u32 s30, s30, s44
	s_add_u32 s30, s30, 0x2000000
	s_add_u32 s58, s60, 4096
	s_add_u32 s97, s60, 36864
	s_add_u32 s31, s60, 2048
	s_mov_b32 s42, 0x80000
	s_mov_b32 s43, 0x3e0293ee
	s_lshl_b32 s44, s27, 7
	s_lshl_b32 s45, s26, 2
	s_add_u32 s44, s44, s45
	s_add_u32 s96, s44, 0x3301f00
	s_mov_b32 s98, 0x3f803f80
	s_mov_b32 s100, 0x3f003f00
	s_mov_b32 s99, 0x3f803f80
	s_mov_b32 s101, 0x3f003f00
	s_waitcnt vmcnt(41)
	v_mov_b32 v1, v12
	v_mov_b32 v2, v13
	v_mov_b32 v3, v14
	v_mov_b32 v4, v15
	v_mov_b32 v5, v16
	v_mov_b32 v6, v17
	s_cmp_eq_u32 s93, 3
	s_cselect_b32 s44, 0x80000000, 0
	v_or_b32 v18, s44, v18
	v_or_b32 v25, s44, v25
	ds_write_b32 v6, v18 offset:5120
	s_lshl_b32 s44, s26, 10
	v_add_u32 v8, s44, v0
	s_waitcnt vmcnt(39)
	ds_write_b128 v8, v[20:23]
	v_mov_b64 v[32:33], -1
	v_mov_b64 v[34:35], -1
	s_add_u32 s44, s33, 0x0
	buffer_store_dwordx4 v[32:35], v25, s[4:7], s44 offen sc1
	s_add_u32 s44, s34, 0x0
	buffer_store_dwordx4 v[32:35], v25, s[4:7], s44 offen sc1
	s_add_u32 s44, s35, 0x0
	buffer_store_dwordx4 v[32:35], v25, s[4:7], s44 offen sc1
	s_add_u32 s44, s38, 0x0
	buffer_store_dwordx4 v[32:35], v25, s[4:7], s44 offen sc1
	s_add_u32 s44, s33, 0x80000
	buffer_store_dwordx4 v[32:35], v25, s[4:7], s44 offen sc1
	s_add_u32 s44, s34, 0x80000
	buffer_store_dwordx4 v[32:35], v25, s[4:7], s44 offen sc1
	s_add_u32 s44, s35, 0x80000
	buffer_store_dwordx4 v[32:35], v25, s[4:7], s44 offen sc1
	s_add_u32 s44, s38, 0x80000
	buffer_store_dwordx4 v[32:35], v25, s[4:7], s44 offen sc1
	s_add_u32 s44, s92, 0x4000
	buffer_store_dword v32, v18, s[4:7], s44 offen sc1
	s_add_u32 s44, s92, 0x8000
	buffer_store_dword v32, v18, s[4:7], s44 offen sc1
	s_add_u32 s44, s92, 0xc000
	buffer_store_dword v32, v18, s[4:7], s44 offen sc1
	s_waitcnt vmcnt(12)
	v_lshl_or_b32 v28, v30, 16, v28
	s_cmp_eq_u32 s26, 1
	s_cselect_b64 vcc, -1, 0
	s_waitcnt vmcnt(11)
	v_cndmask_b32 v28, v28, v29, vcc
	buffer_store_dword v28, v18, s[4:7], s92 offen sc1
	s_waitcnt lgkmcnt(0)
	s_barrier
	v_add_u32 v52, s60, v46
	v_add_u32 v53, s61, v46
	ds_read_b64_tr_b16 v[56:57], v52 offset:0
	ds_read_b64_tr_b16 v[58:59], v52 offset:128
	ds_read_b64_tr_b16 v[60:61], v52 offset:4096
	ds_read_b64_tr_b16 v[62:63], v52 offset:4224
	ds_read_b64_tr_b16 v[64:65], v52 offset:16
	ds_read_b64_tr_b16 v[66:67], v52 offset:144
	ds_read_b64_tr_b16 v[68:69], v52 offset:4112
	ds_read_b64_tr_b16 v[70:71], v52 offset:4240
	ds_read_b64_tr_b16 v[72:73], v53 offset:0
	ds_read_b64_tr_b16 v[74:75], v53 offset:128
	ds_read_b64_tr_b16 v[76:77], v53 offset:4096
	ds_read_b64_tr_b16 v[78:79], v53 offset:4224
	ds_read_b64_tr_b16 v[80:81], v53 offset:16
	ds_read_b64_tr_b16 v[82:83], v53 offset:144
	ds_read_b64_tr_b16 v[84:85], v53 offset:4112
	ds_read_b64_tr_b16 v[86:87], v53 offset:4240
	s_waitcnt lgkmcnt(0)
	s_barrier
	s_add_u32 s44, s67, 0
	s_add_u32 m0, s60, 0
	s_nop 0
	buffer_load_dwordx4 v40, s[12:15], s44 offen nt lds
	s_add_u32 s44, s67, 65536
	s_add_u32 m0, s60, 1024
	s_nop 0
	buffer_load_dwordx4 v40, s[12:15], s44 offen nt lds
	s_add_u32 s44, s67, 131072
	s_add_u32 m0, s60, 2048
	s_nop 0
	buffer_load_dwordx4 v41, s[12:15], s44 offen nt lds
	s_add_u32 s44, s67, 196608
	s_add_u32 m0, s60, 3072
	s_nop 0
	buffer_load_dwordx4 v41, s[12:15], s44 offen nt lds
	s_add_u32 s44, s67, 1048576
	s_add_u32 m0, s60, 4096
	s_nop 0
	buffer_load_dwordx4 v40, s[12:15], s44 offen nt lds
	s_add_u32 s44, s67, 1114112
	s_add_u32 m0, s60, 5120
	s_nop 0
	buffer_load_dwordx4 v40, s[12:15], s44 offen nt lds
	s_add_u32 s44, s67, 1179648
	s_add_u32 m0, s60, 6144
	s_nop 0
	buffer_load_dwordx4 v41, s[12:15], s44 offen nt lds
	s_add_u32 s44, s67, 1245184
	s_add_u32 m0, s60, 7168
	s_nop 0
	buffer_load_dwordx4 v41, s[12:15], s44 offen nt lds
	v_add_u32 v52, s60, v46
	v_add_u32 v53, s61, v46
	ds_read_b64_tr_b16 v[88:89], v52 offset:8192
	ds_read_b64_tr_b16 v[90:91], v52 offset:8320
	ds_read_b64_tr_b16 v[92:93], v52 offset:12288
	ds_read_b64_tr_b16 v[94:95], v52 offset:12416
	ds_read_b64_tr_b16 v[96:97], v52 offset:8208
	ds_read_b64_tr_b16 v[98:99], v52 offset:8336
	ds_read_b64_tr_b16 v[100:101], v52 offset:12304
	ds_read_b64_tr_b16 v[102:103], v52 offset:12432
	ds_read_b64_tr_b16 v[104:105], v53 offset:8192
	ds_read_b64_tr_b16 v[106:107], v53 offset:8320
	ds_read_b64_tr_b16 v[108:109], v53 offset:12288
	ds_read_b64_tr_b16 v[110:111], v53 offset:12416
	ds_read_b64_tr_b16 v[112:113], v53 offset:8208
	ds_read_b64_tr_b16 v[114:115], v53 offset:8336
	ds_read_b64_tr_b16 v[116:117], v53 offset:12304
	ds_read_b64_tr_b16 v[118:119], v53 offset:12432
	s_waitcnt lgkmcnt(0)
	s_barrier
	s_add_u32 s44, s71, 0
	s_add_u32 m0, s60, 8192
	s_nop 0
	buffer_load_dwordx4 v42, s[20:23], s44 offen nt lds
	s_add_u32 s44, s71, 9216
	s_add_u32 m0, s60, 9216
	s_nop 0
	buffer_load_dwordx4 v42, s[20:23], s44 offen nt lds
	s_add_u32 s44, s71, 18432
	s_add_u32 m0, s60, 10240
	s_nop 0
	buffer_load_dwordx4 v43, s[20:23], s44 offen nt lds
	s_add_u32 s44, s71, 27648
	s_add_u32 m0, s60, 11264
	s_nop 0
	buffer_load_dwordx4 v43, s[20:23], s44 offen nt lds
	s_add_u32 s44, s66, 0
	s_add_u32 m0, s60, 12288
	s_nop 0
	buffer_load_dwordx4 v40, s[16:19], s44 offen nt lds
	s_add_u32 s44, s66, 65536
	s_add_u32 m0, s60, 13312
	s_nop 0
	buffer_load_dwordx4 v40, s[16:19], s44 offen nt lds
	s_add_u32 s44, s66, 131072
	s_add_u32 m0, s60, 14336
	s_nop 0
	buffer_load_dwordx4 v41, s[16:19], s44 offen nt lds
	s_add_u32 s44, s66, 196608
	s_add_u32 m0, s60, 15360
	s_nop 0
	buffer_load_dwordx4 v41, s[16:19], s44 offen nt lds
	v_add_u32 v52, s60, v46
	v_add_u32 v53, s61, v46
	ds_read_b64_tr_b16 v[144:145], v52 offset:16384
	ds_read_b64_tr_b16 v[146:147], v52 offset:16512
	ds_read_b64_tr_b16 v[148:149], v52 offset:20480
	ds_read_b64_tr_b16 v[150:151], v52 offset:20608
	ds_read_b64_tr_b16 v[152:153], v52 offset:16400
	ds_read_b64_tr_b16 v[154:155], v52 offset:16528
	ds_read_b64_tr_b16 v[156:157], v52 offset:20496
	ds_read_b64_tr_b16 v[158:159], v52 offset:20624
	ds_read_b64_tr_b16 v[176:177], v53 offset:16384
	ds_read_b64_tr_b16 v[178:179], v53 offset:16512
	ds_read_b64_tr_b16 v[180:181], v53 offset:20480
	ds_read_b64_tr_b16 v[182:183], v53 offset:20608
	ds_read_b64_tr_b16 v[184:185], v53 offset:16400
	ds_read_b64_tr_b16 v[186:187], v53 offset:16528
	ds_read_b64_tr_b16 v[188:189], v53 offset:20496
	ds_read_b64_tr_b16 v[190:191], v53 offset:20624
	s_waitcnt lgkmcnt(0)
	s_barrier
	s_add_u32 s44, s66, 1048576
	s_add_u32 m0, s60, 16384
	s_nop 0
	buffer_load_dwordx4 v40, s[16:19], s44 offen nt lds
	s_add_u32 s44, s66, 1114112
	s_add_u32 m0, s60, 17408
	s_nop 0
	buffer_load_dwordx4 v40, s[16:19], s44 offen nt lds
	s_add_u32 s44, s66, 1179648
	s_add_u32 m0, s60, 18432
	s_nop 0
	buffer_load_dwordx4 v41, s[16:19], s44 offen nt lds
	s_add_u32 s44, s66, 1245184
	s_add_u32 m0, s60, 19456
	s_nop 0
	buffer_load_dwordx4 v41, s[16:19], s44 offen nt lds
	s_add_u32 s44, s72, 0
	s_add_u32 m0, s60, 20480
	s_nop 0
	buffer_load_dwordx4 v42, s[20:23], s44 offen nt lds
	s_add_u32 s44, s72, 9216
	s_add_u32 m0, s60, 21504
	s_nop 0
	buffer_load_dwordx4 v42, s[20:23], s44 offen nt lds
	s_add_u32 s44, s72, 18432
	s_add_u32 m0, s60, 22528
	s_nop 0
	buffer_load_dwordx4 v43, s[20:23], s44 offen nt lds
	s_add_u32 s44, s72, 27648
	s_add_u32 m0, s60, 23552
	s_nop 0
	buffer_load_dwordx4 v43, s[20:23], s44 offen nt lds
	v_mov_b32 v7, 0
	global_load_dword v6, v7, s[24:25] offset:8 sc1
	v_add_u32 v52, s60, v46
	v_add_u32 v53, s61, v46
	ds_read_b64_tr_b16 v[208:209], v52 offset:24576
	ds_read_b64_tr_b16 v[210:211], v52 offset:24704
	ds_read_b64_tr_b16 v[212:213], v52 offset:28672
	ds_read_b64_tr_b16 v[214:215], v52 offset:28800
	ds_read_b64_tr_b16 v[216:217], v52 offset:24592
	ds_read_b64_tr_b16 v[218:219], v52 offset:24720
	ds_read_b64_tr_b16 v[220:221], v52 offset:28688
	ds_read_b64_tr_b16 v[222:223], v52 offset:28816
	ds_read_b64_tr_b16 v[240:241], v53 offset:24576
	ds_read_b64_tr_b16 v[242:243], v53 offset:24704
	ds_read_b64_tr_b16 v[244:245], v53 offset:28672
	ds_read_b64_tr_b16 v[246:247], v53 offset:28800
	ds_read_b64_tr_b16 v[248:249], v53 offset:24592
	ds_read_b64_tr_b16 v[250:251], v53 offset:24720
	ds_read_b64_tr_b16 v[252:253], v53 offset:28688
	ds_read_b64_tr_b16 v[254:255], v53 offset:28816
	s_waitcnt lgkmcnt(0)
	s_barrier
	s_add_u32 s44, s67, 0
	s_add_u32 m0, s60, 24576
	s_nop 0
	buffer_load_dwordx4 v40, s[16:19], s44 offen nt lds
	s_add_u32 s44, s67, 65536
	s_add_u32 m0, s60, 25600
	s_nop 0
	buffer_load_dwordx4 v40, s[16:19], s44 offen nt lds
	s_add_u32 s44, s67, 131072
	s_add_u32 m0, s60, 26624
	s_nop 0
	buffer_load_dwordx4 v41, s[16:19], s44 offen nt lds
	s_add_u32 s44, s67, 196608
	s_add_u32 m0, s60, 27648
	s_nop 0
	buffer_load_dwordx4 v41, s[16:19], s44 offen nt lds
	s_add_u32 s44, s67, 1048576
	s_add_u32 m0, s60, 28672
	s_nop 0
	buffer_load_dwordx4 v40, s[16:19], s44 offen nt lds
	s_add_u32 s44, s67, 1114112
	s_add_u32 m0, s60, 29696
	s_nop 0
	buffer_load_dwordx4 v40, s[16:19], s44 offen nt lds
	s_add_u32 s44, s67, 1179648
	s_add_u32 m0, s60, 30720
	s_nop 0
	buffer_load_dwordx4 v41, s[16:19], s44 offen nt lds
	s_add_u32 s44, s67, 1245184
	s_add_u32 m0, s60, 31744
	s_nop 0
	buffer_load_dwordx4 v41, s[16:19], s44 offen nt lds
	v_add_u32 v52, s62, v50
	v_add_u32 v53, s63, v50
	ds_read_b64_tr_b16 v[120:121], v52 offset:32768
	ds_read_b64_tr_b16 v[122:123], v52 offset:33024
	ds_read_b64_tr_b16 v[124:125], v53 offset:32768
	ds_read_b64_tr_b16 v[126:127], v53 offset:33024
	ds_read_b64_tr_b16 v[128:129], v52 offset:32784
	ds_read_b64_tr_b16 v[130:131], v52 offset:33040
	ds_read_b64_tr_b16 v[132:133], v53 offset:32784
	ds_read_b64_tr_b16 v[134:135], v53 offset:33040
	s_waitcnt vmcnt(25)
	s_waitcnt lgkmcnt(0)
	s_barrier
	s_add_u32 s44, s68, 0
	s_add_u32 m0, s60, 32768
	s_nop 0
	buffer_load_dwordx4 v40, s[12:15], s44 offen nt lds
	s_add_u32 s44, s68, 65536
	s_add_u32 m0, s60, 33792
	s_nop 0
	buffer_load_dwordx4 v41, s[12:15], s44 offen nt lds
	s_add_u32 s44, s68, 131072
	s_add_u32 m0, s60, 34816
	s_nop 0
	buffer_load_dwordx4 v40, s[12:15], s44 offen nt lds
	s_add_u32 s44, s68, 196608
	s_add_u32 m0, s60, 35840
	s_nop 0
	buffer_load_dwordx4 v41, s[12:15], s44 offen nt lds
	v_add_u32 v52, s60, v46
	v_add_u32 v53, s61, v46
	ds_read_b64_tr_b16 v[192:193], v52 offset:0
	ds_read_b64_tr_b16 v[194:195], v52 offset:128
	ds_read_b64_tr_b16 v[196:197], v52 offset:4096
	ds_read_b64_tr_b16 v[198:199], v52 offset:4224
	ds_read_b64_tr_b16 v[200:201], v52 offset:16
	ds_read_b64_tr_b16 v[202:203], v52 offset:144
	ds_read_b64_tr_b16 v[204:205], v52 offset:4112
	ds_read_b64_tr_b16 v[206:207], v52 offset:4240
	ds_read_b64_tr_b16 v[224:225], v53 offset:0
	ds_read_b64_tr_b16 v[226:227], v53 offset:128
	ds_read_b64_tr_b16 v[228:229], v53 offset:4096
	ds_read_b64_tr_b16 v[230:231], v53 offset:4224
	ds_read_b64_tr_b16 v[232:233], v53 offset:16
	ds_read_b64_tr_b16 v[234:235], v53 offset:144
	ds_read_b64_tr_b16 v[236:237], v53 offset:4112
	ds_read_b64_tr_b16 v[238:239], v53 offset:4240
	s_waitcnt vmcnt(25)
	s_waitcnt lgkmcnt(0)
	s_barrier
	s_cmp_lg_u32 s26, 0
	s_cbranch_scc1 chain_nosigw
	s_getreg_b32 s44, hwreg(HW_REG_XCC_ID)
	s_and_b32 s44, s44, 15
	s_mul_i32 s45, s44, s44
	s_lshl_b32 s45, s45, 16
	s_lshl_b32 s44, s44, 6
	s_add_u32 s44, s44, s45
	s_add_u32 s44, s44, 1
	s_mov_b64 exec, 1
	v_mov_b32 v8, s44
	v_mov_b32 v9, 0
	global_atomic_add v9, v8, s[24:25] sc1
	s_mov_b64 exec, -1
chain_nosigw:
	s_add_u32 s44, s66, 2097152
	s_add_u32 m0, s60, 0
	s_nop 0
	buffer_load_dwordx4 v40, s[16:19], s44 offen nt lds
	s_add_u32 s44, s66, 2162688
	s_add_u32 m0, s60, 1024
	s_nop 0
	buffer_load_dwordx4 v40, s[16:19], s44 offen nt lds
	s_add_u32 s44, s66, 2228224
	s_add_u32 m0, s60, 2048
	s_nop 0
	buffer_load_dwordx4 v41, s[16:19], s44 offen nt lds
	s_add_u32 s44, s66, 2293760
	s_add_u32 m0, s60, 3072
	s_nop 0
	buffer_load_dwordx4 v41, s[16:19], s44 offen nt lds
	s_add_u32 s44, s66, 3145728
	s_add_u32 m0, s60, 4096
	s_nop 0
	buffer_load_dwordx4 v40, s[16:19], s44 offen nt lds
	s_add_u32 s44, s66, 3211264
	s_add_u32 m0, s60, 5120
	s_nop 0
	buffer_load_dwordx4 v40, s[16:19], s44 offen nt lds
	s_add_u32 s44, s66, 3276800
	s_add_u32 m0, s60, 6144
	s_nop 0
	buffer_load_dwordx4 v41, s[16:19], s44 offen nt lds
	s_add_u32 s44, s66, 3342336
	s_add_u32 m0, s60, 7168
	s_nop 0
	buffer_load_dwordx4 v41, s[16:19], s44 offen nt lds
	v_add_u32 v52, s60, v48
	v_xor_b32 v53, 32, v52
	ds_read_b64_tr_b16 a[160:161], v52 offset:8192
	ds_read_b64_tr_b16 a[162:163], v52 offset:8448
	ds_read_b64_tr_b16 a[164:165], v52 offset:9216
	ds_read_b64_tr_b16 a[166:167], v52 offset:9472
	ds_read_b64_tr_b16 a[184:185], v53 offset:8192
	ds_read_b64_tr_b16 a[186:187], v53 offset:8448
	ds_read_b64_tr_b16 a[188:189], v53 offset:9216
	ds_read_b64_tr_b16 a[190:191], v53 offset:9472
	s_waitcnt vmcnt(25)
	s_waitcnt lgkmcnt(0)
	s_barrier
	s_add_u32 s44, s73, 0
	s_add_u32 m0, s60, 8192
	s_nop 0
	buffer_load_dwordx4 v42, s[20:23], s44 offen nt lds
	s_add_u32 s44, s73, 9216
	s_add_u32 m0, s60, 9216
	s_nop 0
	buffer_load_dwordx4 v42, s[20:23], s44 offen nt lds
	s_add_u32 s44, s73, 18432
	s_add_u32 m0, s60, 10240
	s_nop 0
	buffer_load_dwordx4 v43, s[20:23], s44 offen nt lds
	s_add_u32 s44, s73, 27648
	s_add_u32 m0, s60, 11264
	s_nop 0
	buffer_load_dwordx4 v43, s[20:23], s44 offen nt lds
	v_add_u32 v52, s60, v47
	v_add_u32 v53, s61, v47
	v_xor_b32 v54, 32, v52
	v_xor_b32 v55, 32, v53
	ds_read_b64_tr_b16 a[16:17], v52 offset:12288
	ds_read_b64_tr_b16 a[18:19], v52 offset:12416
	ds_read_b64_tr_b16 a[20:21], v52 offset:16384
	ds_read_b64_tr_b16 a[22:23], v52 offset:16512
	ds_read_b64_tr_b16 a[24:25], v54 offset:12288
	ds_read_b64_tr_b16 a[26:27], v54 offset:12416
	ds_read_b64_tr_b16 a[28:29], v54 offset:16384
	ds_read_b64_tr_b16 a[30:31], v54 offset:16512
	ds_read_b64_tr_b16 a[48:49], v53 offset:12288
	ds_read_b64_tr_b16 a[50:51], v53 offset:12416
	ds_read_b64_tr_b16 a[52:53], v53 offset:16384
	ds_read_b64_tr_b16 a[54:55], v53 offset:16512
	ds_read_b64_tr_b16 a[56:57], v55 offset:12288
	ds_read_b64_tr_b16 a[58:59], v55 offset:12416
	ds_read_b64_tr_b16 a[60:61], v55 offset:16384
	ds_read_b64_tr_b16 a[62:63], v55 offset:16512
	s_waitcnt vmcnt(25)
	s_waitcnt lgkmcnt(0)
	s_barrier
	s_add_u32 s44, s70, 512
	s_add_u32 m0, s60, 12288
	s_nop 0
	buffer_load_dwordx4 v42, s[20:23], s44 offen nt lds
	s_add_u32 s44, s70, 9728
	s_add_u32 m0, s60, 13312
	s_nop 0
	buffer_load_dwordx4 v42, s[20:23], s44 offen nt lds
	s_add_u32 s44, s70, 18944
	s_add_u32 m0, s60, 14336
	s_nop 0
	buffer_load_dwordx4 v43, s[20:23], s44 offen nt lds
	s_add_u32 s44, s70, 28160
	s_add_u32 m0, s60, 15360
	s_nop 0
	buffer_load_dwordx4 v43, s[20:23], s44 offen nt lds
	s_add_u32 s44, s67, 2097152
	s_add_u32 m0, s60, 16384
	s_nop 0
	buffer_load_dwordx4 v40, s[16:19], s44 offen nt lds
	s_add_u32 s44, s67, 2162688
	s_add_u32 m0, s60, 17408
	s_nop 0
	buffer_load_dwordx4 v40, s[16:19], s44 offen nt lds
	s_add_u32 s44, s67, 2228224
	s_add_u32 m0, s60, 18432
	s_nop 0
	buffer_load_dwordx4 v41, s[16:19], s44 offen nt lds
	s_add_u32 s44, s67, 2293760
	s_add_u32 m0, s60, 19456
	s_nop 0
	buffer_load_dwordx4 v41, s[16:19], s44 offen nt lds
	v_add_u32 v52, s60, v48
	v_xor_b32 v53, 32, v52
	ds_read_b64_tr_b16 a[168:169], v52 offset:20480
	ds_read_b64_tr_b16 a[170:171], v52 offset:20736
	ds_read_b64_tr_b16 a[172:173], v52 offset:21504
	ds_read_b64_tr_b16 a[174:175], v52 offset:21760
	ds_read_b64_tr_b16 a[192:193], v53 offset:20480
	ds_read_b64_tr_b16 a[194:195], v53 offset:20736
	ds_read_b64_tr_b16 a[196:197], v53 offset:21504
	ds_read_b64_tr_b16 a[198:199], v53 offset:21760
	s_waitcnt vmcnt(24)
	s_waitcnt lgkmcnt(0)
	s_barrier
	s_add_u32 s44, s67, 3145728
	s_add_u32 m0, s60, 20480
	s_nop 0
	buffer_load_dwordx4 v40, s[16:19], s44 offen nt lds
	s_add_u32 s44, s67, 3211264
	s_add_u32 m0, s60, 21504
	s_nop 0
	buffer_load_dwordx4 v40, s[16:19], s44 offen nt lds
	s_add_u32 s44, s67, 3276800
	s_add_u32 m0, s60, 22528
	s_nop 0
	buffer_load_dwordx4 v41, s[16:19], s44 offen nt lds
	s_add_u32 s44, s67, 3342336
	s_add_u32 m0, s60, 23552
	s_nop 0
	buffer_load_dwordx4 v41, s[16:19], s44 offen nt lds
	v_readfirstlane_b32 s44, v6
	s_cmp_lg_u32 s44, 0
	s_cbranch_scc1 chain_clrw
chain_clrwl:
	global_load_dword v6, v7, s[24:25] offset:8 sc1
	s_sub_u32 s42, s42, 1
	s_cbranch_scc1 chain_end
	s_waitcnt vmcnt(0)
	v_readfirstlane_b32 s44, v6
	s_cmp_lg_u32 s44, 0
	s_cbranch_scc0 chain_clrwl
chain_clrw:
	buffer_load_dword v6, off, s[4:7], s96 offset:256 sc1
	v_add_u32 v52, s60, v47
	v_add_u32 v53, s61, v47
	v_xor_b32 v54, 32, v52
	v_xor_b32 v55, 32, v53
	ds_read_b64_tr_b16 a[80:81], v52 offset:24576
	ds_read_b64_tr_b16 a[82:83], v52 offset:24704
	ds_read_b64_tr_b16 a[84:85], v52 offset:28672
	ds_read_b64_tr_b16 a[86:87], v52 offset:28800
	ds_read_b64_tr_b16 a[88:89], v54 offset:24576
	ds_read_b64_tr_b16 a[90:91], v54 offset:24704
	ds_read_b64_tr_b16 a[92:93], v54 offset:28672
	ds_read_b64_tr_b16 a[94:95], v54 offset:28800
	ds_read_b64_tr_b16 a[112:113], v53 offset:24576
	ds_read_b64_tr_b16 a[114:115], v53 offset:24704
	ds_read_b64_tr_b16 a[116:117], v53 offset:28672
	ds_read_b64_tr_b16 a[118:119], v53 offset:28800
	ds_read_b64_tr_b16 a[120:121], v55 offset:24576
	ds_read_b64_tr_b16 a[122:123], v55 offset:24704
	ds_read_b64_tr_b16 a[124:125], v55 offset:28672
	ds_read_b64_tr_b16 a[126:127], v55 offset:28800
	s_waitcnt vmcnt(25)
	s_waitcnt lgkmcnt(0)
	s_barrier
	s_add_u32 s44, s72, 512
	s_add_u32 m0, s60, 24576
	s_nop 0
	buffer_load_dwordx4 v42, s[20:23], s44 offen nt lds
	s_add_u32 s44, s72, 9728
	s_add_u32 m0, s60, 25600
	s_nop 0
	buffer_load_dwordx4 v42, s[20:23], s44 offen nt lds
	s_add_u32 s44, s72, 18944
	s_add_u32 m0, s60, 26624
	s_nop 0
	buffer_load_dwordx4 v43, s[20:23], s44 offen nt lds
	s_add_u32 s44, s72, 28160
	s_add_u32 m0, s60, 27648
	s_nop 0
	buffer_load_dwordx4 v43, s[20:23], s44 offen nt lds
	s_add_u32 s44, s73, 512
	s_add_u32 m0, s60, 28672
	s_nop 0
	buffer_load_dwordx4 v42, s[20:23], s44 offen nt lds
	s_add_u32 s44, s73, 9728
	s_add_u32 m0, s60, 29696
	s_nop 0
	buffer_load_dwordx4 v42, s[20:23], s44 offen nt lds
	s_add_u32 s44, s73, 18944
	s_add_u32 m0, s60, 30720
	s_nop 0
	buffer_load_dwordx4 v43, s[20:23], s44 offen nt lds
	s_add_u32 s44, s73, 28160
	s_add_u32 m0, s60, 31744
	s_nop 0
	buffer_load_dwordx4 v43, s[20:23], s44 offen nt lds
	v_add_u32 v52, s62, v50
	v_add_u32 v53, s63, v50
	ds_read_b64_tr_b16 a[0:1], v52 offset:32768
	ds_read_b64_tr_b16 a[2:3], v52 offset:33024
	ds_read_b64_tr_b16 a[4:5], v53 offset:32768
	ds_read_b64_tr_b16 a[6:7], v53 offset:33024
	ds_read_b64_tr_b16 a[8:9], v52 offset:32784
	ds_read_b64_tr_b16 a[10:11], v52 offset:33040
	ds_read_b64_tr_b16 a[12:13], v53 offset:32784
	ds_read_b64_tr_b16 a[14:15], v53 offset:33040
	s_waitcnt vmcnt(25)
	s_waitcnt lgkmcnt(0)
	s_barrier
	s_add_u32 s44, s68, 0
	s_add_u32 m0, s60, 32768
	s_nop 0
	buffer_load_dwordx4 v40, s[16:19], s44 offen nt lds
	s_add_u32 s44, s68, 65536
	s_add_u32 m0, s60, 33792
	s_nop 0
	buffer_load_dwordx4 v41, s[16:19], s44 offen nt lds
	s_add_u32 s44, s68, 131072
	s_add_u32 m0, s60, 34816
	s_nop 0
	buffer_load_dwordx4 v40, s[16:19], s44 offen nt lds
	s_add_u32 s44, s68, 196608
	s_add_u32 m0, s60, 35840
	s_nop 0
	buffer_load_dwordx4 v41, s[16:19], s44 offen nt lds
	v_add_u32 v52, s60, v47
	v_add_u32 v53, s61, v47
	v_xor_b32 v54, 32, v52
	v_xor_b32 v55, 32, v53
	ds_read_b64_tr_b16 a[32:33], v52 offset:0
	ds_read_b64_tr_b16 a[34:35], v52 offset:128
	ds_read_b64_tr_b16 a[36:37], v52 offset:4096
	ds_read_b64_tr_b16 a[38:39], v52 offset:4224
	ds_read_b64_tr_b16 a[40:41], v54 offset:0
	ds_read_b64_tr_b16 a[42:43], v54 offset:128
	ds_read_b64_tr_b16 a[44:45], v54 offset:4096
	ds_read_b64_tr_b16 a[46:47], v54 offset:4224
	ds_read_b64_tr_b16 a[64:65], v53 offset:0
	ds_read_b64_tr_b16 a[66:67], v53 offset:128
	ds_read_b64_tr_b16 a[68:69], v53 offset:4096
	ds_read_b64_tr_b16 a[70:71], v53 offset:4224
	ds_read_b64_tr_b16 a[72:73], v55 offset:0
	ds_read_b64_tr_b16 a[74:75], v55 offset:128
	ds_read_b64_tr_b16 a[76:77], v55 offset:4096
	ds_read_b64_tr_b16 a[78:79], v55 offset:4224
	s_waitcnt vmcnt(25)
	s_waitcnt lgkmcnt(0)
	s_barrier
	s_cmp_lg_u32 s26, 0
	s_cbranch_scc1 chain_nosig2w
	s_mov_b64 exec, 1
	v_mov_b32 v52, 1
	v_mov_b32 v53, 0
	global_atomic_add v53, v52, s[24:25] offset:128 sc1
	s_mov_b64 exec, -1
chain_nosig2w:
	s_add_u32 s44, s66, 0
	s_add_u32 m0, s60, 0
	s_nop 0
	buffer_load_dwordx4 v40, s[12:15], s44 offen nt lds
	s_add_u32 s44, s66, 65536
	s_add_u32 m0, s60, 1024
	s_nop 0
	buffer_load_dwordx4 v40, s[12:15], s44 offen nt lds
	s_add_u32 s44, s66, 131072
	s_add_u32 m0, s60, 2048
	s_nop 0
	buffer_load_dwordx4 v41, s[12:15], s44 offen nt lds
	s_add_u32 s44, s66, 196608
	s_add_u32 m0, s60, 3072
	s_nop 0
	buffer_load_dwordx4 v41, s[12:15], s44 offen nt lds
	s_add_u32 s44, s66, 1048576
	s_add_u32 m0, s60, 4096
	s_nop 0
	buffer_load_dwordx4 v40, s[12:15], s44 offen nt lds
	s_add_u32 s44, s66, 1114112
	s_add_u32 m0, s60, 5120
	s_nop 0
	buffer_load_dwordx4 v40, s[12:15], s44 offen nt lds
	s_add_u32 s44, s66, 1179648
	s_add_u32 m0, s60, 6144
	s_nop 0
	buffer_load_dwordx4 v41, s[12:15], s44 offen nt lds
	s_add_u32 s44, s66, 1245184
	s_add_u32 m0, s60, 7168
	s_nop 0
	buffer_load_dwordx4 v41, s[12:15], s44 offen nt lds
	v_add_u32 v52, s60, v48
	v_xor_b32 v53, 32, v52
	ds_read_b64_tr_b16 a[176:177], v52 offset:8192
	ds_read_b64_tr_b16 a[178:179], v52 offset:8448
	ds_read_b64_tr_b16 a[180:181], v52 offset:9216
	ds_read_b64_tr_b16 a[182:183], v52 offset:9472
	ds_read_b64_tr_b16 a[200:201], v53 offset:8192
	ds_read_b64_tr_b16 a[202:203], v53 offset:8448
	ds_read_b64_tr_b16 a[204:205], v53 offset:9216
	ds_read_b64_tr_b16 a[206:207], v53 offset:9472
	s_waitcnt vmcnt(29)
	s_waitcnt lgkmcnt(0)
	s_barrier
	s_add_u32 s44, s66, 0
	s_add_u32 m0, s60, 8192
	s_nop 0
	buffer_load_dwordx4 v40, s[8:11], s44 offen nt lds
	s_add_u32 s44, s66, 65536
	s_add_u32 m0, s60, 9216
	s_nop 0
	buffer_load_dwordx4 v40, s[8:11], s44 offen nt lds
	s_add_u32 s44, s66, 131072
	s_add_u32 m0, s60, 10240
	s_nop 0
	buffer_load_dwordx4 v41, s[8:11], s44 offen nt lds
	s_add_u32 s44, s66, 196608
	s_add_u32 m0, s60, 11264
	s_nop 0
	buffer_load_dwordx4 v41, s[8:11], s44 offen nt lds
	v_add_u32 v52, s60, v48
	v_xor_b32 v53, 32, v52
	ds_read_b64_tr_b16 a[208:209], v52 offset:12288
	ds_read_b64_tr_b16 a[210:211], v52 offset:12544
	ds_read_b64_tr_b16 a[212:213], v52 offset:13312
	ds_read_b64_tr_b16 a[214:215], v52 offset:13568
	ds_read_b64_tr_b16 a[232:233], v53 offset:12288
	ds_read_b64_tr_b16 a[234:235], v53 offset:12544
	ds_read_b64_tr_b16 a[236:237], v53 offset:13312
	ds_read_b64_tr_b16 a[238:239], v53 offset:13568
	s_waitcnt vmcnt(25)
	s_waitcnt lgkmcnt(0)
	s_barrier
	s_add_u32 s44, s66, 1048576
	s_add_u32 m0, s60, 12288
	s_nop 0
	buffer_load_dwordx4 v40, s[8:11], s44 offen nt lds
	s_add_u32 s44, s66, 1114112
	s_add_u32 m0, s60, 13312
	s_nop 0
	buffer_load_dwordx4 v40, s[8:11], s44 offen nt lds
	s_add_u32 s44, s66, 1179648
	s_add_u32 m0, s60, 14336
	s_nop 0
	buffer_load_dwordx4 v41, s[8:11], s44 offen nt lds
	s_add_u32 s44, s66, 1245184
	s_add_u32 m0, s60, 15360
	s_nop 0
	buffer_load_dwordx4 v41, s[8:11], s44 offen nt lds
	v_add_u32 v52, s60, v47
	v_add_u32 v53, s61, v47
	v_xor_b32 v54, 32, v52
	v_xor_b32 v55, 32, v53
	ds_read_b64_tr_b16 a[96:97], v52 offset:16384
	ds_read_b64_tr_b16 a[98:99], v52 offset:16512
	ds_read_b64_tr_b16 a[100:101], v52 offset:20480
	ds_read_b64_tr_b16 a[102:103], v52 offset:20608
	ds_read_b64_tr_b16 a[104:105], v54 offset:16384
	ds_read_b64_tr_b16 a[106:107], v54 offset:16512
	ds_read_b64_tr_b16 a[108:109], v54 offset:20480
	ds_read_b64_tr_b16 a[110:111], v54 offset:20608
	ds_read_b64_tr_b16 a[128:129], v53 offset:16384
	ds_read_b64_tr_b16 a[130:131], v53 offset:16512
	ds_read_b64_tr_b16 a[132:133], v53 offset:20480
	ds_read_b64_tr_b16 a[134:135], v53 offset:20608
	ds_read_b64_tr_b16 a[136:137], v55 offset:16384
	ds_read_b64_tr_b16 a[138:139], v55 offset:16512
	ds_read_b64_tr_b16 a[140:141], v55 offset:20480
	ds_read_b64_tr_b16 a[142:143], v55 offset:20608
	s_waitcnt vmcnt(24)
	s_waitcnt lgkmcnt(0)
	s_barrier
	s_add_u32 s44, s67, 0
	s_add_u32 m0, s60, 16384
	s_nop 0
	buffer_load_dwordx4 v40, s[8:11], s44 offen nt lds
	s_add_u32 s44, s67, 65536
	s_add_u32 m0, s60, 17408
	s_nop 0
	buffer_load_dwordx4 v40, s[8:11], s44 offen nt lds
	s_add_u32 s44, s67, 131072
	s_add_u32 m0, s60, 18432
	s_nop 0
	buffer_load_dwordx4 v41, s[8:11], s44 offen nt lds
	s_add_u32 s44, s67, 196608
	s_add_u32 m0, s60, 19456
	s_nop 0
	buffer_load_dwordx4 v41, s[8:11], s44 offen nt lds
	s_add_u32 s44, s67, 1048576
	s_add_u32 m0, s60, 20480
	s_nop 0
	buffer_load_dwordx4 v40, s[8:11], s44 offen nt lds
	s_add_u32 s44, s67, 1114112
	s_add_u32 m0, s60, 21504
	s_nop 0
	buffer_load_dwordx4 v40, s[8:11], s44 offen nt lds
	s_add_u32 s44, s67, 1179648
	s_add_u32 m0, s60, 22528
	s_nop 0
	buffer_load_dwordx4 v41, s[8:11], s44 offen nt lds
	s_add_u32 s44, s67, 1245184
	s_add_u32 m0, s60, 23552
	s_nop 0
	buffer_load_dwordx4 v41, s[8:11], s44 offen nt lds
	v_add_u32 v52, s60, v48
	v_xor_b32 v53, 32, v52
	ds_read_b64_tr_b16 a[216:217], v52 offset:24576
	ds_read_b64_tr_b16 a[218:219], v52 offset:24832
	ds_read_b64_tr_b16 a[220:221], v52 offset:25600
	ds_read_b64_tr_b16 a[222:223], v52 offset:25856
	ds_read_b64_tr_b16 a[240:241], v53 offset:24576
	ds_read_b64_tr_b16 a[242:243], v53 offset:24832
	ds_read_b64_tr_b16 a[244:245], v53 offset:25600
	ds_read_b64_tr_b16 a[246:247], v53 offset:25856
	s_waitcnt vmcnt(28)
	s_waitcnt lgkmcnt(0)
	s_barrier
	s_add_u32 s44, s70, 0
	s_add_u32 m0, s60, 24576
	s_nop 0
	buffer_load_dwordx4 v42, s[20:23], s44 offen nt lds
	s_add_u32 s44, s70, 9216
	s_add_u32 m0, s60, 25600
	s_nop 0
	buffer_load_dwordx4 v42, s[20:23], s44 offen nt lds
	s_add_u32 s44, s70, 18432
	s_add_u32 m0, s60, 26624
	s_nop 0
	buffer_load_dwordx4 v43, s[20:23], s44 offen nt lds
	s_add_u32 s44, s70, 27648
	s_add_u32 m0, s60, 27648
	s_nop 0
	buffer_load_dwordx4 v43, s[20:23], s44 offen nt lds
	v_add_u32 v52, s60, v48
	v_xor_b32 v53, 32, v52
	ds_read_b64_tr_b16 a[224:225], v52 offset:28672
	ds_read_b64_tr_b16 a[226:227], v52 offset:28928
	ds_read_b64_tr_b16 a[228:229], v52 offset:29696
	ds_read_b64_tr_b16 a[230:231], v52 offset:29952
	ds_read_b64_tr_b16 a[248:249], v53 offset:28672
	ds_read_b64_tr_b16 a[250:251], v53 offset:28928
	ds_read_b64_tr_b16 a[252:253], v53 offset:29696
	ds_read_b64_tr_b16 a[254:255], v53 offset:29952
	s_waitcnt vmcnt(28)
	s_waitcnt lgkmcnt(0)
	s_barrier
	s_add_u32 s44, s71, 512
	s_add_u32 m0, s60, 28672
	s_nop 0
	buffer_load_dwordx4 v42, s[20:23], s44 offen nt lds
	s_add_u32 s44, s71, 9728
	s_add_u32 m0, s60, 29696
	s_nop 0
	buffer_load_dwordx4 v42, s[20:23], s44 offen nt lds
	s_add_u32 s44, s71, 18944
	s_add_u32 m0, s60, 30720
	s_nop 0
	buffer_load_dwordx4 v43, s[20:23], s44 offen nt lds
	s_add_u32 s44, s71, 28160
	s_add_u32 m0, s60, 31744
	s_nop 0
	buffer_load_dwordx4 v43, s[20:23], s44 offen nt lds
	v_add_u32 v52, s62, v51
	v_add_u32 v53, s63, v51
	v_xor_b32 v54, 32, v52
	v_xor_b32 v55, 32, v53
	ds_read_b64_tr_b16 a[144:145], v52 offset:32768
	ds_read_b64_tr_b16 a[146:147], v52 offset:33024
	ds_read_b64_tr_b16 a[148:149], v53 offset:32768
	ds_read_b64_tr_b16 a[150:151], v53 offset:33024
	ds_read_b64_tr_b16 a[152:153], v54 offset:32768
	ds_read_b64_tr_b16 a[154:155], v54 offset:33024
	ds_read_b64_tr_b16 a[156:157], v55 offset:32768
	ds_read_b64_tr_b16 a[158:159], v55 offset:33024
	s_waitcnt vmcnt(24)
	s_waitcnt lgkmcnt(0)
	s_barrier
	s_add_u32 s44, s69, 0
	s_add_u32 m0, s60, 32768
	s_nop 0
	buffer_load_dwordx4 v44, s[20:23], s44 offen nt lds
	s_add_u32 s44, s69, 9216
	s_add_u32 m0, s60, 33792
	s_nop 0
	buffer_load_dwordx4 v44, s[20:23], s44 offen nt lds
	s_add_u32 s44, s69, 18432
	s_add_u32 m0, s60, 34816
	s_nop 0
	buffer_load_dwordx4 v45, s[20:23], s44 offen nt lds
	s_add_u32 s44, s69, 27648
	s_add_u32 m0, s60, 35840
	s_nop 0
	buffer_load_dwordx4 v45, s[20:23], s44 offen nt lds
	v_add_u32 v52, s60, v46
	v_add_u32 v53, s61, v46
	ds_read_b64_tr_b16 v[8:9], v52 offset:0
	ds_read_b64_tr_b16 v[10:11], v52 offset:128
	ds_read_b64_tr_b16 v[12:13], v52 offset:4096
	ds_read_b64_tr_b16 v[14:15], v52 offset:4224
	ds_read_b64_tr_b16 v[136:137], v52 offset:16
	ds_read_b64_tr_b16 v[138:139], v52 offset:144
	ds_read_b64_tr_b16 v[140:141], v52 offset:4112
	ds_read_b64_tr_b16 v[142:143], v52 offset:4240
	ds_read_b64_tr_b16 v[160:161], v53 offset:0
	ds_read_b64_tr_b16 v[162:163], v53 offset:128
	ds_read_b64_tr_b16 v[164:165], v53 offset:4096
	ds_read_b64_tr_b16 v[166:167], v53 offset:4224
	ds_read_b64_tr_b16 v[168:169], v53 offset:16
	ds_read_b64_tr_b16 v[170:171], v53 offset:144
	ds_read_b64_tr_b16 v[172:173], v53 offset:4112
	ds_read_b64_tr_b16 v[174:175], v53 offset:4240
	s_waitcnt vmcnt(20)
	s_waitcnt lgkmcnt(0)
	s_barrier
	ds_write_b128 v2, v[8:11] offset:0
	ds_write_b128 v2, v[12:15] offset:1024
	v_readfirstlane_b32 s95, v6
	s_cmp_lg_u32 s95, 0
	s_cbranch_scc1 chain_kv0w
chain_kv0wl:
	buffer_load_dword v6, off, s[4:7], s96 offset:256 sc1
	s_sub_u32 s42, s42, 1
	s_cbranch_scc1 chain_end
	s_waitcnt vmcnt(0)
	v_readfirstlane_b32 s95, v6
	s_cmp_lg_u32 s95, 0
	s_cbranch_scc0 chain_kv0wl
chain_kv0w:
	s_mov_b32 m0, s58
	s_nop 0
	buffer_load_dwordx4 v0, s[4:7], s29 offen offset:0 sc1 lds
	buffer_load_dwordx4 v0, s[4:7], s29 offen offset:1024 sc1 lds
	buffer_load_dwordx4 v0, s[4:7], s29 offen offset:2048 sc1 lds
	buffer_load_dwordx4 v0, s[4:7], s29 offen offset:3072 sc1 lds
	v_add_u32 v52, s60, v46
	v_add_u32 v53, s61, v46
	ds_read_b64_tr_b16 v[8:9], v52 offset:8192
	ds_read_b64_tr_b16 v[10:11], v52 offset:8320
	ds_read_b64_tr_b16 v[12:13], v52 offset:12288
	ds_read_b64_tr_b16 v[14:15], v52 offset:12416
	ds_read_b64_tr_b16 v[16:17], v52 offset:8208
	ds_read_b64_tr_b16 v[18:19], v52 offset:8336
	ds_read_b64_tr_b16 v[20:21], v52 offset:12304
	ds_read_b64_tr_b16 v[22:23], v52 offset:12432
	ds_read_b64_tr_b16 v[24:25], v53 offset:8192
	ds_read_b64_tr_b16 v[26:27], v53 offset:8320
	ds_read_b64_tr_b16 v[28:29], v53 offset:12288
	ds_read_b64_tr_b16 v[30:31], v53 offset:12416
	ds_read_b64_tr_b16 v[32:33], v53 offset:8208
	ds_read_b64_tr_b16 v[34:35], v53 offset:8336
	ds_read_b64_tr_b16 v[36:37], v53 offset:12304
	ds_read_b64_tr_b16 v[38:39], v53 offset:12432
	s_waitcnt vmcnt(16)
	s_waitcnt lgkmcnt(0)
	s_barrier
	ds_write_b128 v2, v[8:11] offset:8192
	ds_write_b128 v2, v[12:15] offset:9216
	ds_write_b128 v2, v[16:19] offset:10240
	ds_write_b128 v2, v[20:23] offset:11264
	ds_write_b128 v2, v[24:27] offset:12288
	ds_write_b128 v2, v[28:31] offset:13312
	ds_write_b128 v2, v[32:35] offset:14336
	ds_write_b128 v2, v[36:39] offset:15360
	v_add_u32 v52, s60, v46
	v_add_u32 v53, s61, v46
	ds_read_b64_tr_b16 v[8:9], v52 offset:16384
	ds_read_b64_tr_b16 v[10:11], v52 offset:16512
	ds_read_b64_tr_b16 v[12:13], v52 offset:20480
	ds_read_b64_tr_b16 v[14:15], v52 offset:20608
	ds_read_b64_tr_b16 v[16:17], v52 offset:16400
	ds_read_b64_tr_b16 v[18:19], v52 offset:16528
	ds_read_b64_tr_b16 v[20:21], v52 offset:20496
	ds_read_b64_tr_b16 v[22:23], v52 offset:20624
	ds_read_b64_tr_b16 v[24:25], v53 offset:16384
	ds_read_b64_tr_b16 v[26:27], v53 offset:16512
	ds_read_b64_tr_b16 v[28:29], v53 offset:20480
	ds_read_b64_tr_b16 v[30:31], v53 offset:20608
	ds_read_b64_tr_b16 v[32:33], v53 offset:16400
	ds_read_b64_tr_b16 v[34:35], v53 offset:16528
	ds_read_b64_tr_b16 v[36:37], v53 offset:20496
	ds_read_b64_tr_b16 v[38:39], v53 offset:20624
	s_waitcnt vmcnt(12)
	s_waitcnt lgkmcnt(0)
	s_barrier
	ds_write_b128 v2, v[8:11] offset:16384
	ds_write_b128 v2, v[12:15] offset:17408
	ds_write_b128 v2, v[16:19] offset:18432
	ds_write_b128 v2, v[20:23] offset:19456
	ds_write_b128 v2, v[24:27] offset:20480
	ds_write_b128 v2, v[28:31] offset:21504
	ds_write_b128 v2, v[32:35] offset:22528
	ds_write_b128 v2, v[36:39] offset:23552
	v_add_u32 v52, s60, v48
	v_xor_b32 v53, 32, v52
	ds_read_b64_tr_b16 v[8:9], v52 offset:24576
	ds_read_b64_tr_b16 v[10:11], v52 offset:24832
	ds_read_b64_tr_b16 v[12:13], v52 offset:25600
	ds_read_b64_tr_b16 v[14:15], v52 offset:25856
	ds_read_b64_tr_b16 v[16:17], v53 offset:24576
	ds_read_b64_tr_b16 v[18:19], v53 offset:24832
	ds_read_b64_tr_b16 v[20:21], v53 offset:25600
	ds_read_b64_tr_b16 v[22:23], v53 offset:25856
	s_waitcnt vmcnt(8)
	s_waitcnt lgkmcnt(0)
	s_barrier
	ds_write_b128 v2, v[8:11] offset:24576
	ds_write_b128 v2, v[12:15] offset:25600
	ds_write_b128 v2, v[16:19] offset:26624
	ds_write_b128 v2, v[20:23] offset:27648
	v_add_u32 v52, s60, v48
	v_xor_b32 v53, 32, v52
	ds_read_b64_tr_b16 v[8:9], v52 offset:28672
	ds_read_b64_tr_b16 v[10:11], v52 offset:28928
	ds_read_b64_tr_b16 v[12:13], v52 offset:29696
	ds_read_b64_tr_b16 v[14:15], v52 offset:29952
	ds_read_b64_tr_b16 v[16:17], v53 offset:28672
	ds_read_b64_tr_b16 v[18:19], v53 offset:28928
	ds_read_b64_tr_b16 v[20:21], v53 offset:29696
	ds_read_b64_tr_b16 v[22:23], v53 offset:29952
	s_waitcnt vmcnt(4)
	s_waitcnt lgkmcnt(0)
	s_barrier
	ds_write_b128 v2, v[8:11] offset:28672
	ds_write_b128 v2, v[12:15] offset:29696
	ds_write_b128 v2, v[16:19] offset:30720
	ds_write_b128 v2, v[20:23] offset:31744
	v_mov_b32 v52, v49
	v_add_u32 v53, 78848, v52
	ds_read_b64_tr_b16 v[8:9], v52 offset:32768
	ds_read_b64_tr_b16 v[10:11], v52 offset:33024
	ds_read_b64_tr_b16 v[12:13], v52 offset:33792
	ds_read_b64_tr_b16 v[14:15], v52 offset:34048
	ds_read_b64_tr_b16 v[16:17], v53 offset:32768
	ds_read_b64_tr_b16 v[18:19], v53 offset:33024
	ds_read_b64_tr_b16 v[20:21], v53 offset:33792
	ds_read_b64_tr_b16 v[22:23], v53 offset:34048
	s_waitcnt lgkmcnt(0)
	s_barrier
	ds_write_b128 v2, v[8:11] offset:32768
	ds_write_b128 v2, v[12:15] offset:33792
	ds_write_b128 v2, v[16:19] offset:34816
	ds_write_b128 v2, v[20:23] offset:35840
	v_mov_b32 v6, s95
	s_mov_b64 exec, 1
	ds_write_b32 v2, v6 offset:37120
	s_mov_b64 exec, -1
	s_lshl_b32 s44, s26, 8
	v_lshrrev_b32 v6, 2, v0
	v_add_u32 v6, s44, v6
	s_add_u32 s29, s29, 524288
	s_waitcnt vmcnt(0) lgkmcnt(0)
chain_both:
	v_mov_b32 v9, 0
chain_init:
	global_load_dword v8, v9, s[24:25] sc1
	s_sub_u32 s42, s42, 1
	s_cbranch_scc1 chain_end
	s_waitcnt vmcnt(0)
	v_readfirstlane_b32 s44, v8
	s_bitcmp1_b32 s44, 5
	s_cbranch_scc0 chain_init
	s_mov_b32 m0, s31
	s_waitcnt vmcnt(0) lgkmcnt(0)
	s_xor_b32 s33, s33, 0x80000
	s_xor_b32 s34, s34, 0x80000
	s_xor_b32 s35, s35, 0x80000
	s_xor_b32 s38, s38, 0x80000
	s_bfe_u32 s45, s44, 0xa0006
	s_mul_i32 s45, s45, s45
	s_lshr_b32 s44, s44, 16
	s_lshl_b32 s44, s44, 5
	s_cmp_eq_u32 s44, s45
	s_cbranch_scc0 chain_e0_s
	s_branch chain_e0_f
chain_e0_f:
	s_barrier
	buffer_load_dwordx4 v0, s[4:7], s39 offen sc1 lds
	s_waitcnt vmcnt(3)
	ds_read_b128 v[40:43], v2 offset:0
	ds_read_b128 v[44:47], v2 offset:1024
	ds_read_b128 v[32:35], v2 offset:8192
	ds_read_b128 v[36:39], v2 offset:9216
	ds_read_b32 v7, v2 offset:37120
	s_xor_b32 s33, s33, 0x80000
	s_xor_b32 s34, s34, 0x80000
	s_xor_b32 s35, s35, 0x80000
	s_xor_b32 s38, s38, 0x80000
	s_bfe_u32 s59, s28, 0x10001
	v_mov_b64 v[8:9], 0
	v_mov_b64 v[10:11], 0
	v_mov_b64 v[12:13], 0
	v_mov_b64 v[14:15], 0
	v_mov_b64 v[16:17], 0
	v_mov_b64 v[18:19], 0
	v_mov_b64 v[20:21], 0
	v_mov_b64 v[22:23], 0
	v_mov_b64 v[48:49], 0
	v_mov_b64 v[50:51], 0
	v_mov_b64 v[52:53], 0
	v_mov_b64 v[54:55], 0
	s_waitcnt lgkmcnt(0)
	v_readfirstlane_b32 s95, v7
	s_add_u32 s46, s28, 2
	s_min_u32 s46, s46, 64
	buffer_load_dwordx4 v0, s[4:7], s39 offen sc1 lds
	s_waitcnt vmcnt(1) lgkmcnt(0)
	buffer_load_dwordx4 v0, s[4:7], s39 offen sc1 lds
	ds_read_b128 v[24:27], v2 offset:2048
	s_mov_b32 m0, s36
chain_h2r_f:
	s_waitcnt lgkmcnt(0)
	v_max3_u32 v7, v24, v25, v26
	v_max_u32 v7, v7, v27
	v_smfmac_f32_16x16x64_bf16 v[12:15], v[24:27], v[40:47], v1
	v_cmp_eq_u32 vcc, -1, v7
	v_smfmac_f32_16x16x64_bf16 v[8:11], v[24:27], v[32:39], v1
	s_cbranch_vccnz chain_r2e_f
chain_eok_f:
	s_barrier
	ds_read_b128 v[28:31], v3 offset:2048
	v_smfmac_f32_16x16x64_bf16 v[20:23], v[24:27], v[136:143], v1
	ds_read_b128 v[40:43], v2 offset:10240
	ds_read_b128 v[44:47], v2 offset:11264
	v_smfmac_f32_16x16x64_bf16 v[48:51], v[24:27], a[16:23], v1
	buffer_load_dword v6, s[4:7], s40 offen sc1 lds
	s_mov_b32 m0, s31
	v_smfmac_f32_16x16x64_bf16 v[52:55], v[24:27], a[24:31], v1
	buffer_load_dwordx4 v0, s[4:7], s57 offen offset:1024 sc1 lds
	ds_read_b128 v[32:35], v2 offset:12288
	s_waitcnt lgkmcnt(3)
	v_smfmac_f32_16x16x64_bf16 v[12:15], v[28:31], v[160:167], v1
	ds_read_b128 v[36:39], v2 offset:13312
	s_waitcnt lgkmcnt(2)
	v_smfmac_f32_16x16x64_bf16 v[16:19], v[24:27], v[40:47], v1
	ds_read_b128 v[24:27], v4 offset:2048
	ds_read_b128 v[40:43], v2 offset:14336
	v_smfmac_f32_16x16x64_bf16 v[20:23], v[28:31], v[168:175], v1
	ds_read_b128 v[44:47], v2 offset:15360
	s_waitcnt lgkmcnt(3)
	v_smfmac_f32_16x16x64_bf16 v[8:11], v[28:31], v[32:39], v1
	ds_read_b128 v[32:35], v2 offset:16384
	ds_read_b128 v[36:39], v2 offset:17408
	s_waitcnt lgkmcnt(4)
	v_smfmac_f32_16x16x64_bf16 v[12:15], v[24:27], v[192:199], v1
	s_waitcnt lgkmcnt(2)
	v_smfmac_f32_16x16x64_bf16 v[16:19], v[28:31], v[40:47], v1
	ds_read_b128 v[28:31], v5 offset:2048
	ds_read_b128 v[40:43], v2 offset:18432
	v_smfmac_f32_16x16x64_bf16 v[20:23], v[24:27], v[200:207], v1
	ds_read_b128 v[44:47], v2 offset:19456
	s_waitcnt lgkmcnt(3)
	v_smfmac_f32_16x16x64_bf16 v[8:11], v[24:27], v[32:39], v1
	ds_read_b128 v[32:35], v2 offset:20480
	ds_read_b128 v[36:39], v2 offset:21504
	s_waitcnt lgkmcnt(2)
	v_smfmac_f32_16x16x64_bf16 v[16:19], v[24:27], v[40:47], v1
	ds_read_b128 v[40:43], v2 offset:22528
	ds_read_b128 v[44:47], v2 offset:23552
	v_smfmac_f32_16x16x64_bf16 v[12:15], v[28:31], v[224:231], v1
	s_waitcnt vmcnt(0)
	ds_read_b128 v[24:27], v2 offset:3072
	ds_read_b32 v7, v6 offset:4096
	v_smfmac_f32_16x16x64_bf16 v[20:23], v[28:31], v[232:239], v1
	s_waitcnt lgkmcnt(0)
	v_max3_u32 v7, v7, v24, v25
	v_max3_u32 v7, v7, v26, v27
	v_smfmac_f32_16x16x64_bf16 v[8:11], v[28:31], v[32:39], v1
	v_cmp_eq_u32 vcc, -1, v7
	v_smfmac_f32_16x16x64_bf16 v[16:19], v[28:31], v[40:47], v1
	s_cbranch_vccnz chain_r2l_f
chain_lok_f:
	s_barrier
	v_lshlrev_b32 v7, 2, v0
	ds_read_b128 v[32:35], v3 offset:3072
	v_smfmac_f32_16x16x64_bf16 v[8:11], v[24:27], v[56:63], v1
	ds_read_b128 v[36:39], v4 offset:3072
	ds_read_b128 v[28:31], v5 offset:3072
	v_smfmac_f32_16x16x64_bf16 v[12:15], v[24:27], v[144:151], v1
	s_cmp_lt_u32 s95, s46
	s_cbranch_scc1 chain_kvw_f
chain_kvok_f:
	v_smfmac_f32_16x16x64_bf16 v[16:19], v[24:27], v[64:71], v1
	s_mov_b32 m0, s97
	s_nop 0
	buffer_load_dword v7, s[4:7], s29 offen sc1 lds
	v_smfmac_f32_16x16x64_bf16 v[20:23], v[24:27], v[152:159], v1
	ds_read_b128 v[24:27], v0 offset:4096
	s_waitcnt lgkmcnt(3)
	v_smfmac_f32_16x16x64_bf16 v[8:11], v[32:35], v[72:79], v1
	s_mov_b64 exec, 1
	buffer_load_dword off, s[4:7], s96 offset:256 sc1 lds
	s_mov_b64 exec, -1
	v_smfmac_f32_16x16x64_bf16 v[12:15], v[32:35], v[176:183], v1
	v_smfmac_f32_16x16x64_bf16 v[16:19], v[32:35], v[80:87], v1
	s_mov_b32 m0, s58
	v_smfmac_f32_16x16x64_bf16 v[20:23], v[32:35], v[184:191], v1
	ds_read_b128 v[32:35], v0 offset:0
	s_waitcnt lgkmcnt(3)
	v_smfmac_f32_16x16x64_bf16 v[8:11], v[36:39], v[88:95], v1
	v_smfmac_f32_16x16x64_bf16 v[12:15], v[36:39], v[208:215], v1
	ds_read_b128 v[40:43], v2 offset:4096
	v_smfmac_f32_16x16x64_bf16 v[16:19], v[36:39], v[96:103], v1
	ds_read_b128 v[44:47], v2 offset:5120
	v_smfmac_f32_16x16x64_bf16 v[20:23], v[36:39], v[216:223], v1
	s_waitcnt lgkmcnt(4)
	v_smfmac_f32_16x16x64_bf16 v[8:11], v[28:31], v[104:111], v1
	s_waitcnt lgkmcnt(0)
	v_smfmac_f32_16x16x64_bf16 v[12:15], v[28:31], v[240:247], v1
	v_smfmac_f32_16x16x64_bf16 v[16:19], v[28:31], v[112:119], v1
	v_smfmac_f32_16x16x64_bf16 v[20:23], v[28:31], v[248:255], v1
	v_smfmac_f32_16x16x64_bf16 v[8:11], v[24:27], v[120:127], v1
	v_smfmac_f32_16x16x64_bf16 v[12:15], v[24:27], a[0:7], v1
	v_smfmac_f32_16x16x64_bf16 v[16:19], v[24:27], v[128:135], v1
	v_cvt_pk_bf16_f32 v8, v8, v9
	v_cvt_pk_bf16_f32 v9, v10, v11
	v_smfmac_f32_16x16x64_bf16 v[20:23], v[24:27], a[8:15], v1
	v_cvt_pk_bf16_f32 v10, v12, v13
	v_cvt_pk_bf16_f32 v11, v14, v15
	s_nop 1
	v_mfma_f32_16x16x32_bf16 v[12:15], v[8:11], v[32:35], 0
	v_cvt_pk_bf16_f32 v16, v16, v17
	v_cvt_pk_bf16_f32 v17, v18, v19
	s_nop 0
	v_cvt_pk_bf16_f32 v18, v20, v21
	v_cvt_pk_bf16_f32 v19, v22, v23
	s_nop 1
	v_mfma_f32_16x16x32_bf16 v[20:23], v[16:19], v[32:35], 0
	v_cvt_pk_bf16_f32 v8, v12, v13
	v_cvt_pk_bf16_f32 v9, v14, v15
	v_smfmac_f32_16x16x64_bf16 v[48:51], v[24:27], a[144:151], v1
	ds_read_b128 v[32:35], v3 offset:3072
	s_nop 2
	v_cvt_pk_bf16_f32 v10, v20, v21
	v_cvt_pk_bf16_f32 v11, v22, v23
	s_nop 1
	v_mfma_f32_16x16x32_bf16 v[12:15], v[8:11], v[8:11], 0
	buffer_load_dwordx4 v0, s[4:7], s29 offen offset:0 sc1 lds
	v_mfma_f32_16x16x32_bf16 v[20:23], v[44:47], v[8:11], 0
	buffer_store_dwordx4 v[8:11], v0, s[4:7], s30 offen sc1
	v_mfma_f32_16x16x32_bf16 v[16:19], v[40:43], v[8:11], 0
	v_mov_b32_dpp v12, v14 row_ror:8 row_mask:0xf bank_mask:0xc
	v_mov_b32_dpp v13, v15 row_ror:8 row_mask:0xf bank_mask:0xc
	v_lshrrev_b32 v7, 2, v0
	v_mov_b64 v[46:47], s[100:101]
	v_permlane32_swap_b32 v12, v13
	v_smfmac_f32_16x16x64_bf16 v[52:55], v[24:27], a[152:159], v1
	ds_read_b128 v[24:27], v2 offset:3072
	ds_write_b32 v6, v13 offset:2048
	v_mov_b32_dpp v16, v20 row_ror:8 row_mask:0xf bank_mask:0xc
	v_mov_b32_dpp v17, v21 row_ror:8 row_mask:0xf bank_mask:0xc
	v_mov_b32_dpp v18, v22 row_ror:8 row_mask:0xf bank_mask:0xc
	v_mov_b32_dpp v19, v23 row_ror:8 row_mask:0xf bank_mask:0xc
	v_smfmac_f32_16x16x64_bf16 v[48:51], v[28:31], a[128:135], v1
	ds_write_b128 v2, v[16:19] offset:38400
	v_smfmac_f32_16x16x64_bf16 v[52:55], v[28:31], a[136:143], v1
	ds_read_b128 v[28:31], v5 offset:2048
	buffer_load_dwordx4 v0, s[4:7], s29 offen offset:1024 sc1 lds
	v_smfmac_f32_16x16x64_bf16 v[48:51], v[36:39], a[96:103], v1
	v_smfmac_f32_16x16x64_bf16 v[52:55], v[36:39], a[104:111], v1
	ds_read_b128 v[36:39], v4 offset:2048
	s_waitcnt lgkmcnt(5)
	v_smfmac_f32_16x16x64_bf16 v[48:51], v[32:35], a[64:71], v1
	s_waitcnt lgkmcnt(2)
	s_barrier
	ds_read_b128 v[8:11], v3 offset:38400
	ds_read_b128 v[12:15], v4 offset:38400
	ds_read_b128 v[20:23], v5 offset:38400
	ds_read2st64_b32 v[40:41], v7 offset0:8 offset1:9
	ds_read2st64_b32 v[42:43], v7 offset0:10 offset1:11
	v_smfmac_f32_16x16x64_bf16 v[52:55], v[32:35], a[72:79], v1
	ds_read_b128 v[32:35], v3 offset:2048
	v_smfmac_f32_16x16x64_bf16 v[48:51], v[24:27], a[32:39], v1
	v_smfmac_f32_16x16x64_bf16 v[52:55], v[24:27], a[40:47], v1
	s_waitcnt lgkmcnt(7)
	v_smfmac_f32_16x16x64_bf16 v[48:51], v[28:31], a[112:119], v1
	v_smfmac_f32_16x16x64_bf16 v[52:55], v[28:31], a[120:127], v1
	s_waitcnt lgkmcnt(1)
	v_pk_add_f32 v[8:9], v[8:9], v[16:17]
	v_pk_add_f32 v[10:11], v[10:11], v[18:19]
	v_pk_add_f32 v[12:13], v[12:13], v[20:21]
	v_pk_add_f32 v[14:15], v[14:15], v[22:23]
	v_pk_add_f32 v[40:41], v[40:41], v[42:43]
	v_pk_add_f32 v[8:9], v[8:9], v[12:13]
	v_pk_add_f32 v[10:11], v[10:11], v[14:15]
	v_add_f32 v12, v40, v41
	v_max3_f32 v13, v8, v9, v10
	v_max3_f32 v13, v13, v11, v12
	v_smfmac_f32_16x16x64_bf16 v[48:51], v[36:39], a[80:87], v1
	ds_read_b128 v[16:19], v2 offset:6144
	v_max_f32_dpp v14, v13, v13 row_ror:8 row_mask:0xf bank_mask:0xf
	v_max_f32_dpp v15, v13, v13 row_ror:8 row_mask:0xf bank_mask:0xf
	v_smfmac_f32_16x16x64_bf16 v[52:55], v[36:39], a[88:95], v1
	ds_read_b128 v[20:23], v2 offset:7168
	v_permlane16_swap_b32 v14, v15
	v_max_f32 v13, v14, v15
	v_max_f32 v14, v14, v15
	v_mov_b64 v[36:37], s[98:99]
	v_mov_b64 v[38:39], s[98:99]
	v_permlane32_swap_b32 v13, v14
	s_waitcnt lgkmcnt(2)
	v_smfmac_f32_16x16x64_bf16 v[48:51], v[32:35], a[48:55], v1
	ds_read_b128 v[24:27], v2 offset:24576
	v_max_f32 v13, v13, v14
	v_mul_f32 v13, s43, v13
	v_smfmac_f32_16x16x64_bf16 v[52:55], v[32:35], a[56:63], v1
	ds_read_b128 v[28:31], v2 offset:25600
	v_fma_f32 v8, v8, s43, -v13
	v_fma_f32 v9, v9, s43, -v13
	v_fma_f32 v10, v10, s43, -v13
	v_fma_f32 v11, v11, s43, -v13
	v_fma_f32 v12, v12, s43, -v13
	v_exp_f32 v12, v12
	v_exp_f32 v8, v8
	v_exp_f32 v9, v9
	v_cvt_pk_bf16_f32 v48, v48, v50
	v_cvt_pk_bf16_f32 v49, v49, v51
	v_exp_f32 v10, v10
	v_mov_b32_dpp v13, v12 row_ror:8 row_mask:0xf bank_mask:0xf
	v_exp_f32 v11, v11
	v_cvt_pk_bf16_f32 v40, v8, v9
	v_cvt_pk_bf16_f32 v41, v10, v11
	v_cvt_pk_bf16_f32 v50, v52, v54
	v_mov_b32_dpp v42, v40 row_ror:8 row_mask:0xf bank_mask:0xf
	v_mov_b32_dpp v43, v41 row_ror:8 row_mask:0xf bank_mask:0xf
	v_cvt_pk_bf16_f32 v44, v12, v13
	v_cvt_pk_bf16_f32 v45, v12, v13
	v_mfma_f32_16x16x32_bf16 v[8:11], v[36:39], v[40:43], 0
	v_cvt_pk_bf16_f32 v51, v53, v55
	v_permlane32_swap_b32 v44, v45
	s_waitcnt lgkmcnt(3)
	v_mfma_f32_16x16x32_bf16 v[32:35], v[16:19], v[40:43], 0
	buffer_store_dwordx4 v[48:51], v0, s[4:7], s30 offen offset:1024 sc1
	s_waitcnt lgkmcnt(2)
	v_mfma_f32_16x16x32_bf16 v[36:39], v[20:23], v[40:43], 0
	ds_read_b128 v[16:19], v2 offset:26624
	v_mfma_f32_16x16x16_bf16 v[8:11], v[46:47], v[44:45], v[8:11]
	v_mov_b64 v[12:13], 0
	v_mov_b64 v[14:15], 0
	v_mfma_f32_16x16x16_bf16 v[32:35], v[48:49], v[44:45], v[32:35]
	v_mov_b64 v[40:41], 0
	v_mov_b64 v[42:43], 0
	v_mfma_f32_16x16x16_bf16 v[36:39], v[50:51], v[44:45], v[36:39]
	v_rcp_f32 v52, v8
	ds_read_b128 v[20:23], v2 offset:27648
	s_nop 1
	v_pk_mul_f32 v[32:33], v[32:33], v[52:53] op_sel_hi:[1,0]
	v_pk_mul_f32 v[34:35], v[34:35], v[52:53] op_sel_hi:[1,0]
	v_cvt_pk_bf16_f32 v32, v32, v33
	v_cvt_pk_bf16_f32 v33, v34, v35
	v_pk_mul_f32 v[36:37], v[36:37], v[52:53] op_sel_hi:[1,0]
	v_pk_mul_f32 v[38:39], v[38:39], v[52:53] op_sel_hi:[1,0]
	v_cvt_pk_bf16_f32 v34, v36, v37
	v_cvt_pk_bf16_f32 v35, v38, v39
	v_mov_b32_dpp v32, v32 row_ror:8 row_mask:0xf bank_mask:0xc
	v_mov_b32_dpp v33, v33 row_ror:8 row_mask:0xf bank_mask:0xc
	v_mov_b32_dpp v34, v34 row_ror:8 row_mask:0xf bank_mask:0xc
	v_mov_b32_dpp v35, v35 row_ror:8 row_mask:0xf bank_mask:0xc
	ds_write_b128 v2, v[32:35] offset:37376
	s_nop 0
	v_smfmac_f32_16x16x64_bf16 v[40:43], v[32:35], a[208:215], v1
	buffer_load_dwordx4 v0, s[4:7], s29 offen offset:2048 sc1 lds
	s_cmp_eq_u32 s28, 63
	s_waitcnt lgkmcnt(1)
	v_smfmac_f32_16x16x64_bf16 v[12:15], v[32:35], v[16:23], v1
	buffer_load_dwordx4 v0, s[4:7], s29 offen offset:3072 sc1 lds
	s_cbranch_scc1 chain_end
	v_mov_b64 v[8:9], 0
	v_mov_b64 v[10:11], 0
	v_mov_b64 v[44:45], 0
	v_mov_b64 v[46:47], 0
	s_waitcnt lgkmcnt(0)
	s_barrier
	ds_read_b128 v[36:39], v3 offset:37376
	ds_read_b128 v[52:55], v4 offset:37376
	ds_read_b128 v[48:51], v5 offset:37376
	v_smfmac_f32_16x16x64_bf16 v[8:11], v[32:35], v[24:31], v1
	v_smfmac_f32_16x16x64_bf16 v[44:47], v[32:35], a[232:239], v1
	ds_read_b128 v[32:35], v0 offset:3072
	s_waitcnt lgkmcnt(3)
	v_smfmac_f32_16x16x64_bf16 v[8:11], v[36:39], a[160:167], v1
	ds_read_b128 v[24:27], v2 offset:28672
	v_smfmac_f32_16x16x64_bf16 v[12:15], v[36:39], a[184:191], v1
	ds_read_b128 v[28:31], v2 offset:29696
	s_waitcnt lgkmcnt(4)
	v_smfmac_f32_16x16x64_bf16 v[8:11], v[52:55], a[168:175], v1
	ds_read_b128 v[16:19], v2 offset:30720
	v_smfmac_f32_16x16x64_bf16 v[12:15], v[52:55], a[192:199], v1
	ds_read_b128 v[20:23], v2 offset:31744
	s_waitcnt lgkmcnt(5)
	v_smfmac_f32_16x16x64_bf16 v[8:11], v[48:51], a[176:183], v1
	s_add_u32 s41, s41, 0x4000
	s_and_b32 s41, s41, 0xc000
	v_smfmac_f32_16x16x64_bf16 v[12:15], v[48:51], a[200:207], v1
	s_waitcnt lgkmcnt(2)
	v_smfmac_f32_16x16x64_bf16 v[40:43], v[36:39], v[24:31], v1
	v_cvt_pk_bf16_f32 v8, v8, v9
	v_cvt_pk_bf16_f32 v9, v10, v11
	v_bfi_b32 v8, 1, s59, v8
	s_nop 0
	v_cvt_pk_bf16_f32 v10, v12, v13
	v_cvt_pk_bf16_f32 v11, v14, v15
	buffer_store_dwordx4 v[8:11], v0, s[4:7], s32 offen offset:0
	ds_read_b128 v[12:15], v32
	s_waitcnt lgkmcnt(1)
	v_smfmac_f32_16x16x64_bf16 v[44:47], v[36:39], v[16:23], v1
	ds_read_b128 v[24:27], v2 offset:32768
	ds_read_b128 v[28:31], v2 offset:33792
	v_smfmac_f32_16x16x64_bf16 v[40:43], v[52:55], a[216:223], v1
	ds_read_b128 v[36:39], v34
	ds_read_b128 v[16:19], v2 offset:34816
	v_smfmac_f32_16x16x64_bf16 v[44:47], v[52:55], a[240:247], v1
	ds_read_b128 v[20:23], v2 offset:35840
	v_mov_b64 v[8:9], 0
	v_mov_b64 v[10:11], 0
	v_smfmac_f32_16x16x64_bf16 v[40:43], v[48:51], a[224:231], v1
	ds_read_b32 v32, v6 offset:5120
	s_waitcnt lgkmcnt(4)
	v_smfmac_f32_16x16x64_bf16 v[8:11], v[12:15], v[24:31], v1
	v_smfmac_f32_16x16x64_bf16 v[44:47], v[48:51], a[248:255], v1
	s_waitcnt lgkmcnt(1)
	v_smfmac_f32_16x16x64_bf16 v[8:11], v[36:39], v[16:23], v1
	ds_read_b128 v[36:39], v0 offset:1024
	s_cmp_lg_u32 s93, 0
	v_cvt_pk_bf16_f32 v40, v40, v41
	v_cvt_pk_bf16_f32 v41, v42, v43
	v_bfi_b32 v40, 1, s59, v40
	v_cvt_pk_bf16_f32 v42, v44, v45
	v_cvt_pk_bf16_f32 v43, v46, v47
	buffer_store_dwordx4 v[40:43], v0, s[4:7], s32 offen offset:1024
	v_cvt_pk_bf16_f32 v8, v8, v9
	v_cvt_pk_bf16_f32 v9, v10, v11
	v_bfi_b32 v8, 1, s59, v8
	buffer_store_dwordx2 v[8:9], v35, s[4:7], s32 offen offset:2048
	s_cbranch_scc1 chain_late_f
	s_add_u32 s37, s41, s92
	s_add_u32 s39, s41, s94
	s_add_u32 s40, s41, s56
	s_add_u32 s57, s39, 3072
	s_mov_b32 m0, s31
	s_add_u32 s28, s28, 1
	s_add_u32 s30, s30, 262144
	s_add_u32 s29, s29, 524288
	s_xor_b32 s32, s32, 0x80000
	s_xor_b32 s48, s41, 0x8000
	s_add_u32 s48, s48, s92
	s_waitcnt vmcnt(2)
	buffer_load_dwordx4 v[24:27], v33, s[4:7], s33 offen sc1
	buffer_load_dwordx4 v[28:31], v33, s[4:7], s34 offen sc1
	buffer_load_dwordx4 v[16:19], v33, s[4:7], s35 offen sc1
	buffer_load_dwordx4 v[20:23], v33, s[4:7], s38 offen sc1
	s_waitcnt vmcnt(5)
	buffer_load_dwordx4 v[48:51], v33, s[4:7], s33 offen sc1
	buffer_load_dwordx4 v[52:55], v33, s[4:7], s34 offen sc1
	buffer_load_dwordx4 v[44:47], v33, s[4:7], s35 offen sc1
	buffer_load_dwordx4 v[40:43], v33, s[4:7], s38 offen sc1
	s_waitcnt lgkmcnt(0)
	s_waitcnt vmcnt(7)
	v_mfma_f32_16x16x32_bf16 v[12:15], v[36:39], v[24:27], 0
	s_waitcnt vmcnt(6)
	v_mfma_f32_16x16x32_bf16 v[12:15], v[36:39], v[28:31], v[12:15]
	v_bitop3_b32 v7, v24, v28, s59 bitop3:0x7e
	s_waitcnt vmcnt(5)
	v_mfma_f32_16x16x32_bf16 v[12:15], v[36:39], v[16:19], v[12:15]
	s_waitcnt vmcnt(4)
	v_mfma_f32_16x16x32_bf16 v[12:15], v[36:39], v[20:23], v[12:15]
	v_bitop3_b32 v8, v16, v20, s59 bitop3:0x7e
	v_bitop3_b32 v7, v7, v8, 1 bitop3:0xa8
	v_cmp_ne_u32 vcc, 0, v7
	s_cbranch_vccnz chain_rea_f
	s_nop 3
	v_add_f32_dpp v12, v12, v12 row_ror:8 row_mask:0xf bank_mask:0xf
	v_add_f32_dpp v13, v13, v13 row_ror:8 row_mask:0xf bank_mask:0xf
	v_cvt_pk_bf16_f32 v12, v12, v13
	buffer_store_dword v12, v32, s[4:7], s37 offen
	v_mov_b32 v8, -1
	buffer_store_dword v8, v32, s[4:7], s48 offen
chain_eb_f:
	s_waitcnt vmcnt(2)
	ds_read_b128 v[40:43], v2 offset:0
	ds_read_b128 v[44:47], v2 offset:1024
	ds_read_b128 v[32:35], v2 offset:8192
	ds_read_b128 v[36:39], v2 offset:9216
	ds_read_b32 v7, v2 offset:37120
	s_xor_b32 s33, s33, 0x80000
	s_xor_b32 s34, s34, 0x80000
	s_xor_b32 s35, s35, 0x80000
	s_xor_b32 s38, s38, 0x80000
	s_bfe_u32 s59, s28, 0x10001
	v_mov_b64 v[8:9], 0
	v_mov_b64 v[10:11], 0
	v_mov_b64 v[12:13], 0
	v_mov_b64 v[14:15], 0
	v_mov_b64 v[16:17], 0
	v_mov_b64 v[18:19], 0
	v_mov_b64 v[20:21], 0
	v_mov_b64 v[22:23], 0
	v_mov_b64 v[48:49], 0
	v_mov_b64 v[50:51], 0
	v_mov_b64 v[52:53], 0
	v_mov_b64 v[54:55], 0
	s_waitcnt lgkmcnt(0)
	v_readfirstlane_b32 s95, v7
	s_add_u32 s46, s28, 2
	s_min_u32 s46, s46, 64
	s_barrier
	buffer_load_dwordx4 v0, s[4:7], s39 offen sc1 lds
	s_waitcnt vmcnt(0) lgkmcnt(0)
	buffer_load_dwordx4 v0, s[4:7], s39 offen sc1 lds
	ds_read_b128 v[24:27], v2 offset:2048
	s_mov_b32 m0, s36
	s_branch chain_h2r_f
chain_late_f:
	s_cmp_eq_u32 s93, 2
	s_cbranch_scc0 chain_tail_f
	s_waitcnt vmcnt(1)
	buffer_load_dwordx4 v[24:27], v33, s[4:7], s33 offen sc1
	buffer_load_dwordx4 v[28:31], v33, s[4:7], s34 offen sc1
	buffer_load_dwordx4 v[16:19], v33, s[4:7], s35 offen sc1
	buffer_load_dwordx4 v[20:23], v33, s[4:7], s38 offen sc1
	s_add_u32 s37, s41, s92
	s_add_u32 s39, s41, s94
	s_add_u32 s40, s41, s56
	s_add_u32 s57, s39, 3072
	s_mov_b32 m0, s31
	s_add_u32 s28, s28, 1
	s_add_u32 s30, s30, 262144
	s_add_u32 s29, s29, 524288
	s_xor_b32 s32, s32, 0x80000
	s_xor_b32 s48, s41, 0x8000
	s_add_u32 s48, s48, s92
	buffer_load_dwordx4 v[48:51], v33, s[4:7], s33 offen sc1
	buffer_load_dwordx4 v[52:55], v33, s[4:7], s34 offen sc1
	buffer_load_dwordx4 v[44:47], v33, s[4:7], s35 offen sc1
	buffer_load_dwordx4 v[40:43], v33, s[4:7], s38 offen sc1
	s_waitcnt lgkmcnt(0)
	s_waitcnt vmcnt(7)
	v_mfma_f32_16x16x32_bf16 v[12:15], v[36:39], v[24:27], 0
	s_waitcnt vmcnt(6)
	v_mfma_f32_16x16x32_bf16 v[12:15], v[36:39], v[28:31], v[12:15]
	v_bitop3_b32 v7, v24, v28, s59 bitop3:0x7e
	s_waitcnt vmcnt(5)
	v_mfma_f32_16x16x32_bf16 v[12:15], v[36:39], v[16:19], v[12:15]
	s_waitcnt vmcnt(4)
	v_mfma_f32_16x16x32_bf16 v[12:15], v[36:39], v[20:23], v[12:15]
	v_bitop3_b32 v8, v16, v20, s59 bitop3:0x7e
	v_bitop3_b32 v7, v7, v8, 1 bitop3:0xa8
	v_cmp_ne_u32 vcc, 0, v7
	s_cbranch_vccnz chain_rla_f
	s_nop 3
	v_add_f32_dpp v12, v12, v12 row_ror:8 row_mask:0xf bank_mask:0xf
	v_add_f32_dpp v13, v13, v13 row_ror:8 row_mask:0xf bank_mask:0xf
	v_cvt_pk_bf16_f32 v12, v12, v13
	buffer_store_dword v12, v32, s[4:7], s37 offen
	v_mov_b32 v8, -1
	buffer_store_dword v8, v32, s[4:7], s48 offen
chain_lb_f:
	s_branch chain_e0_f
chain_tail_f:
	s_cmp_eq_u32 s93, 3
	s_cbranch_scc1 chain_idle_f
	s_waitcnt vmcnt(0)
	buffer_load_dwordx4 v[24:27], v33, s[4:7], s33 offen sc1
	buffer_load_dwordx4 v[28:31], v33, s[4:7], s34 offen sc1
	buffer_load_dwordx4 v[16:19], v33, s[4:7], s35 offen sc1
	buffer_load_dwordx4 v[20:23], v33, s[4:7], s38 offen sc1
	s_add_u32 s37, s41, s92
	s_add_u32 s39, s41, s94
	s_add_u32 s40, s41, s56
	s_add_u32 s57, s39, 3072
	s_mov_b32 m0, s31
	s_add_u32 s28, s28, 1
	s_add_u32 s30, s30, 262144
	s_add_u32 s29, s29, 524288
	s_xor_b32 s32, s32, 0x80000
	s_xor_b32 s48, s41, 0x8000
	s_add_u32 s48, s48, s92
	buffer_load_dwordx4 v[48:51], v33, s[4:7], s33 offen sc1
	buffer_load_dwordx4 v[52:55], v33, s[4:7], s34 offen sc1
	buffer_load_dwordx4 v[44:47], v33, s[4:7], s35 offen sc1
	buffer_load_dwordx4 v[40:43], v33, s[4:7], s38 offen sc1
	s_waitcnt lgkmcnt(0)
	s_waitcnt vmcnt(7)
	v_mfma_f32_16x16x32_bf16 v[12:15], v[36:39], v[24:27], 0
	v_bitop3_b32 v7, v24, v26, s59 bitop3:0x7e
	s_waitcnt vmcnt(6)
	v_mfma_f32_16x16x32_bf16 v[12:15], v[36:39], v[28:31], v[12:15]
	v_bitop3_b32 v8, v28, v30, s59 bitop3:0x7e
	s_waitcnt vmcnt(5)
	v_mfma_f32_16x16x32_bf16 v[12:15], v[36:39], v[16:19], v[12:15]
	v_bitop3_b32 v9, v16, v18, s59 bitop3:0x7e
	v_or3_b32 v7, v7, v8, v9
	s_waitcnt vmcnt(4)
	v_mfma_f32_16x16x32_bf16 v[12:15], v[36:39], v[20:23], v[12:15]
	v_bitop3_b32 v8, v20, v22, s59 bitop3:0x7e
	v_bitop3_b32 v7, v7, v8, 1 bitop3:0xa8
	v_cmp_ne_u32 vcc, 0, v7
	s_cbranch_vccnz chain_rza_f
	s_nop 3
	v_add_f32_dpp v12, v12, v12 row_ror:4 row_mask:0xf bank_mask:0xf
	v_add_f32_dpp v13, v13, v13 row_ror:4 row_mask:0xf bank_mask:0xf
	s_nop 0
	v_add_f32_dpp v12, v12, v12 row_ror:8 row_mask:0xf bank_mask:0xf
	v_add_f32_dpp v13, v13, v13 row_ror:8 row_mask:0xf bank_mask:0xf
	v_cvt_pk_bf16_f32 v12, v12, v13
	buffer_store_dword v12, v32, s[4:7], s37 offen
	v_mov_b32 v8, -1
	buffer_store_dword v8, v32, s[4:7], s48 offen
chain_zb_f:
	s_branch chain_e0_f
chain_idle_f:
	s_add_u32 s37, s41, s92
	s_add_u32 s39, s41, s94
	s_add_u32 s40, s41, s56
	s_add_u32 s57, s39, 3072
	s_mov_b32 m0, s31
	s_add_u32 s28, s28, 1
	s_add_u32 s30, s30, 262144
	s_add_u32 s29, s29, 524288
	s_xor_b32 s32, s32, 0x80000
	s_xor_b32 s48, s41, 0x8000
	s_add_u32 s48, s48, s92
	s_waitcnt vmcnt(0)
	s_waitcnt lgkmcnt(0)
	s_branch chain_e0_f
chain_rea_f:
	s_waitcnt vmcnt(0)
	v_mfma_f32_16x16x32_bf16 v[12:15], v[36:39], v[48:51], 0
	v_mfma_f32_16x16x32_bf16 v[12:15], v[36:39], v[52:55], v[12:15]
	v_bitop3_b32 v7, v48, v52, s59 bitop3:0x7e
	v_mfma_f32_16x16x32_bf16 v[12:15], v[36:39], v[44:47], v[12:15]
	v_mfma_f32_16x16x32_bf16 v[12:15], v[36:39], v[40:43], v[12:15]
	v_bitop3_b32 v8, v44, v40, s59 bitop3:0x7e
	v_bitop3_b32 v7, v7, v8, 1 bitop3:0xa8
	v_cmp_ne_u32 vcc, 0, v7
	s_cbranch_vccnz chain_rec_f
	s_nop 3
	v_add_f32_dpp v12, v12, v12 row_ror:8 row_mask:0xf bank_mask:0xf
	v_add_f32_dpp v13, v13, v13 row_ror:8 row_mask:0xf bank_mask:0xf
	v_cvt_pk_bf16_f32 v12, v12, v13
	buffer_store_dword v12, v32, s[4:7], s37 offen
	v_mov_b32 v8, -1
	buffer_store_dword v8, v32, s[4:7], s48 offen
	s_branch chain_eb_f
chain_rec_f:
	s_sub_u32 s42, s42, 1
	s_cbranch_scc1 chain_end
	buffer_load_dwordx4 v[24:27], v33, s[4:7], s33 offen sc1
	buffer_load_dwordx4 v[28:31], v33, s[4:7], s34 offen sc1
	buffer_load_dwordx4 v[16:19], v33, s[4:7], s35 offen sc1
	buffer_load_dwordx4 v[20:23], v33, s[4:7], s38 offen sc1
	s_waitcnt vmcnt(0)
	v_mfma_f32_16x16x32_bf16 v[12:15], v[36:39], v[24:27], 0
	v_mfma_f32_16x16x32_bf16 v[12:15], v[36:39], v[28:31], v[12:15]
	v_bitop3_b32 v7, v24, v28, s59 bitop3:0x7e
	v_mfma_f32_16x16x32_bf16 v[12:15], v[36:39], v[16:19], v[12:15]
	v_mfma_f32_16x16x32_bf16 v[12:15], v[36:39], v[20:23], v[12:15]
	v_bitop3_b32 v8, v16, v20, s59 bitop3:0x7e
	v_bitop3_b32 v7, v7, v8, 1 bitop3:0xa8
	v_cmp_ne_u32 vcc, 0, v7
	s_cbranch_vccnz chain_rec_f
	s_nop 3
	v_add_f32_dpp v12, v12, v12 row_ror:8 row_mask:0xf bank_mask:0xf
	v_add_f32_dpp v13, v13, v13 row_ror:8 row_mask:0xf bank_mask:0xf
	v_cvt_pk_bf16_f32 v12, v12, v13
	buffer_store_dword v12, v32, s[4:7], s37 offen
	v_mov_b32 v8, -1
	buffer_store_dword v8, v32, s[4:7], s48 offen
	s_branch chain_eb_f
chain_rla_f:
	s_waitcnt vmcnt(0)
	v_mfma_f32_16x16x32_bf16 v[12:15], v[36:39], v[48:51], 0
	v_mfma_f32_16x16x32_bf16 v[12:15], v[36:39], v[52:55], v[12:15]
	v_bitop3_b32 v7, v48, v52, s59 bitop3:0x7e
	v_mfma_f32_16x16x32_bf16 v[12:15], v[36:39], v[44:47], v[12:15]
	v_mfma_f32_16x16x32_bf16 v[12:15], v[36:39], v[40:43], v[12:15]
	v_bitop3_b32 v8, v44, v40, s59 bitop3:0x7e
	v_bitop3_b32 v7, v7, v8, 1 bitop3:0xa8
	v_cmp_ne_u32 vcc, 0, v7
	s_cbranch_vccnz chain_rlc_f
	s_nop 3
	v_add_f32_dpp v12, v12, v12 row_ror:8 row_mask:0xf bank_mask:0xf
	v_add_f32_dpp v13, v13, v13 row_ror:8 row_mask:0xf bank_mask:0xf
	v_cvt_pk_bf16_f32 v12, v12, v13
	buffer_store_dword v12, v32, s[4:7], s37 offen
	v_mov_b32 v8, -1
	buffer_store_dword v8, v32, s[4:7], s48 offen
	s_branch chain_lb_f
chain_rlc_f:
	s_sub_u32 s42, s42, 1
	s_cbranch_scc1 chain_end
	buffer_load_dwordx4 v[24:27], v33, s[4:7], s33 offen sc1
	buffer_load_dwordx4 v[28:31], v33, s[4:7], s34 offen sc1
	buffer_load_dwordx4 v[16:19], v33, s[4:7], s35 offen sc1
	buffer_load_dwordx4 v[20:23], v33, s[4:7], s38 offen sc1
	s_waitcnt vmcnt(0)
	v_mfma_f32_16x16x32_bf16 v[12:15], v[36:39], v[24:27], 0
	v_mfma_f32_16x16x32_bf16 v[12:15], v[36:39], v[28:31], v[12:15]
	v_bitop3_b32 v7, v24, v28, s59 bitop3:0x7e
	v_mfma_f32_16x16x32_bf16 v[12:15], v[36:39], v[16:19], v[12:15]
	v_mfma_f32_16x16x32_bf16 v[12:15], v[36:39], v[20:23], v[12:15]
	v_bitop3_b32 v8, v16, v20, s59 bitop3:0x7e
	v_bitop3_b32 v7, v7, v8, 1 bitop3:0xa8
	v_cmp_ne_u32 vcc, 0, v7
	s_cbranch_vccnz chain_rlc_f
	s_nop 3
	v_add_f32_dpp v12, v12, v12 row_ror:8 row_mask:0xf bank_mask:0xf
	v_add_f32_dpp v13, v13, v13 row_ror:8 row_mask:0xf bank_mask:0xf
	v_cvt_pk_bf16_f32 v12, v12, v13
	buffer_store_dword v12, v32, s[4:7], s37 offen
	v_mov_b32 v8, -1
	buffer_store_dword v8, v32, s[4:7], s48 offen
	s_branch chain_lb_f
chain_rza_f:
	s_waitcnt vmcnt(0)
	v_mfma_f32_16x16x32_bf16 v[12:15], v[36:39], v[48:51], 0
	v_bitop3_b32 v7, v48, v50, s59 bitop3:0x7e
	v_mfma_f32_16x16x32_bf16 v[12:15], v[36:39], v[52:55], v[12:15]
	v_bitop3_b32 v8, v52, v54, s59 bitop3:0x7e
	v_mfma_f32_16x16x32_bf16 v[12:15], v[36:39], v[44:47], v[12:15]
	v_bitop3_b32 v9, v44, v46, s59 bitop3:0x7e
	v_or3_b32 v7, v7, v8, v9
	v_mfma_f32_16x16x32_bf16 v[12:15], v[36:39], v[40:43], v[12:15]
	v_bitop3_b32 v8, v40, v42, s59 bitop3:0x7e
	v_bitop3_b32 v7, v7, v8, 1 bitop3:0xa8
	v_cmp_ne_u32 vcc, 0, v7
	s_cbranch_vccnz chain_rzc_f
	s_nop 3
	v_add_f32_dpp v12, v12, v12 row_ror:4 row_mask:0xf bank_mask:0xf
	v_add_f32_dpp v13, v13, v13 row_ror:4 row_mask:0xf bank_mask:0xf
	s_nop 0
	v_add_f32_dpp v12, v12, v12 row_ror:8 row_mask:0xf bank_mask:0xf
	v_add_f32_dpp v13, v13, v13 row_ror:8 row_mask:0xf bank_mask:0xf
	v_cvt_pk_bf16_f32 v12, v12, v13
	buffer_store_dword v12, v32, s[4:7], s37 offen
	v_mov_b32 v8, -1
	buffer_store_dword v8, v32, s[4:7], s48 offen
	s_branch chain_zb_f
chain_rzc_f:
	s_sub_u32 s42, s42, 1
	s_cbranch_scc1 chain_end
	buffer_load_dwordx4 v[24:27], v33, s[4:7], s33 offen sc1
	buffer_load_dwordx4 v[28:31], v33, s[4:7], s34 offen sc1
	buffer_load_dwordx4 v[16:19], v33, s[4:7], s35 offen sc1
	buffer_load_dwordx4 v[20:23], v33, s[4:7], s38 offen sc1
	s_waitcnt vmcnt(0)
	v_mfma_f32_16x16x32_bf16 v[12:15], v[36:39], v[24:27], 0
	v_bitop3_b32 v7, v24, v26, s59 bitop3:0x7e
	v_mfma_f32_16x16x32_bf16 v[12:15], v[36:39], v[28:31], v[12:15]
	v_bitop3_b32 v8, v28, v30, s59 bitop3:0x7e
	v_mfma_f32_16x16x32_bf16 v[12:15], v[36:39], v[16:19], v[12:15]
	v_bitop3_b32 v9, v16, v18, s59 bitop3:0x7e
	v_or3_b32 v7, v7, v8, v9
	v_mfma_f32_16x16x32_bf16 v[12:15], v[36:39], v[20:23], v[12:15]
	v_bitop3_b32 v8, v20, v22, s59 bitop3:0x7e
	v_bitop3_b32 v7, v7, v8, 1 bitop3:0xa8
	v_cmp_ne_u32 vcc, 0, v7
	s_cbranch_vccnz chain_rzc_f
	s_nop 3
	v_add_f32_dpp v12, v12, v12 row_ror:4 row_mask:0xf bank_mask:0xf
	v_add_f32_dpp v13, v13, v13 row_ror:4 row_mask:0xf bank_mask:0xf
	s_nop 0
	v_add_f32_dpp v12, v12, v12 row_ror:8 row_mask:0xf bank_mask:0xf
	v_add_f32_dpp v13, v13, v13 row_ror:8 row_mask:0xf bank_mask:0xf
	v_cvt_pk_bf16_f32 v12, v12, v13
	buffer_store_dword v12, v32, s[4:7], s37 offen
	v_mov_b32 v8, -1
	buffer_store_dword v8, v32, s[4:7], s48 offen
	s_branch chain_zb_f
chain_r2e_f:
	s_mov_b32 m0, s31
	s_nop 5
	v_mov_b64 v[8:9], 0
	v_mov_b64 v[10:11], 0
	v_mov_b64 v[12:13], 0
	v_mov_b64 v[14:15], 0
chain_r2e2_f:
	buffer_load_dwordx4 v0, s[4:7], s39 offen sc1 lds
	s_waitcnt vmcnt(3)
	ds_read_b128 v[24:27], v2 offset:2048
	s_sub_u32 s42, s42, 1
	s_cbranch_scc1 chain_end
	s_waitcnt lgkmcnt(0)
	v_max3_u32 v7, v24, v25, v26
	v_max_u32 v7, v7, v27
	v_cmp_eq_u32 vcc, -1, v7
	s_cbranch_vccnz chain_r2e2_f
	s_mov_b32 m0, s36
	v_smfmac_f32_16x16x64_bf16 v[12:15], v[24:27], v[40:47], v1
	v_smfmac_f32_16x16x64_bf16 v[8:11], v[24:27], v[32:39], v1
	s_branch chain_eok_f
chain_r2l_f:
	s_sub_u32 s42, s42, 1
	s_cbranch_scc1 chain_end
	buffer_load_dwordx4 v0, s[4:7], s57 offen offset:1024 sc1 lds
	s_mov_b32 m0, s36
	s_nop 0
	buffer_load_dword v6, s[4:7], s40 offen sc1 lds
	s_mov_b32 m0, s31
	s_waitcnt vmcnt(0)
	ds_read_b128 v[24:27], v2 offset:3072
	ds_read_b32 v7, v6 offset:4096
	s_waitcnt lgkmcnt(0)
	v_max3_u32 v7, v7, v24, v25
	v_max3_u32 v7, v7, v26, v27
	v_cmp_eq_u32 vcc, -1, v7
	s_cbranch_vccnz chain_r2l_f
	s_branch chain_lok_f
chain_kvw_f:
	s_mov_b64 exec, 1
	s_mov_b32 m0, s97
	s_nop 0
	buffer_load_dword off, s[4:7], s96 offset:256 sc1 lds
	s_mov_b64 exec, -1
	s_sub_u32 s42, s42, 1
	s_cbranch_scc1 chain_end
	s_waitcnt vmcnt(0)
	ds_read_b32 v7, v2 offset:37120
	s_waitcnt lgkmcnt(0)
	v_readfirstlane_b32 s95, v7
	s_cmp_lt_u32 s95, s46
	s_cbranch_scc1 chain_kvw_f
	v_lshlrev_b32 v7, 2, v0
	s_branch chain_kvok_f
chain_e0_s:
	s_barrier
	buffer_load_dwordx4 v0, s[4:7], s39 offen sc1 lds
	s_waitcnt vmcnt(3)
	ds_read_b128 v[40:43], v2 offset:0
	ds_read_b128 v[44:47], v2 offset:1024
	ds_read_b128 v[32:35], v2 offset:8192
	ds_read_b128 v[36:39], v2 offset:9216
	ds_read_b32 v7, v2 offset:37120
	s_xor_b32 s33, s33, 0x80000
	s_xor_b32 s34, s34, 0x80000
	s_xor_b32 s35, s35, 0x80000
	s_xor_b32 s38, s38, 0x80000
	s_bfe_u32 s59, s28, 0x10001
	v_mov_b64 v[8:9], 0
	v_mov_b64 v[10:11], 0
	v_mov_b64 v[12:13], 0
	v_mov_b64 v[14:15], 0
	v_mov_b64 v[16:17], 0
	v_mov_b64 v[18:19], 0
	v_mov_b64 v[20:21], 0
	v_mov_b64 v[22:23], 0
	v_mov_b64 v[48:49], 0
	v_mov_b64 v[50:51], 0
	v_mov_b64 v[52:53], 0
	v_mov_b64 v[54:55], 0
	s_waitcnt lgkmcnt(0)
	v_readfirstlane_b32 s95, v7
	s_add_u32 s46, s28, 2
	s_min_u32 s46, s46, 64
	buffer_load_dwordx4 v0, s[4:7], s39 offen sc1 lds
	s_waitcnt vmcnt(1) lgkmcnt(0)
	buffer_load_dwordx4 v0, s[4:7], s39 offen sc1 lds
	ds_read_b128 v[24:27], v2 offset:2048
	s_mov_b32 m0, s36
chain_h2r_s:
	s_waitcnt lgkmcnt(0)
	v_max3_u32 v7, v24, v25, v26
	v_max_u32 v7, v7, v27
	v_smfmac_f32_16x16x64_bf16 v[12:15], v[24:27], v[40:47], v1
	v_cmp_eq_u32 vcc, -1, v7
	v_smfmac_f32_16x16x64_bf16 v[8:11], v[24:27], v[32:39], v1
	s_cbranch_vccnz chain_r2e_s
chain_eok_s:
	s_barrier
	ds_read_b128 v[28:31], v3 offset:2048
	v_smfmac_f32_16x16x64_bf16 v[20:23], v[24:27], v[136:143], v1
	ds_read_b128 v[40:43], v2 offset:10240
	ds_read_b128 v[44:47], v2 offset:11264
	v_smfmac_f32_16x16x64_bf16 v[48:51], v[24:27], a[16:23], v1
	buffer_load_dword v6, s[4:7], s40 offen sc1 lds
	s_mov_b32 m0, s31
	v_smfmac_f32_16x16x64_bf16 v[52:55], v[24:27], a[24:31], v1
	buffer_load_dwordx4 v0, s[4:7], s57 offen offset:1024 sc1 lds
	ds_read_b128 v[32:35], v2 offset:12288
	s_waitcnt lgkmcnt(3)
	v_smfmac_f32_16x16x64_bf16 v[12:15], v[28:31], v[160:167], v1
	ds_read_b128 v[36:39], v2 offset:13312
	s_waitcnt lgkmcnt(2)
	v_smfmac_f32_16x16x64_bf16 v[16:19], v[24:27], v[40:47], v1
	ds_read_b128 v[24:27], v4 offset:2048
	ds_read_b128 v[40:43], v2 offset:14336
	v_smfmac_f32_16x16x64_bf16 v[20:23], v[28:31], v[168:175], v1
	ds_read_b128 v[44:47], v2 offset:15360
	s_waitcnt lgkmcnt(3)
	v_smfmac_f32_16x16x64_bf16 v[8:11], v[28:31], v[32:39], v1
	ds_read_b128 v[32:35], v2 offset:16384
	ds_read_b128 v[36:39], v2 offset:17408
	s_waitcnt lgkmcnt(4)
	v_smfmac_f32_16x16x64_bf16 v[12:15], v[24:27], v[192:199], v1
	s_waitcnt lgkmcnt(2)
	v_smfmac_f32_16x16x64_bf16 v[16:19], v[28:31], v[40:47], v1
	ds_read_b128 v[28:31], v5 offset:2048
	ds_read_b128 v[40:43], v2 offset:18432
	v_smfmac_f32_16x16x64_bf16 v[20:23], v[24:27], v[200:207], v1
	ds_read_b128 v[44:47], v2 offset:19456
	s_waitcnt lgkmcnt(3)
	v_smfmac_f32_16x16x64_bf16 v[8:11], v[24:27], v[32:39], v1
	ds_read_b128 v[32:35], v2 offset:20480
	ds_read_b128 v[36:39], v2 offset:21504
	s_waitcnt lgkmcnt(2)
	v_smfmac_f32_16x16x64_bf16 v[16:19], v[24:27], v[40:47], v1
	ds_read_b128 v[40:43], v2 offset:22528
	ds_read_b128 v[44:47], v2 offset:23552
	v_smfmac_f32_16x16x64_bf16 v[12:15], v[28:31], v[224:231], v1
	s_waitcnt vmcnt(0)
	ds_read_b128 v[24:27], v2 offset:3072
	ds_read_b32 v7, v6 offset:4096
	v_smfmac_f32_16x16x64_bf16 v[20:23], v[28:31], v[232:239], v1
	s_waitcnt lgkmcnt(0)
	v_max3_u32 v7, v7, v24, v25
	v_max3_u32 v7, v7, v26, v27
	v_smfmac_f32_16x16x64_bf16 v[8:11], v[28:31], v[32:39], v1
	v_cmp_eq_u32 vcc, -1, v7
	v_smfmac_f32_16x16x64_bf16 v[16:19], v[28:31], v[40:47], v1
	s_cbranch_vccnz chain_r2l_s
chain_lok_s:
	s_barrier
	v_lshlrev_b32 v7, 2, v0
	ds_read_b128 v[32:35], v3 offset:3072
	v_smfmac_f32_16x16x64_bf16 v[8:11], v[24:27], v[56:63], v1
	ds_read_b128 v[36:39], v4 offset:3072
	ds_read_b128 v[28:31], v5 offset:3072
	v_smfmac_f32_16x16x64_bf16 v[12:15], v[24:27], v[144:151], v1
	s_cmp_lt_u32 s95, s46
	s_cbranch_scc1 chain_kvw_s
chain_kvok_s:
	v_smfmac_f32_16x16x64_bf16 v[16:19], v[24:27], v[64:71], v1
	s_mov_b32 m0, s97
	s_nop 0
	buffer_load_dword v7, s[4:7], s29 offen sc1 lds
	v_smfmac_f32_16x16x64_bf16 v[20:23], v[24:27], v[152:159], v1
	ds_read_b128 v[24:27], v0 offset:4096
	s_waitcnt lgkmcnt(3)
	v_smfmac_f32_16x16x64_bf16 v[8:11], v[32:35], v[72:79], v1
	s_mov_b64 exec, 1
	buffer_load_dword off, s[4:7], s96 offset:256 sc1 lds
	s_mov_b64 exec, -1
	v_smfmac_f32_16x16x64_bf16 v[12:15], v[32:35], v[176:183], v1
	v_smfmac_f32_16x16x64_bf16 v[16:19], v[32:35], v[80:87], v1
	s_mov_b32 m0, s58
	v_smfmac_f32_16x16x64_bf16 v[20:23], v[32:35], v[184:191], v1
	ds_read_b128 v[32:35], v0 offset:0
	s_waitcnt lgkmcnt(3)
	v_smfmac_f32_16x16x64_bf16 v[8:11], v[36:39], v[88:95], v1
	v_smfmac_f32_16x16x64_bf16 v[12:15], v[36:39], v[208:215], v1
	ds_read_b128 v[40:43], v2 offset:4096
	v_smfmac_f32_16x16x64_bf16 v[16:19], v[36:39], v[96:103], v1
	ds_read_b128 v[44:47], v2 offset:5120
	v_smfmac_f32_16x16x64_bf16 v[20:23], v[36:39], v[216:223], v1
	s_waitcnt lgkmcnt(4)
	v_smfmac_f32_16x16x64_bf16 v[8:11], v[28:31], v[104:111], v1
	s_waitcnt lgkmcnt(0)
	v_smfmac_f32_16x16x64_bf16 v[12:15], v[28:31], v[240:247], v1
	v_smfmac_f32_16x16x64_bf16 v[16:19], v[28:31], v[112:119], v1
	v_smfmac_f32_16x16x64_bf16 v[20:23], v[28:31], v[248:255], v1
	v_smfmac_f32_16x16x64_bf16 v[8:11], v[24:27], v[120:127], v1
	v_smfmac_f32_16x16x64_bf16 v[12:15], v[24:27], a[0:7], v1
	v_smfmac_f32_16x16x64_bf16 v[16:19], v[24:27], v[128:135], v1
	v_cvt_pk_bf16_f32 v8, v8, v9
	v_cvt_pk_bf16_f32 v9, v10, v11
	v_smfmac_f32_16x16x64_bf16 v[20:23], v[24:27], a[8:15], v1
	v_cvt_pk_bf16_f32 v10, v12, v13
	v_cvt_pk_bf16_f32 v11, v14, v15
	s_nop 1
	v_mfma_f32_16x16x32_bf16 v[12:15], v[8:11], v[32:35], 0
	v_cvt_pk_bf16_f32 v16, v16, v17
	v_cvt_pk_bf16_f32 v17, v18, v19
	s_nop 0
	v_cvt_pk_bf16_f32 v18, v20, v21
	v_cvt_pk_bf16_f32 v19, v22, v23
	s_nop 1
	v_mfma_f32_16x16x32_bf16 v[20:23], v[16:19], v[32:35], 0
	v_cvt_pk_bf16_f32 v8, v12, v13
	v_cvt_pk_bf16_f32 v9, v14, v15
	v_smfmac_f32_16x16x64_bf16 v[48:51], v[24:27], a[144:151], v1
	ds_read_b128 v[32:35], v3 offset:3072
	s_nop 2
	v_cvt_pk_bf16_f32 v10, v20, v21
	v_cvt_pk_bf16_f32 v11, v22, v23
	s_nop 1
	v_mfma_f32_16x16x32_bf16 v[12:15], v[8:11], v[8:11], 0
	buffer_load_dwordx4 v0, s[4:7], s29 offen offset:0 sc1 lds
	v_mfma_f32_16x16x32_bf16 v[20:23], v[44:47], v[8:11], 0
	buffer_store_dwordx4 v[8:11], v0, s[4:7], s30 offen sc1
	v_mfma_f32_16x16x32_bf16 v[16:19], v[40:43], v[8:11], 0
	v_mov_b32_dpp v12, v14 row_ror:8 row_mask:0xf bank_mask:0xc
	v_mov_b32_dpp v13, v15 row_ror:8 row_mask:0xf bank_mask:0xc
	v_lshrrev_b32 v7, 2, v0
	v_mov_b64 v[46:47], s[100:101]
	v_permlane32_swap_b32 v12, v13
	v_smfmac_f32_16x16x64_bf16 v[52:55], v[24:27], a[152:159], v1
	ds_read_b128 v[24:27], v2 offset:3072
	ds_write_b32 v6, v13 offset:2048
	v_mov_b32_dpp v16, v20 row_ror:8 row_mask:0xf bank_mask:0xc
	v_mov_b32_dpp v17, v21 row_ror:8 row_mask:0xf bank_mask:0xc
	v_mov_b32_dpp v18, v22 row_ror:8 row_mask:0xf bank_mask:0xc
	v_mov_b32_dpp v19, v23 row_ror:8 row_mask:0xf bank_mask:0xc
	v_smfmac_f32_16x16x64_bf16 v[48:51], v[28:31], a[128:135], v1
	ds_write_b128 v2, v[16:19] offset:38400
	v_smfmac_f32_16x16x64_bf16 v[52:55], v[28:31], a[136:143], v1
	ds_read_b128 v[28:31], v5 offset:2048
	buffer_load_dwordx4 v0, s[4:7], s29 offen offset:1024 sc1 lds
	v_smfmac_f32_16x16x64_bf16 v[48:51], v[36:39], a[96:103], v1
	v_smfmac_f32_16x16x64_bf16 v[52:55], v[36:39], a[104:111], v1
	ds_read_b128 v[36:39], v4 offset:2048
	s_waitcnt lgkmcnt(5)
	v_smfmac_f32_16x16x64_bf16 v[48:51], v[32:35], a[64:71], v1
	s_waitcnt lgkmcnt(2)
	s_barrier
	ds_read_b128 v[8:11], v3 offset:38400
	ds_read_b128 v[12:15], v4 offset:38400
	ds_read_b128 v[20:23], v5 offset:38400
	ds_read2st64_b32 v[40:41], v7 offset0:8 offset1:9
	ds_read2st64_b32 v[42:43], v7 offset0:10 offset1:11
	v_smfmac_f32_16x16x64_bf16 v[52:55], v[32:35], a[72:79], v1
	ds_read_b128 v[32:35], v3 offset:2048
	v_smfmac_f32_16x16x64_bf16 v[48:51], v[24:27], a[32:39], v1
	v_smfmac_f32_16x16x64_bf16 v[52:55], v[24:27], a[40:47], v1
	s_waitcnt lgkmcnt(7)
	v_smfmac_f32_16x16x64_bf16 v[48:51], v[28:31], a[112:119], v1
	v_smfmac_f32_16x16x64_bf16 v[52:55], v[28:31], a[120:127], v1
	s_waitcnt lgkmcnt(1)
	v_pk_add_f32 v[8:9], v[8:9], v[16:17]
	v_pk_add_f32 v[10:11], v[10:11], v[18:19]
	v_pk_add_f32 v[12:13], v[12:13], v[20:21]
	v_pk_add_f32 v[14:15], v[14:15], v[22:23]
	v_pk_add_f32 v[40:41], v[40:41], v[42:43]
	v_pk_add_f32 v[8:9], v[8:9], v[12:13]
	v_pk_add_f32 v[10:11], v[10:11], v[14:15]
	v_add_f32 v12, v40, v41
	v_max3_f32 v13, v8, v9, v10
	v_max3_f32 v13, v13, v11, v12
	v_smfmac_f32_16x16x64_bf16 v[48:51], v[36:39], a[80:87], v1
	ds_read_b128 v[16:19], v2 offset:6144
	v_max_f32_dpp v14, v13, v13 row_ror:8 row_mask:0xf bank_mask:0xf
	v_max_f32_dpp v15, v13, v13 row_ror:8 row_mask:0xf bank_mask:0xf
	v_smfmac_f32_16x16x64_bf16 v[52:55], v[36:39], a[88:95], v1
	ds_read_b128 v[20:23], v2 offset:7168
	v_permlane16_swap_b32 v14, v15
	v_max_f32 v13, v14, v15
	v_max_f32 v14, v14, v15
	v_mov_b64 v[36:37], s[98:99]
	v_mov_b64 v[38:39], s[98:99]
	v_permlane32_swap_b32 v13, v14
	s_waitcnt lgkmcnt(2)
	v_smfmac_f32_16x16x64_bf16 v[48:51], v[32:35], a[48:55], v1
	ds_read_b128 v[24:27], v2 offset:24576
	v_max_f32 v13, v13, v14
	v_mul_f32 v13, s43, v13
	v_smfmac_f32_16x16x64_bf16 v[52:55], v[32:35], a[56:63], v1
	ds_read_b128 v[28:31], v2 offset:25600
	v_fma_f32 v8, v8, s43, -v13
	v_fma_f32 v9, v9, s43, -v13
	v_fma_f32 v10, v10, s43, -v13
	v_fma_f32 v11, v11, s43, -v13
	v_fma_f32 v12, v12, s43, -v13
	v_exp_f32 v12, v12
	v_exp_f32 v8, v8
	v_exp_f32 v9, v9
	v_cvt_pk_bf16_f32 v48, v48, v50
	v_cvt_pk_bf16_f32 v49, v49, v51
	v_exp_f32 v10, v10
	v_mov_b32_dpp v13, v12 row_ror:8 row_mask:0xf bank_mask:0xf
	v_exp_f32 v11, v11
	v_cvt_pk_bf16_f32 v40, v8, v9
	v_cvt_pk_bf16_f32 v41, v10, v11
	v_cvt_pk_bf16_f32 v50, v52, v54
	v_mov_b32_dpp v42, v40 row_ror:8 row_mask:0xf bank_mask:0xf
	v_mov_b32_dpp v43, v41 row_ror:8 row_mask:0xf bank_mask:0xf
	v_cvt_pk_bf16_f32 v44, v12, v13
	v_cvt_pk_bf16_f32 v45, v12, v13
	v_mfma_f32_16x16x32_bf16 v[8:11], v[36:39], v[40:43], 0
	v_cvt_pk_bf16_f32 v51, v53, v55
	v_permlane32_swap_b32 v44, v45
	s_waitcnt lgkmcnt(3)
	v_mfma_f32_16x16x32_bf16 v[32:35], v[16:19], v[40:43], 0
	buffer_store_dwordx4 v[48:51], v0, s[4:7], s30 offen offset:1024 sc1
	s_waitcnt lgkmcnt(2)
	v_mfma_f32_16x16x32_bf16 v[36:39], v[20:23], v[40:43], 0
	ds_read_b128 v[16:19], v2 offset:26624
	v_mfma_f32_16x16x16_bf16 v[8:11], v[46:47], v[44:45], v[8:11]
	v_mov_b64 v[12:13], 0
	v_mov_b64 v[14:15], 0
	v_mfma_f32_16x16x16_bf16 v[32:35], v[48:49], v[44:45], v[32:35]
	v_mov_b64 v[40:41], 0
	v_mov_b64 v[42:43], 0
	v_mfma_f32_16x16x16_bf16 v[36:39], v[50:51], v[44:45], v[36:39]
	v_rcp_f32 v52, v8
	ds_read_b128 v[20:23], v2 offset:27648
	s_nop 1
	v_pk_mul_f32 v[32:33], v[32:33], v[52:53] op_sel_hi:[1,0]
	v_pk_mul_f32 v[34:35], v[34:35], v[52:53] op_sel_hi:[1,0]
	v_cvt_pk_bf16_f32 v32, v32, v33
	v_cvt_pk_bf16_f32 v33, v34, v35
	v_pk_mul_f32 v[36:37], v[36:37], v[52:53] op_sel_hi:[1,0]
	v_pk_mul_f32 v[38:39], v[38:39], v[52:53] op_sel_hi:[1,0]
	v_cvt_pk_bf16_f32 v34, v36, v37
	v_cvt_pk_bf16_f32 v35, v38, v39
	v_mov_b32_dpp v32, v32 row_ror:8 row_mask:0xf bank_mask:0xc
	v_mov_b32_dpp v33, v33 row_ror:8 row_mask:0xf bank_mask:0xc
	v_mov_b32_dpp v34, v34 row_ror:8 row_mask:0xf bank_mask:0xc
	v_mov_b32_dpp v35, v35 row_ror:8 row_mask:0xf bank_mask:0xc
	ds_write_b128 v2, v[32:35] offset:37376
	s_nop 0
	v_smfmac_f32_16x16x64_bf16 v[40:43], v[32:35], a[208:215], v1
	buffer_load_dwordx4 v0, s[4:7], s29 offen offset:2048 sc1 lds
	s_cmp_eq_u32 s28, 63
	s_waitcnt lgkmcnt(1)
	v_smfmac_f32_16x16x64_bf16 v[12:15], v[32:35], v[16:23], v1
	buffer_load_dwordx4 v0, s[4:7], s29 offen offset:3072 sc1 lds
	s_cbranch_scc1 chain_end
	v_mov_b64 v[8:9], 0
	v_mov_b64 v[10:11], 0
	v_mov_b64 v[44:45], 0
	v_mov_b64 v[46:47], 0
	s_waitcnt lgkmcnt(0)
	s_barrier
	ds_read_b128 v[36:39], v3 offset:37376
	ds_read_b128 v[52:55], v4 offset:37376
	ds_read_b128 v[48:51], v5 offset:37376
	v_smfmac_f32_16x16x64_bf16 v[8:11], v[32:35], v[24:31], v1
	v_smfmac_f32_16x16x64_bf16 v[44:47], v[32:35], a[232:239], v1
	ds_read_b128 v[32:35], v0 offset:3072
	s_waitcnt lgkmcnt(3)
	v_smfmac_f32_16x16x64_bf16 v[8:11], v[36:39], a[160:167], v1
	ds_read_b128 v[24:27], v2 offset:28672
	v_smfmac_f32_16x16x64_bf16 v[12:15], v[36:39], a[184:191], v1
	ds_read_b128 v[28:31], v2 offset:29696
	s_waitcnt lgkmcnt(4)
	v_smfmac_f32_16x16x64_bf16 v[8:11], v[52:55], a[168:175], v1
	ds_read_b128 v[16:19], v2 offset:30720
	v_smfmac_f32_16x16x64_bf16 v[12:15], v[52:55], a[192:199], v1
	ds_read_b128 v[20:23], v2 offset:31744
	s_waitcnt lgkmcnt(5)
	v_smfmac_f32_16x16x64_bf16 v[8:11], v[48:51], a[176:183], v1
	s_add_u32 s41, s41, 0x4000
	s_and_b32 s41, s41, 0xc000
	v_smfmac_f32_16x16x64_bf16 v[12:15], v[48:51], a[200:207], v1
	s_waitcnt lgkmcnt(2)
	v_smfmac_f32_16x16x64_bf16 v[40:43], v[36:39], v[24:31], v1
	v_cvt_pk_bf16_f32 v8, v8, v9
	v_cvt_pk_bf16_f32 v9, v10, v11
	v_bfi_b32 v8, 1, s59, v8
	s_nop 0
	v_cvt_pk_bf16_f32 v10, v12, v13
	v_cvt_pk_bf16_f32 v11, v14, v15
	buffer_store_dwordx4 v[8:11], v0, s[4:7], s32 offen offset:0 sc1
	ds_read_b128 v[12:15], v32
	s_waitcnt lgkmcnt(1)
	v_smfmac_f32_16x16x64_bf16 v[44:47], v[36:39], v[16:23], v1
	ds_read_b128 v[24:27], v2 offset:32768
	ds_read_b128 v[28:31], v2 offset:33792
	v_smfmac_f32_16x16x64_bf16 v[40:43], v[52:55], a[216:223], v1
	ds_read_b128 v[36:39], v34
	ds_read_b128 v[16:19], v2 offset:34816
	v_smfmac_f32_16x16x64_bf16 v[44:47], v[52:55], a[240:247], v1
	ds_read_b128 v[20:23], v2 offset:35840
	v_mov_b64 v[8:9], 0
	v_mov_b64 v[10:11], 0
	v_smfmac_f32_16x16x64_bf16 v[40:43], v[48:51], a[224:231], v1
	ds_read_b32 v32, v6 offset:5120
	s_waitcnt lgkmcnt(4)
	v_smfmac_f32_16x16x64_bf16 v[8:11], v[12:15], v[24:31], v1
	v_smfmac_f32_16x16x64_bf16 v[44:47], v[48:51], a[248:255], v1
	s_waitcnt lgkmcnt(1)
	v_smfmac_f32_16x16x64_bf16 v[8:11], v[36:39], v[16:23], v1
	ds_read_b128 v[36:39], v0 offset:1024
	s_cmp_lg_u32 s93, 0
	v_cvt_pk_bf16_f32 v40, v40, v41
	v_cvt_pk_bf16_f32 v41, v42, v43
	v_bfi_b32 v40, 1, s59, v40
	v_cvt_pk_bf16_f32 v42, v44, v45
	v_cvt_pk_bf16_f32 v43, v46, v47
	buffer_store_dwordx4 v[40:43], v0, s[4:7], s32 offen offset:1024 sc1
	v_cvt_pk_bf16_f32 v8, v8, v9
	v_cvt_pk_bf16_f32 v9, v10, v11
	v_bfi_b32 v8, 1, s59, v8
	buffer_store_dwordx2 v[8:9], v35, s[4:7], s32 offen offset:2048 sc1
	s_cbranch_scc1 chain_late_s
	s_add_u32 s37, s41, s92
	s_add_u32 s39, s41, s94
	s_add_u32 s40, s41, s56
	s_add_u32 s57, s39, 3072
	s_mov_b32 m0, s31
	s_add_u32 s28, s28, 1
	s_add_u32 s30, s30, 262144
	s_add_u32 s29, s29, 524288
	s_xor_b32 s32, s32, 0x80000
	s_xor_b32 s48, s41, 0x8000
	s_add_u32 s48, s48, s92
	s_waitcnt vmcnt(2)
	buffer_load_dwordx4 v[24:27], v33, s[4:7], s33 offen sc1
	buffer_load_dwordx4 v[28:31], v33, s[4:7], s34 offen sc1
	buffer_load_dwordx4 v[16:19], v33, s[4:7], s35 offen sc1
	buffer_load_dwordx4 v[20:23], v33, s[4:7], s38 offen sc1
	s_waitcnt vmcnt(5)
	buffer_load_dwordx4 v[48:51], v33, s[4:7], s33 offen sc1
	buffer_load_dwordx4 v[52:55], v33, s[4:7], s34 offen sc1
	buffer_load_dwordx4 v[44:47], v33, s[4:7], s35 offen sc1
	buffer_load_dwordx4 v[40:43], v33, s[4:7], s38 offen sc1
	s_waitcnt lgkmcnt(0)
	s_waitcnt vmcnt(7)
	v_mfma_f32_16x16x32_bf16 v[12:15], v[36:39], v[24:27], 0
	s_waitcnt vmcnt(6)
	v_mfma_f32_16x16x32_bf16 v[12:15], v[36:39], v[28:31], v[12:15]
	v_bitop3_b32 v7, v24, v28, s59 bitop3:0x7e
	s_waitcnt vmcnt(5)
	v_mfma_f32_16x16x32_bf16 v[12:15], v[36:39], v[16:19], v[12:15]
	s_waitcnt vmcnt(4)
	v_mfma_f32_16x16x32_bf16 v[12:15], v[36:39], v[20:23], v[12:15]
	v_bitop3_b32 v8, v16, v20, s59 bitop3:0x7e
	v_bitop3_b32 v7, v7, v8, 1 bitop3:0xa8
	v_cmp_ne_u32 vcc, 0, v7
	s_cbranch_vccnz chain_rea_s
	s_nop 3
	v_add_f32_dpp v12, v12, v12 row_ror:8 row_mask:0xf bank_mask:0xf
	v_add_f32_dpp v13, v13, v13 row_ror:8 row_mask:0xf bank_mask:0xf
	v_cvt_pk_bf16_f32 v12, v12, v13
	buffer_store_dword v12, v32, s[4:7], s37 offen sc1
	v_mov_b32 v8, -1
	buffer_store_dword v8, v32, s[4:7], s48 offen sc1
chain_eb_s:
	s_waitcnt vmcnt(2)
	ds_read_b128 v[40:43], v2 offset:0
	ds_read_b128 v[44:47], v2 offset:1024
	ds_read_b128 v[32:35], v2 offset:8192
	ds_read_b128 v[36:39], v2 offset:9216
	ds_read_b32 v7, v2 offset:37120
	s_xor_b32 s33, s33, 0x80000
	s_xor_b32 s34, s34, 0x80000
	s_xor_b32 s35, s35, 0x80000
	s_xor_b32 s38, s38, 0x80000
	s_bfe_u32 s59, s28, 0x10001
	v_mov_b64 v[8:9], 0
	v_mov_b64 v[10:11], 0
	v_mov_b64 v[12:13], 0
	v_mov_b64 v[14:15], 0
	v_mov_b64 v[16:17], 0
	v_mov_b64 v[18:19], 0
	v_mov_b64 v[20:21], 0
	v_mov_b64 v[22:23], 0
	v_mov_b64 v[48:49], 0
	v_mov_b64 v[50:51], 0
	v_mov_b64 v[52:53], 0
	v_mov_b64 v[54:55], 0
	s_waitcnt lgkmcnt(0)
	v_readfirstlane_b32 s95, v7
	s_add_u32 s46, s28, 2
	s_min_u32 s46, s46, 64
	s_barrier
	buffer_load_dwordx4 v0, s[4:7], s39 offen sc1 lds
	s_waitcnt vmcnt(0) lgkmcnt(0)
	buffer_load_dwordx4 v0, s[4:7], s39 offen sc1 lds
	ds_read_b128 v[24:27], v2 offset:2048
	s_mov_b32 m0, s36
	s_branch chain_h2r_s
chain_late_s:
	s_cmp_eq_u32 s93, 2
	s_cbranch_scc0 chain_tail_s
	s_waitcnt vmcnt(1)
	buffer_load_dwordx4 v[24:27], v33, s[4:7], s33 offen sc1
	buffer_load_dwordx4 v[28:31], v33, s[4:7], s34 offen sc1
	buffer_load_dwordx4 v[16:19], v33, s[4:7], s35 offen sc1
	buffer_load_dwordx4 v[20:23], v33, s[4:7], s38 offen sc1
	s_add_u32 s37, s41, s92
	s_add_u32 s39, s41, s94
	s_add_u32 s40, s41, s56
	s_add_u32 s57, s39, 3072
	s_mov_b32 m0, s31
	s_add_u32 s28, s28, 1
	s_add_u32 s30, s30, 262144
	s_add_u32 s29, s29, 524288
	s_xor_b32 s32, s32, 0x80000
	s_xor_b32 s48, s41, 0x8000
	s_add_u32 s48, s48, s92
	buffer_load_dwordx4 v[48:51], v33, s[4:7], s33 offen sc1
	buffer_load_dwordx4 v[52:55], v33, s[4:7], s34 offen sc1
	buffer_load_dwordx4 v[44:47], v33, s[4:7], s35 offen sc1
	buffer_load_dwordx4 v[40:43], v33, s[4:7], s38 offen sc1
	s_waitcnt lgkmcnt(0)
	s_waitcnt vmcnt(7)
	v_mfma_f32_16x16x32_bf16 v[12:15], v[36:39], v[24:27], 0
	s_waitcnt vmcnt(6)
	v_mfma_f32_16x16x32_bf16 v[12:15], v[36:39], v[28:31], v[12:15]
	v_bitop3_b32 v7, v24, v28, s59 bitop3:0x7e
	s_waitcnt vmcnt(5)
	v_mfma_f32_16x16x32_bf16 v[12:15], v[36:39], v[16:19], v[12:15]
	s_waitcnt vmcnt(4)
	v_mfma_f32_16x16x32_bf16 v[12:15], v[36:39], v[20:23], v[12:15]
	v_bitop3_b32 v8, v16, v20, s59 bitop3:0x7e
	v_bitop3_b32 v7, v7, v8, 1 bitop3:0xa8
	v_cmp_ne_u32 vcc, 0, v7
	s_cbranch_vccnz chain_rla_s
	s_nop 3
	v_add_f32_dpp v12, v12, v12 row_ror:8 row_mask:0xf bank_mask:0xf
	v_add_f32_dpp v13, v13, v13 row_ror:8 row_mask:0xf bank_mask:0xf
	v_cvt_pk_bf16_f32 v12, v12, v13
	buffer_store_dword v12, v32, s[4:7], s37 offen sc1
	v_mov_b32 v8, -1
	buffer_store_dword v8, v32, s[4:7], s48 offen sc1
chain_lb_s:
	s_branch chain_e0_s
chain_tail_s:
	s_cmp_eq_u32 s93, 3
	s_cbranch_scc1 chain_idle_s
	s_waitcnt vmcnt(0)
	buffer_load_dwordx4 v[24:27], v33, s[4:7], s33 offen sc1
	buffer_load_dwordx4 v[28:31], v33, s[4:7], s34 offen sc1
	buffer_load_dwordx4 v[16:19], v33, s[4:7], s35 offen sc1
	buffer_load_dwordx4 v[20:23], v33, s[4:7], s38 offen sc1
	s_add_u32 s37, s41, s92
	s_add_u32 s39, s41, s94
	s_add_u32 s40, s41, s56
	s_add_u32 s57, s39, 3072
	s_mov_b32 m0, s31
	s_add_u32 s28, s28, 1
	s_add_u32 s30, s30, 262144
	s_add_u32 s29, s29, 524288
	s_xor_b32 s32, s32, 0x80000
	s_xor_b32 s48, s41, 0x8000
	s_add_u32 s48, s48, s92
	buffer_load_dwordx4 v[48:51], v33, s[4:7], s33 offen sc1
	buffer_load_dwordx4 v[52:55], v33, s[4:7], s34 offen sc1
	buffer_load_dwordx4 v[44:47], v33, s[4:7], s35 offen sc1
	buffer_load_dwordx4 v[40:43], v33, s[4:7], s38 offen sc1
	s_waitcnt lgkmcnt(0)
	s_waitcnt vmcnt(7)
	v_mfma_f32_16x16x32_bf16 v[12:15], v[36:39], v[24:27], 0
	v_bitop3_b32 v7, v24, v26, s59 bitop3:0x7e
	s_waitcnt vmcnt(6)
	v_mfma_f32_16x16x32_bf16 v[12:15], v[36:39], v[28:31], v[12:15]
	v_bitop3_b32 v8, v28, v30, s59 bitop3:0x7e
	s_waitcnt vmcnt(5)
	v_mfma_f32_16x16x32_bf16 v[12:15], v[36:39], v[16:19], v[12:15]
	v_bitop3_b32 v9, v16, v18, s59 bitop3:0x7e
	v_or3_b32 v7, v7, v8, v9
	s_waitcnt vmcnt(4)
	v_mfma_f32_16x16x32_bf16 v[12:15], v[36:39], v[20:23], v[12:15]
	v_bitop3_b32 v8, v20, v22, s59 bitop3:0x7e
	v_bitop3_b32 v7, v7, v8, 1 bitop3:0xa8
	v_cmp_ne_u32 vcc, 0, v7
	s_cbranch_vccnz chain_rza_s
	s_nop 3
	v_add_f32_dpp v12, v12, v12 row_ror:4 row_mask:0xf bank_mask:0xf
	v_add_f32_dpp v13, v13, v13 row_ror:4 row_mask:0xf bank_mask:0xf
	s_nop 0
	v_add_f32_dpp v12, v12, v12 row_ror:8 row_mask:0xf bank_mask:0xf
	v_add_f32_dpp v13, v13, v13 row_ror:8 row_mask:0xf bank_mask:0xf
	v_cvt_pk_bf16_f32 v12, v12, v13
	buffer_store_dword v12, v32, s[4:7], s37 offen sc1
	v_mov_b32 v8, -1
	buffer_store_dword v8, v32, s[4:7], s48 offen sc1
chain_zb_s:
	s_branch chain_e0_s
chain_idle_s:
	s_add_u32 s37, s41, s92
	s_add_u32 s39, s41, s94
	s_add_u32 s40, s41, s56
	s_add_u32 s57, s39, 3072
	s_mov_b32 m0, s31
	s_add_u32 s28, s28, 1
	s_add_u32 s30, s30, 262144
	s_add_u32 s29, s29, 524288
	s_xor_b32 s32, s32, 0x80000
	s_xor_b32 s48, s41, 0x8000
	s_add_u32 s48, s48, s92
	s_waitcnt vmcnt(0)
	s_waitcnt lgkmcnt(0)
	s_branch chain_e0_s
chain_rea_s:
	s_waitcnt vmcnt(0)
	v_mfma_f32_16x16x32_bf16 v[12:15], v[36:39], v[48:51], 0
	v_mfma_f32_16x16x32_bf16 v[12:15], v[36:39], v[52:55], v[12:15]
	v_bitop3_b32 v7, v48, v52, s59 bitop3:0x7e
	v_mfma_f32_16x16x32_bf16 v[12:15], v[36:39], v[44:47], v[12:15]
	v_mfma_f32_16x16x32_bf16 v[12:15], v[36:39], v[40:43], v[12:15]
	v_bitop3_b32 v8, v44, v40, s59 bitop3:0x7e
	v_bitop3_b32 v7, v7, v8, 1 bitop3:0xa8
	v_cmp_ne_u32 vcc, 0, v7
	s_cbranch_vccnz chain_rec_s
	s_nop 3
	v_add_f32_dpp v12, v12, v12 row_ror:8 row_mask:0xf bank_mask:0xf
	v_add_f32_dpp v13, v13, v13 row_ror:8 row_mask:0xf bank_mask:0xf
	v_cvt_pk_bf16_f32 v12, v12, v13
	buffer_store_dword v12, v32, s[4:7], s37 offen sc1
	v_mov_b32 v8, -1
	buffer_store_dword v8, v32, s[4:7], s48 offen sc1
	s_branch chain_eb_s
chain_rec_s:
	s_sub_u32 s42, s42, 1
	s_cbranch_scc1 chain_end
	buffer_load_dwordx4 v[24:27], v33, s[4:7], s33 offen sc1
	buffer_load_dwordx4 v[28:31], v33, s[4:7], s34 offen sc1
	buffer_load_dwordx4 v[16:19], v33, s[4:7], s35 offen sc1
	buffer_load_dwordx4 v[20:23], v33, s[4:7], s38 offen sc1
	s_waitcnt vmcnt(0)
	v_mfma_f32_16x16x32_bf16 v[12:15], v[36:39], v[24:27], 0
	v_mfma_f32_16x16x32_bf16 v[12:15], v[36:39], v[28:31], v[12:15]
	v_bitop3_b32 v7, v24, v28, s59 bitop3:0x7e
	v_mfma_f32_16x16x32_bf16 v[12:15], v[36:39], v[16:19], v[12:15]
	v_mfma_f32_16x16x32_bf16 v[12:15], v[36:39], v[20:23], v[12:15]
	v_bitop3_b32 v8, v16, v20, s59 bitop3:0x7e
	v_bitop3_b32 v7, v7, v8, 1 bitop3:0xa8
	v_cmp_ne_u32 vcc, 0, v7
	s_cbranch_vccnz chain_rec_s
	s_nop 3
	v_add_f32_dpp v12, v12, v12 row_ror:8 row_mask:0xf bank_mask:0xf
	v_add_f32_dpp v13, v13, v13 row_ror:8 row_mask:0xf bank_mask:0xf
	v_cvt_pk_bf16_f32 v12, v12, v13
	buffer_store_dword v12, v32, s[4:7], s37 offen sc1
	v_mov_b32 v8, -1
	buffer_store_dword v8, v32, s[4:7], s48 offen sc1
	s_branch chain_eb_s
chain_rla_s:
	s_waitcnt vmcnt(0)
	v_mfma_f32_16x16x32_bf16 v[12:15], v[36:39], v[48:51], 0
	v_mfma_f32_16x16x32_bf16 v[12:15], v[36:39], v[52:55], v[12:15]
	v_bitop3_b32 v7, v48, v52, s59 bitop3:0x7e
	v_mfma_f32_16x16x32_bf16 v[12:15], v[36:39], v[44:47], v[12:15]
	v_mfma_f32_16x16x32_bf16 v[12:15], v[36:39], v[40:43], v[12:15]
	v_bitop3_b32 v8, v44, v40, s59 bitop3:0x7e
	v_bitop3_b32 v7, v7, v8, 1 bitop3:0xa8
	v_cmp_ne_u32 vcc, 0, v7
	s_cbranch_vccnz chain_rlc_s
	s_nop 3
	v_add_f32_dpp v12, v12, v12 row_ror:8 row_mask:0xf bank_mask:0xf
	v_add_f32_dpp v13, v13, v13 row_ror:8 row_mask:0xf bank_mask:0xf
	v_cvt_pk_bf16_f32 v12, v12, v13
	buffer_store_dword v12, v32, s[4:7], s37 offen sc1
	v_mov_b32 v8, -1
	buffer_store_dword v8, v32, s[4:7], s48 offen sc1
	s_branch chain_lb_s
chain_rlc_s:
	s_sub_u32 s42, s42, 1
	s_cbranch_scc1 chain_end
	buffer_load_dwordx4 v[24:27], v33, s[4:7], s33 offen sc1
	buffer_load_dwordx4 v[28:31], v33, s[4:7], s34 offen sc1
	buffer_load_dwordx4 v[16:19], v33, s[4:7], s35 offen sc1
	buffer_load_dwordx4 v[20:23], v33, s[4:7], s38 offen sc1
	s_waitcnt vmcnt(0)
	v_mfma_f32_16x16x32_bf16 v[12:15], v[36:39], v[24:27], 0
	v_mfma_f32_16x16x32_bf16 v[12:15], v[36:39], v[28:31], v[12:15]
	v_bitop3_b32 v7, v24, v28, s59 bitop3:0x7e
	v_mfma_f32_16x16x32_bf16 v[12:15], v[36:39], v[16:19], v[12:15]
	v_mfma_f32_16x16x32_bf16 v[12:15], v[36:39], v[20:23], v[12:15]
	v_bitop3_b32 v8, v16, v20, s59 bitop3:0x7e
	v_bitop3_b32 v7, v7, v8, 1 bitop3:0xa8
	v_cmp_ne_u32 vcc, 0, v7
	s_cbranch_vccnz chain_rlc_s
	s_nop 3
	v_add_f32_dpp v12, v12, v12 row_ror:8 row_mask:0xf bank_mask:0xf
	v_add_f32_dpp v13, v13, v13 row_ror:8 row_mask:0xf bank_mask:0xf
	v_cvt_pk_bf16_f32 v12, v12, v13
	buffer_store_dword v12, v32, s[4:7], s37 offen sc1
	v_mov_b32 v8, -1
	buffer_store_dword v8, v32, s[4:7], s48 offen sc1
	s_branch chain_lb_s
chain_rza_s:
	s_waitcnt vmcnt(0)
	v_mfma_f32_16x16x32_bf16 v[12:15], v[36:39], v[48:51], 0
	v_bitop3_b32 v7, v48, v50, s59 bitop3:0x7e
	v_mfma_f32_16x16x32_bf16 v[12:15], v[36:39], v[52:55], v[12:15]
	v_bitop3_b32 v8, v52, v54, s59 bitop3:0x7e
	v_mfma_f32_16x16x32_bf16 v[12:15], v[36:39], v[44:47], v[12:15]
	v_bitop3_b32 v9, v44, v46, s59 bitop3:0x7e
	v_or3_b32 v7, v7, v8, v9
	v_mfma_f32_16x16x32_bf16 v[12:15], v[36:39], v[40:43], v[12:15]
	v_bitop3_b32 v8, v40, v42, s59 bitop3:0x7e
	v_bitop3_b32 v7, v7, v8, 1 bitop3:0xa8
	v_cmp_ne_u32 vcc, 0, v7
	s_cbranch_vccnz chain_rzc_s
	s_nop 3
	v_add_f32_dpp v12, v12, v12 row_ror:4 row_mask:0xf bank_mask:0xf
	v_add_f32_dpp v13, v13, v13 row_ror:4 row_mask:0xf bank_mask:0xf
	s_nop 0
	v_add_f32_dpp v12, v12, v12 row_ror:8 row_mask:0xf bank_mask:0xf
	v_add_f32_dpp v13, v13, v13 row_ror:8 row_mask:0xf bank_mask:0xf
	v_cvt_pk_bf16_f32 v12, v12, v13
	buffer_store_dword v12, v32, s[4:7], s37 offen sc1
	v_mov_b32 v8, -1
	buffer_store_dword v8, v32, s[4:7], s48 offen sc1
	s_branch chain_zb_s
chain_rzc_s:
	s_sub_u32 s42, s42, 1
	s_cbranch_scc1 chain_end
	buffer_load_dwordx4 v[24:27], v33, s[4:7], s33 offen sc1
	buffer_load_dwordx4 v[28:31], v33, s[4:7], s34 offen sc1
	buffer_load_dwordx4 v[16:19], v33, s[4:7], s35 offen sc1
	buffer_load_dwordx4 v[20:23], v33, s[4:7], s38 offen sc1
	s_waitcnt vmcnt(0)
	v_mfma_f32_16x16x32_bf16 v[12:15], v[36:39], v[24:27], 0
	v_bitop3_b32 v7, v24, v26, s59 bitop3:0x7e
	v_mfma_f32_16x16x32_bf16 v[12:15], v[36:39], v[28:31], v[12:15]
	v_bitop3_b32 v8, v28, v30, s59 bitop3:0x7e
	v_mfma_f32_16x16x32_bf16 v[12:15], v[36:39], v[16:19], v[12:15]
	v_bitop3_b32 v9, v16, v18, s59 bitop3:0x7e
	v_or3_b32 v7, v7, v8, v9
	v_mfma_f32_16x16x32_bf16 v[12:15], v[36:39], v[20:23], v[12:15]
	v_bitop3_b32 v8, v20, v22, s59 bitop3:0x7e
	v_bitop3_b32 v7, v7, v8, 1 bitop3:0xa8
	v_cmp_ne_u32 vcc, 0, v7
	s_cbranch_vccnz chain_rzc_s
	s_nop 3
	v_add_f32_dpp v12, v12, v12 row_ror:4 row_mask:0xf bank_mask:0xf
	v_add_f32_dpp v13, v13, v13 row_ror:4 row_mask:0xf bank_mask:0xf
	s_nop 0
	v_add_f32_dpp v12, v12, v12 row_ror:8 row_mask:0xf bank_mask:0xf
	v_add_f32_dpp v13, v13, v13 row_ror:8 row_mask:0xf bank_mask:0xf
	v_cvt_pk_bf16_f32 v12, v12, v13
	buffer_store_dword v12, v32, s[4:7], s37 offen sc1
	v_mov_b32 v8, -1
	buffer_store_dword v8, v32, s[4:7], s48 offen sc1
	s_branch chain_zb_s
chain_r2e_s:
	s_mov_b32 m0, s31
	s_nop 5
	v_mov_b64 v[8:9], 0
	v_mov_b64 v[10:11], 0
	v_mov_b64 v[12:13], 0
	v_mov_b64 v[14:15], 0
chain_r2e2_s:
	buffer_load_dwordx4 v0, s[4:7], s39 offen sc1 lds
	s_waitcnt vmcnt(3)
	ds_read_b128 v[24:27], v2 offset:2048
	s_sub_u32 s42, s42, 1
	s_cbranch_scc1 chain_end
	s_waitcnt lgkmcnt(0)
	v_max3_u32 v7, v24, v25, v26
	v_max_u32 v7, v7, v27
	v_cmp_eq_u32 vcc, -1, v7
	s_cbranch_vccnz chain_r2e2_s
	s_mov_b32 m0, s36
	v_smfmac_f32_16x16x64_bf16 v[12:15], v[24:27], v[40:47], v1
	v_smfmac_f32_16x16x64_bf16 v[8:11], v[24:27], v[32:39], v1
	s_branch chain_eok_s
chain_r2l_s:
	s_sub_u32 s42, s42, 1
	s_cbranch_scc1 chain_end
	buffer_load_dwordx4 v0, s[4:7], s57 offen offset:1024 sc1 lds
	s_mov_b32 m0, s36
	s_nop 0
	buffer_load_dword v6, s[4:7], s40 offen sc1 lds
	s_mov_b32 m0, s31
	s_waitcnt vmcnt(0)
	ds_read_b128 v[24:27], v2 offset:3072
	ds_read_b32 v7, v6 offset:4096
	s_waitcnt lgkmcnt(0)
	v_max3_u32 v7, v7, v24, v25
	v_max3_u32 v7, v7, v26, v27
	v_cmp_eq_u32 vcc, -1, v7
	s_cbranch_vccnz chain_r2l_s
	s_branch chain_lok_s
chain_kvw_s:
	s_mov_b64 exec, 1
	s_mov_b32 m0, s97
	s_nop 0
	buffer_load_dword off, s[4:7], s96 offset:256 sc1 lds
	s_mov_b64 exec, -1
	s_sub_u32 s42, s42, 1
	s_cbranch_scc1 chain_end
	s_waitcnt vmcnt(0)
	ds_read_b32 v7, v2 offset:37120
	s_waitcnt lgkmcnt(0)
	v_readfirstlane_b32 s95, v7
	s_cmp_lt_u32 s95, s46
	s_cbranch_scc1 chain_kvw_s
	v_lshlrev_b32 v7, 2, v0
	s_branch chain_kvok_s
chain_end:
	s_waitcnt vmcnt(0) lgkmcnt(0)
	s_add_u32 s44, s28, 1
chain_exit:
	s_branch all_exit
kv_entry:
	v_add_u32 v8, 1024, v0
	global_load_dwordx4 v[100:103], v8, s[64:65]
	global_load_dwordx4 v[104:107], v8, s[64:65] offset:1024
	s_load_dwordx2 s[8:9], s[0:1], 24
	s_mov_b32 s10, 4718592
	s_mov_b32 s11, 0x00020000
	s_load_dwordx2 s[12:13], s[0:1], 32
	s_mov_b32 s14, 4718592
	s_mov_b32 s15, 0x00020000
	s_lshl_b32 s48, s26, 17
	s_lshl_b32 s36, s27, 8
	s_add_u32 s48, s48, s36
	s_add_u32 s49, s48, 0
	s_waitcnt vmcnt(0) lgkmcnt(0)
	s_add_u32 s36, s48, 0
	s_add_u32 m0, s44, 0
	s_nop 0
	buffer_load_dwordx4 v100, s[8:11], s36 offen nt lds
	s_add_u32 s36, s48, 32768
	s_add_u32 m0, s44, 1024
	s_nop 0
	buffer_load_dwordx4 v100, s[8:11], s36 offen nt lds
	s_add_u32 s36, s48, 65536
	s_add_u32 m0, s44, 2048
	s_nop 0
	buffer_load_dwordx4 v100, s[8:11], s36 offen nt lds
	s_add_u32 s36, s48, 98304
	s_add_u32 m0, s44, 3072
	s_nop 0
	buffer_load_dwordx4 v100, s[8:11], s36 offen nt lds
	s_add_u32 s36, s48, 524288
	s_add_u32 m0, s44, 16384
	s_nop 0
	buffer_load_dwordx4 v100, s[8:11], s36 offen nt lds
	s_add_u32 s36, s48, 557056
	s_add_u32 m0, s44, 17408
	s_nop 0
	buffer_load_dwordx4 v100, s[8:11], s36 offen nt lds
	s_add_u32 s36, s48, 589824
	s_add_u32 m0, s44, 18432
	s_nop 0
	buffer_load_dwordx4 v100, s[8:11], s36 offen nt lds
	s_add_u32 s36, s48, 622592
	s_add_u32 m0, s44, 19456
	s_nop 0
	buffer_load_dwordx4 v100, s[8:11], s36 offen nt lds
	s_add_u32 s36, s48, 1048576
	s_add_u32 m0, s44, 32768
	s_nop 0
	buffer_load_dwordx4 v100, s[8:11], s36 offen nt lds
	s_add_u32 s36, s48, 1081344
	s_add_u32 m0, s44, 33792
	s_nop 0
	buffer_load_dwordx4 v100, s[8:11], s36 offen nt lds
	s_add_u32 s36, s48, 1114112
	s_add_u32 m0, s44, 34816
	s_nop 0
	buffer_load_dwordx4 v100, s[8:11], s36 offen nt lds
	s_add_u32 s36, s48, 1146880
	s_add_u32 m0, s44, 35840
	s_nop 0
	buffer_load_dwordx4 v100, s[8:11], s36 offen nt lds
	s_add_u32 s36, s48, 1572864
	s_add_u32 m0, s44, 49152
	s_nop 0
	buffer_load_dwordx4 v100, s[8:11], s36 offen nt lds
	s_add_u32 s36, s48, 1605632
	s_add_u32 m0, s44, 50176
	s_nop 0
	buffer_load_dwordx4 v100, s[8:11], s36 offen nt lds
	s_add_u32 s36, s48, 1638400
	s_add_u32 m0, s44, 51200
	s_nop 0
	buffer_load_dwordx4 v100, s[8:11], s36 offen nt lds
	s_add_u32 s36, s48, 1671168
	s_add_u32 m0, s44, 52224
	s_nop 0
	buffer_load_dwordx4 v100, s[8:11], s36 offen nt lds
	s_add_u32 s36, s48, 2097152
	s_add_u32 m0, s44, 65536
	s_nop 0
	buffer_load_dwordx4 v100, s[8:11], s36 offen nt lds
	s_add_u32 s36, s48, 2129920
	s_add_u32 m0, s44, 66560
	s_nop 0
	buffer_load_dwordx4 v100, s[8:11], s36 offen nt lds
	s_add_u32 s36, s48, 2162688
	s_add_u32 m0, s44, 67584
	s_nop 0
	buffer_load_dwordx4 v100, s[8:11], s36 offen nt lds
	s_add_u32 s36, s48, 2195456
	s_add_u32 m0, s44, 68608
	s_nop 0
	buffer_load_dwordx4 v100, s[8:11], s36 offen nt lds
	s_add_u32 s36, s48, 2621440
	s_add_u32 m0, s44, 81920
	s_nop 0
	buffer_load_dwordx4 v100, s[8:11], s36 offen nt lds
	s_add_u32 s36, s48, 2654208
	s_add_u32 m0, s44, 82944
	s_nop 0
	buffer_load_dwordx4 v100, s[8:11], s36 offen nt lds
	s_add_u32 s36, s48, 2686976
	s_add_u32 m0, s44, 83968
	s_nop 0
	buffer_load_dwordx4 v100, s[8:11], s36 offen nt lds
	s_add_u32 s36, s48, 2719744
	s_add_u32 m0, s44, 84992
	s_nop 0
	buffer_load_dwordx4 v100, s[8:11], s36 offen nt lds
	s_add_u32 s36, s48, 3145728
	s_add_u32 m0, s44, 98304
	s_nop 0
	buffer_load_dwordx4 v100, s[8:11], s36 offen nt lds
	s_add_u32 s36, s48, 3178496
	s_add_u32 m0, s44, 99328
	s_nop 0
	buffer_load_dwordx4 v100, s[8:11], s36 offen nt lds
	s_add_u32 s36, s48, 3211264
	s_add_u32 m0, s44, 100352
	s_nop 0
	buffer_load_dwordx4 v100, s[8:11], s36 offen nt lds
	s_add_u32 s36, s48, 3244032
	s_add_u32 m0, s44, 101376
	s_nop 0
	buffer_load_dwordx4 v100, s[8:11], s36 offen nt lds
	s_add_u32 s36, s48, 3670016
	s_add_u32 m0, s44, 114688
	s_nop 0
	buffer_load_dwordx4 v100, s[8:11], s36 offen nt lds
	s_add_u32 s36, s48, 3702784
	s_add_u32 m0, s44, 115712
	s_nop 0
	buffer_load_dwordx4 v100, s[8:11], s36 offen nt lds
	s_add_u32 s36, s48, 3735552
	s_add_u32 m0, s44, 116736
	s_nop 0
	buffer_load_dwordx4 v100, s[8:11], s36 offen nt lds
	s_add_u32 s36, s48, 3768320
	s_add_u32 m0, s44, 117760
	s_nop 0
	buffer_load_dwordx4 v100, s[8:11], s36 offen nt lds
	s_add_u32 s36, s48, 4194304
	s_add_u32 m0, s44, 131072
	s_nop 0
	buffer_load_dwordx4 v100, s[8:11], s36 offen nt lds
	s_add_u32 s36, s48, 4227072
	s_add_u32 m0, s44, 132096
	s_nop 0
	buffer_load_dwordx4 v100, s[8:11], s36 offen nt lds
	s_add_u32 s36, s48, 4259840
	s_add_u32 m0, s44, 133120
	s_nop 0
	buffer_load_dwordx4 v100, s[8:11], s36 offen nt lds
	s_add_u32 s36, s48, 4292608
	s_add_u32 m0, s44, 134144
	s_nop 0
	buffer_load_dwordx4 v100, s[8:11], s36 offen nt lds
	s_lshl_b32 s36, s26, 6
	v_xor_b32 v101, s36, v101
	s_waitcnt vmcnt(32)
	s_waitcnt lgkmcnt(0)
	s_barrier
	s_add_u32 s36, s49, 0
	s_add_u32 m0, s44, 147456
	s_nop 0
	buffer_load_dwordx4 v100, s[12:15], s36 offen nt lds
	s_add_u32 s36, s49, 32768
	s_add_u32 m0, s44, 148480
	s_nop 0
	buffer_load_dwordx4 v100, s[12:15], s36 offen nt lds
	s_add_u32 s36, s49, 65536
	s_add_u32 m0, s44, 149504
	s_nop 0
	buffer_load_dwordx4 v100, s[12:15], s36 offen nt lds
	s_add_u32 s36, s49, 98304
	s_add_u32 m0, s44, 150528
	s_nop 0
	buffer_load_dwordx4 v100, s[12:15], s36 offen nt lds
	v_add_u32 v8, 0, v101
	ds_read_b64_tr_b16 a[0:1], v8 offset:0
	ds_read_b64_tr_b16 a[2:3], v8 offset:1024
	ds_read_b64_tr_b16 a[4:5], v8 offset:4096
	ds_read_b64_tr_b16 a[6:7], v8 offset:5120
	ds_read_b64_tr_b16 a[8:9], v8 offset:8192
	ds_read_b64_tr_b16 a[10:11], v8 offset:9216
	ds_read_b64_tr_b16 a[12:13], v8 offset:12288
	ds_read_b64_tr_b16 a[14:15], v8 offset:13312
	s_waitcnt vmcnt(32)
	s_waitcnt lgkmcnt(0)
	s_barrier
	s_add_u32 s36, s49, 524288
	s_add_u32 m0, s44, 0
	s_nop 0
	buffer_load_dwordx4 v100, s[12:15], s36 offen nt lds
	s_add_u32 s36, s49, 557056
	s_add_u32 m0, s44, 1024
	s_nop 0
	buffer_load_dwordx4 v100, s[12:15], s36 offen nt lds
	s_add_u32 s36, s49, 589824
	s_add_u32 m0, s44, 2048
	s_nop 0
	buffer_load_dwordx4 v100, s[12:15], s36 offen nt lds
	s_add_u32 s36, s49, 622592
	s_add_u32 m0, s44, 3072
	s_nop 0
	buffer_load_dwordx4 v100, s[12:15], s36 offen nt lds
	v_add_u32 v8, 16384, v101
	ds_read_b64_tr_b16 a[16:17], v8 offset:0
	ds_read_b64_tr_b16 a[18:19], v8 offset:1024
	ds_read_b64_tr_b16 a[20:21], v8 offset:4096
	ds_read_b64_tr_b16 a[22:23], v8 offset:5120
	ds_read_b64_tr_b16 a[24:25], v8 offset:8192
	ds_read_b64_tr_b16 a[26:27], v8 offset:9216
	ds_read_b64_tr_b16 a[28:29], v8 offset:12288
	ds_read_b64_tr_b16 a[30:31], v8 offset:13312
	s_waitcnt vmcnt(32)
	s_waitcnt lgkmcnt(0)
	s_barrier
	s_add_u32 s36, s49, 1048576
	s_add_u32 m0, s44, 16384
	s_nop 0
	buffer_load_dwordx4 v100, s[12:15], s36 offen nt lds
	s_add_u32 s36, s49, 1081344
	s_add_u32 m0, s44, 17408
	s_nop 0
	buffer_load_dwordx4 v100, s[12:15], s36 offen nt lds
	s_add_u32 s36, s49, 1114112
	s_add_u32 m0, s44, 18432
	s_nop 0
	buffer_load_dwordx4 v100, s[12:15], s36 offen nt lds
	s_add_u32 s36, s49, 1146880
	s_add_u32 m0, s44, 19456
	s_nop 0
	buffer_load_dwordx4 v100, s[12:15], s36 offen nt lds
	v_add_u32 v8, 32768, v101
	ds_read_b64_tr_b16 a[32:33], v8 offset:0
	ds_read_b64_tr_b16 a[34:35], v8 offset:1024
	ds_read_b64_tr_b16 a[36:37], v8 offset:4096
	ds_read_b64_tr_b16 a[38:39], v8 offset:5120
	ds_read_b64_tr_b16 a[40:41], v8 offset:8192
	ds_read_b64_tr_b16 a[42:43], v8 offset:9216
	ds_read_b64_tr_b16 a[44:45], v8 offset:12288
	ds_read_b64_tr_b16 a[46:47], v8 offset:13312
	s_waitcnt vmcnt(32)
	s_waitcnt lgkmcnt(0)
	s_barrier
	s_add_u32 s36, s49, 1572864
	s_add_u32 m0, s44, 32768
	s_nop 0
	buffer_load_dwordx4 v100, s[12:15], s36 offen nt lds
	s_add_u32 s36, s49, 1605632
	s_add_u32 m0, s44, 33792
	s_nop 0
	buffer_load_dwordx4 v100, s[12:15], s36 offen nt lds
	s_add_u32 s36, s49, 1638400
	s_add_u32 m0, s44, 34816
	s_nop 0
	buffer_load_dwordx4 v100, s[12:15], s36 offen nt lds
	s_add_u32 s36, s49, 1671168
	s_add_u32 m0, s44, 35840
	s_nop 0
	buffer_load_dwordx4 v100, s[12:15], s36 offen nt lds
	v_add_u32 v8, 49152, v101
	ds_read_b64_tr_b16 a[48:49], v8 offset:0
	ds_read_b64_tr_b16 a[50:51], v8 offset:1024
	ds_read_b64_tr_b16 a[52:53], v8 offset:4096
	ds_read_b64_tr_b16 a[54:55], v8 offset:5120
	ds_read_b64_tr_b16 a[56:57], v8 offset:8192
	ds_read_b64_tr_b16 a[58:59], v8 offset:9216
	ds_read_b64_tr_b16 a[60:61], v8 offset:12288
	ds_read_b64_tr_b16 a[62:63], v8 offset:13312
	s_waitcnt vmcnt(32)
	s_waitcnt lgkmcnt(0)
	s_barrier
	s_add_u32 s36, s49, 2097152
	s_add_u32 m0, s44, 49152
	s_nop 0
	buffer_load_dwordx4 v100, s[12:15], s36 offen nt lds
	s_add_u32 s36, s49, 2129920
	s_add_u32 m0, s44, 50176
	s_nop 0
	buffer_load_dwordx4 v100, s[12:15], s36 offen nt lds
	s_add_u32 s36, s49, 2162688
	s_add_u32 m0, s44, 51200
	s_nop 0
	buffer_load_dwordx4 v100, s[12:15], s36 offen nt lds
	s_add_u32 s36, s49, 2195456
	s_add_u32 m0, s44, 52224
	s_nop 0
	buffer_load_dwordx4 v100, s[12:15], s36 offen nt lds
	v_add_u32 v8, 65536, v101
	ds_read_b64_tr_b16 a[64:65], v8 offset:0
	ds_read_b64_tr_b16 a[66:67], v8 offset:1024
	ds_read_b64_tr_b16 a[68:69], v8 offset:4096
	ds_read_b64_tr_b16 a[70:71], v8 offset:5120
	ds_read_b64_tr_b16 a[72:73], v8 offset:8192
	ds_read_b64_tr_b16 a[74:75], v8 offset:9216
	ds_read_b64_tr_b16 a[76:77], v8 offset:12288
	ds_read_b64_tr_b16 a[78:79], v8 offset:13312
	s_waitcnt vmcnt(32)
	s_waitcnt lgkmcnt(0)
	s_barrier
	s_add_u32 s36, s49, 2621440
	s_add_u32 m0, s44, 65536
	s_nop 0
	buffer_load_dwordx4 v100, s[12:15], s36 offen nt lds
	s_add_u32 s36, s49, 2654208
	s_add_u32 m0, s44, 66560
	s_nop 0
	buffer_load_dwordx4 v100, s[12:15], s36 offen nt lds
	s_add_u32 s36, s49, 2686976
	s_add_u32 m0, s44, 67584
	s_nop 0
	buffer_load_dwordx4 v100, s[12:15], s36 offen nt lds
	s_add_u32 s36, s49, 2719744
	s_add_u32 m0, s44, 68608
	s_nop 0
	buffer_load_dwordx4 v100, s[12:15], s36 offen nt lds
	v_add_u32 v8, 81920, v101
	ds_read_b64_tr_b16 a[80:81], v8 offset:0
	ds_read_b64_tr_b16 a[82:83], v8 offset:1024
	ds_read_b64_tr_b16 a[84:85], v8 offset:4096
	ds_read_b64_tr_b16 a[86:87], v8 offset:5120
	ds_read_b64_tr_b16 a[88:89], v8 offset:8192
	ds_read_b64_tr_b16 a[90:91], v8 offset:9216
	ds_read_b64_tr_b16 a[92:93], v8 offset:12288
	ds_read_b64_tr_b16 a[94:95], v8 offset:13312
	s_waitcnt vmcnt(32)
	s_waitcnt lgkmcnt(0)
	s_barrier
	s_add_u32 s36, s49, 3145728
	s_add_u32 m0, s44, 81920
	s_nop 0
	buffer_load_dwordx4 v100, s[12:15], s36 offen nt lds
	s_add_u32 s36, s49, 3178496
	s_add_u32 m0, s44, 82944
	s_nop 0
	buffer_load_dwordx4 v100, s[12:15], s36 offen nt lds
	s_add_u32 s36, s49, 3211264
	s_add_u32 m0, s44, 83968
	s_nop 0
	buffer_load_dwordx4 v100, s[12:15], s36 offen nt lds
	s_add_u32 s36, s49, 3244032
	s_add_u32 m0, s44, 84992
	s_nop 0
	buffer_load_dwordx4 v100, s[12:15], s36 offen nt lds
	v_add_u32 v8, 98304, v101
	ds_read_b64_tr_b16 a[96:97], v8 offset:0
	ds_read_b64_tr_b16 a[98:99], v8 offset:1024
	ds_read_b64_tr_b16 a[100:101], v8 offset:4096
	ds_read_b64_tr_b16 a[102:103], v8 offset:5120
	ds_read_b64_tr_b16 a[104:105], v8 offset:8192
	ds_read_b64_tr_b16 a[106:107], v8 offset:9216
	ds_read_b64_tr_b16 a[108:109], v8 offset:12288
	ds_read_b64_tr_b16 a[110:111], v8 offset:13312
	s_waitcnt vmcnt(32)
	s_waitcnt lgkmcnt(0)
	s_barrier
	s_add_u32 s36, s49, 3670016
	s_add_u32 m0, s44, 98304
	s_nop 0
	buffer_load_dwordx4 v100, s[12:15], s36 offen nt lds
	s_add_u32 s36, s49, 3702784
	s_add_u32 m0, s44, 99328
	s_nop 0
	buffer_load_dwordx4 v100, s[12:15], s36 offen nt lds
	s_add_u32 s36, s49, 3735552
	s_add_u32 m0, s44, 100352
	s_nop 0
	buffer_load_dwordx4 v100, s[12:15], s36 offen nt lds
	s_add_u32 s36, s49, 3768320
	s_add_u32 m0, s44, 101376
	s_nop 0
	buffer_load_dwordx4 v100, s[12:15], s36 offen nt lds
	v_add_u32 v8, 114688, v101
	ds_read_b64_tr_b16 a[112:113], v8 offset:0
	ds_read_b64_tr_b16 a[114:115], v8 offset:1024
	ds_read_b64_tr_b16 a[116:117], v8 offset:4096
	ds_read_b64_tr_b16 a[118:119], v8 offset:5120
	ds_read_b64_tr_b16 a[120:121], v8 offset:8192
	ds_read_b64_tr_b16 a[122:123], v8 offset:9216
	ds_read_b64_tr_b16 a[124:125], v8 offset:12288
	ds_read_b64_tr_b16 a[126:127], v8 offset:13312
	s_waitcnt vmcnt(32)
	s_waitcnt lgkmcnt(0)
	s_barrier
	s_add_u32 s36, s49, 4194304
	s_add_u32 m0, s44, 114688
	s_nop 0
	buffer_load_dwordx4 v100, s[12:15], s36 offen nt lds
	s_add_u32 s36, s49, 4227072
	s_add_u32 m0, s44, 115712
	s_nop 0
	buffer_load_dwordx4 v100, s[12:15], s36 offen nt lds
	s_add_u32 s36, s49, 4259840
	s_add_u32 m0, s44, 116736
	s_nop 0
	buffer_load_dwordx4 v100, s[12:15], s36 offen nt lds
	s_add_u32 s36, s49, 4292608
	s_add_u32 m0, s44, 117760
	s_nop 0
	buffer_load_dwordx4 v100, s[12:15], s36 offen nt lds
	v_add_u32 v8, 131072, v101
	ds_read_b64_tr_b16 a[128:129], v8 offset:0
	ds_read_b64_tr_b16 a[130:131], v8 offset:1024
	ds_read_b64_tr_b16 a[132:133], v8 offset:4096
	ds_read_b64_tr_b16 a[134:135], v8 offset:5120
	ds_read_b64_tr_b16 a[136:137], v8 offset:8192
	ds_read_b64_tr_b16 a[138:139], v8 offset:9216
	ds_read_b64_tr_b16 a[140:141], v8 offset:12288
	ds_read_b64_tr_b16 a[142:143], v8 offset:13312
	s_waitcnt vmcnt(32)
	s_waitcnt lgkmcnt(0)
	s_barrier
	v_add_u32 v8, 147456, v101
	ds_read_b64_tr_b16 a[144:145], v8 offset:0
	ds_read_b64_tr_b16 a[146:147], v8 offset:1024
	ds_read_b64_tr_b16 a[148:149], v8 offset:4096
	ds_read_b64_tr_b16 a[150:151], v8 offset:5120
	ds_read_b64_tr_b16 a[152:153], v8 offset:8192
	ds_read_b64_tr_b16 a[154:155], v8 offset:9216
	ds_read_b64_tr_b16 a[156:157], v8 offset:12288
	ds_read_b64_tr_b16 a[158:159], v8 offset:13312
	s_waitcnt vmcnt(28)
	s_waitcnt lgkmcnt(0)
	s_barrier
	v_add_u32 v8, 0, v101
	ds_read_b64_tr_b16 a[160:161], v8 offset:0
	ds_read_b64_tr_b16 a[162:163], v8 offset:1024
	ds_read_b64_tr_b16 a[164:165], v8 offset:4096
	ds_read_b64_tr_b16 a[166:167], v8 offset:5120
	ds_read_b64_tr_b16 a[168:169], v8 offset:8192
	ds_read_b64_tr_b16 a[170:171], v8 offset:9216
	ds_read_b64_tr_b16 a[172:173], v8 offset:12288
	ds_read_b64_tr_b16 a[174:175], v8 offset:13312
	s_waitcnt vmcnt(24)
	s_waitcnt lgkmcnt(0)
	s_barrier
	v_add_u32 v8, 16384, v101
	ds_read_b64_tr_b16 a[176:177], v8 offset:0
	ds_read_b64_tr_b16 a[178:179], v8 offset:1024
	ds_read_b64_tr_b16 a[180:181], v8 offset:4096
	ds_read_b64_tr_b16 a[182:183], v8 offset:5120
	ds_read_b64_tr_b16 a[184:185], v8 offset:8192
	ds_read_b64_tr_b16 a[186:187], v8 offset:9216
	ds_read_b64_tr_b16 a[188:189], v8 offset:12288
	ds_read_b64_tr_b16 a[190:191], v8 offset:13312
	s_waitcnt vmcnt(20)
	s_waitcnt lgkmcnt(0)
	s_barrier
	v_add_u32 v8, 32768, v101
	ds_read_b64_tr_b16 a[192:193], v8 offset:0
	ds_read_b64_tr_b16 a[194:195], v8 offset:1024
	ds_read_b64_tr_b16 a[196:197], v8 offset:4096
	ds_read_b64_tr_b16 a[198:199], v8 offset:5120
	ds_read_b64_tr_b16 a[200:201], v8 offset:8192
	ds_read_b64_tr_b16 a[202:203], v8 offset:9216
	ds_read_b64_tr_b16 a[204:205], v8 offset:12288
	ds_read_b64_tr_b16 a[206:207], v8 offset:13312
	s_waitcnt vmcnt(16)
	s_waitcnt lgkmcnt(0)
	s_barrier
	v_add_u32 v8, 49152, v101
	ds_read_b64_tr_b16 a[208:209], v8 offset:0
	ds_read_b64_tr_b16 a[210:211], v8 offset:1024
	ds_read_b64_tr_b16 a[212:213], v8 offset:4096
	ds_read_b64_tr_b16 a[214:215], v8 offset:5120
	ds_read_b64_tr_b16 a[216:217], v8 offset:8192
	ds_read_b64_tr_b16 a[218:219], v8 offset:9216
	ds_read_b64_tr_b16 a[220:221], v8 offset:12288
	ds_read_b64_tr_b16 a[222:223], v8 offset:13312
	s_waitcnt vmcnt(12)
	s_waitcnt lgkmcnt(0)
	s_barrier
	v_add_u32 v8, 65536, v101
	ds_read_b64_tr_b16 a[224:225], v8 offset:0
	ds_read_b64_tr_b16 a[226:227], v8 offset:1024
	ds_read_b64_tr_b16 a[228:229], v8 offset:4096
	ds_read_b64_tr_b16 a[230:231], v8 offset:5120
	ds_read_b64_tr_b16 a[232:233], v8 offset:8192
	ds_read_b64_tr_b16 a[234:235], v8 offset:9216
	ds_read_b64_tr_b16 a[236:237], v8 offset:12288
	ds_read_b64_tr_b16 a[238:239], v8 offset:13312
	s_waitcnt vmcnt(8)
	s_waitcnt lgkmcnt(0)
	s_barrier
	v_add_u32 v8, 81920, v101
	ds_read_b64_tr_b16 a[240:241], v8 offset:0
	ds_read_b64_tr_b16 a[242:243], v8 offset:1024
	ds_read_b64_tr_b16 a[244:245], v8 offset:4096
	ds_read_b64_tr_b16 a[246:247], v8 offset:5120
	ds_read_b64_tr_b16 a[248:249], v8 offset:8192
	ds_read_b64_tr_b16 a[250:251], v8 offset:9216
	ds_read_b64_tr_b16 a[252:253], v8 offset:12288
	ds_read_b64_tr_b16 a[254:255], v8 offset:13312
	s_waitcnt vmcnt(4)
	s_waitcnt lgkmcnt(0)
	s_barrier
	v_add_u32 v8, 98304, v101
	ds_read_b64_tr_b16 v[112:113], v8 offset:0
	ds_read_b64_tr_b16 v[114:115], v8 offset:1024
	ds_read_b64_tr_b16 v[116:117], v8 offset:4096
	ds_read_b64_tr_b16 v[118:119], v8 offset:5120
	ds_read_b64_tr_b16 v[120:121], v8 offset:8192
	ds_read_b64_tr_b16 v[122:123], v8 offset:9216
	ds_read_b64_tr_b16 v[124:125], v8 offset:12288
	ds_read_b64_tr_b16 v[126:127], v8 offset:13312
	s_waitcnt vmcnt(0)
	s_waitcnt lgkmcnt(0)
	s_barrier
	v_add_u32 v8, 114688, v101
	ds_read_b64_tr_b16 v[128:129], v8 offset:0
	ds_read_b64_tr_b16 v[130:131], v8 offset:1024
	ds_read_b64_tr_b16 v[132:133], v8 offset:4096
	ds_read_b64_tr_b16 v[134:135], v8 offset:5120
	ds_read_b64_tr_b16 v[136:137], v8 offset:8192
	ds_read_b64_tr_b16 v[138:139], v8 offset:9216
	ds_read_b64_tr_b16 v[140:141], v8 offset:12288
	ds_read_b64_tr_b16 v[142:143], v8 offset:13312
	s_waitcnt lgkmcnt(0)
	s_barrier
	v_add_u32 v2, 36864, v0
	v_xor_b32 v2, v2, v0
	s_lshl_b32 s32, s27, 7
	s_lshl_b32 s36, s26, 2
	s_add_u32 s32, s32, s36
	s_add_u32 s32, s32, 0x3302000
	s_mov_b32 s30, 0x3400000
	s_mov_b32 s33, 0x3300000
	s_lshl_b32 s31, s27, 14
	s_lshl_b32 s36, s26, 12
	s_add_u32 s31, s31, s36
	s_add_u32 s31, s31, 0x0
	v_mov_b64 v[108:109], -1
	v_mov_b64 v[110:111], -1
	s_lshl_b32 s45, s27, 13
	s_lshl_b32 s36, s26, 11
	s_add_u32 s45, s45, s36
	s_add_u32 s45, s45, 0x2000000
	s_mul_i32 s36, s26, 3072
	s_add_u32 s30, s30, s36
	s_mov_b32 s35, s36
	s_lshl_b32 s46, s36, 1
	s_add_u32 s46, s46, 36864
	v_mov_b32 v1, v0
	s_mov_b32 s28, 0
	s_mov_b32 s29, 1
	v_mov_b32 v8, 0
kv_init:
	global_load_dword v9, v8, s[24:25] offset:8 sc1
	s_sub_u32 s34, s34, 1
	s_cbranch_scc1 all_exit
	s_waitcnt vmcnt(0)
	v_readfirstlane_b32 s36, v9
	s_cmp_eq_u32 s36, 0
	s_cbranch_scc1 kv_init
	s_branch kv_spin
kv_loop:
	s_waitcnt vmcnt(12)
	s_barrier
	buffer_load_dword v96, v104, s[4:7], s33 offen sc1
	ds_read_b128 v[40:43], v1 offset:0
	ds_read_b128 v[44:47], v1 offset:1024
	ds_read_b128 v[48:51], v1 offset:2048
	s_waitcnt lgkmcnt(2)
	v_mfma_f32_32x32x16_bf16 v[8:23], a[0:3], v[40:43], 0
	ds_read_b128 v[52:55], v1 offset:3072
	v_mfma_f32_32x32x16_bf16 v[24:39], v[40:43], a[144:147], 0
	s_waitcnt lgkmcnt(2)
	v_mfma_f32_32x32x16_bf16 v[8:23], a[4:7], v[44:47], v[8:23]
	ds_read_b128 v[56:59], v1 offset:4096
	v_mfma_f32_32x32x16_bf16 v[24:39], v[44:47], a[148:151], v[24:39]
	s_waitcnt lgkmcnt(2)
	v_mfma_f32_32x32x16_bf16 v[8:23], a[8:11], v[48:51], v[8:23]
	ds_read_b128 v[60:63], v1 offset:5120
	v_mfma_f32_32x32x16_bf16 v[24:39], v[48:51], a[152:155], v[24:39]
	s_waitcnt lgkmcnt(2)
	v_mfma_f32_32x32x16_bf16 v[8:23], a[12:15], v[52:55], v[8:23]
	ds_read_b128 v[64:67], v1 offset:6144
	v_mfma_f32_32x32x16_bf16 v[24:39], v[52:55], a[156:159], v[24:39]
	s_waitcnt lgkmcnt(2)
	v_mfma_f32_32x32x16_bf16 v[8:23], a[16:19], v[56:59], v[8:23]
	ds_read_b128 v[68:71], v1 offset:7168
	v_mfma_f32_32x32x16_bf16 v[24:39], v[56:59], a[160:163], v[24:39]
	s_waitcnt lgkmcnt(2)
	v_mfma_f32_32x32x16_bf16 v[8:23], a[20:23], v[60:63], v[8:23]
	ds_read_b128 v[40:43], v1 offset:8192
	v_mfma_f32_32x32x16_bf16 v[24:39], v[60:63], a[164:167], v[24:39]
	s_waitcnt lgkmcnt(2)
	v_mfma_f32_32x32x16_bf16 v[8:23], a[24:27], v[64:67], v[8:23]
	ds_read_b128 v[44:47], v1 offset:9216
	v_mfma_f32_32x32x16_bf16 v[24:39], v[64:67], a[168:171], v[24:39]
	s_waitcnt lgkmcnt(2)
	v_mfma_f32_32x32x16_bf16 v[8:23], a[28:31], v[68:71], v[8:23]
	ds_read_b128 v[48:51], v1 offset:10240
	v_mfma_f32_32x32x16_bf16 v[24:39], v[68:71], a[172:175], v[24:39]
	s_waitcnt lgkmcnt(2)
	v_mfma_f32_32x32x16_bf16 v[8:23], a[32:35], v[40:43], v[8:23]
	ds_read_b128 v[52:55], v1 offset:11264
	v_mfma_f32_32x32x16_bf16 v[24:39], v[40:43], a[176:179], v[24:39]
	s_waitcnt lgkmcnt(2)
	v_mfma_f32_32x32x16_bf16 v[8:23], a[36:39], v[44:47], v[8:23]
	s_waitcnt vmcnt(10)
	s_barrier
	ds_read_b128 v[56:59], v1 offset:12288
	v_mfma_f32_32x32x16_bf16 v[24:39], v[44:47], a[180:183], v[24:39]
	s_waitcnt lgkmcnt(2)
	v_mfma_f32_32x32x16_bf16 v[8:23], a[40:43], v[48:51], v[8:23]
	ds_read_b128 v[60:63], v1 offset:13312
	v_mfma_f32_32x32x16_bf16 v[24:39], v[48:51], a[184:187], v[24:39]
	s_waitcnt lgkmcnt(2)
	v_mfma_f32_32x32x16_bf16 v[8:23], a[44:47], v[52:55], v[8:23]
	ds_read_b128 v[64:67], v1 offset:14336
	v_mfma_f32_32x32x16_bf16 v[24:39], v[52:55], a[188:191], v[24:39]
	s_waitcnt lgkmcnt(2)
	v_mfma_f32_32x32x16_bf16 v[8:23], a[48:51], v[56:59], v[8:23]
	ds_read_b128 v[68:71], v1 offset:15360
	v_mfma_f32_32x32x16_bf16 v[24:39], v[56:59], a[192:195], v[24:39]
	s_waitcnt lgkmcnt(2)
	v_mfma_f32_32x32x16_bf16 v[8:23], a[52:55], v[60:63], v[8:23]
	ds_read_b128 v[40:43], v1 offset:16384
	v_mfma_f32_32x32x16_bf16 v[24:39], v[60:63], a[196:199], v[24:39]
	s_waitcnt lgkmcnt(2)
	v_mfma_f32_32x32x16_bf16 v[8:23], a[56:59], v[64:67], v[8:23]
	ds_read_b128 v[44:47], v1 offset:17408
	v_mfma_f32_32x32x16_bf16 v[24:39], v[64:67], a[200:203], v[24:39]
	s_waitcnt lgkmcnt(2)
	v_mfma_f32_32x32x16_bf16 v[8:23], a[60:63], v[68:71], v[8:23]
	ds_read_b128 v[48:51], v1 offset:18432
	v_mfma_f32_32x32x16_bf16 v[24:39], v[68:71], a[204:207], v[24:39]
	s_waitcnt lgkmcnt(2)
	v_mfma_f32_32x32x16_bf16 v[8:23], a[64:67], v[40:43], v[8:23]
	ds_read_b128 v[52:55], v1 offset:19456
	v_mfma_f32_32x32x16_bf16 v[24:39], v[40:43], a[208:211], v[24:39]
	s_waitcnt lgkmcnt(2)
	v_mfma_f32_32x32x16_bf16 v[8:23], a[68:71], v[44:47], v[8:23]
	ds_read_b128 v[56:59], v1 offset:20480
	v_mfma_f32_32x32x16_bf16 v[24:39], v[44:47], a[212:215], v[24:39]
	s_waitcnt lgkmcnt(2)
	v_mfma_f32_32x32x16_bf16 v[8:23], a[72:75], v[48:51], v[8:23]
	ds_read_b128 v[60:63], v1 offset:21504
	v_mfma_f32_32x32x16_bf16 v[24:39], v[48:51], a[216:219], v[24:39]
	s_waitcnt lgkmcnt(2)
	v_mfma_f32_32x32x16_bf16 v[8:23], a[76:79], v[52:55], v[8:23]
	ds_read_b128 v[64:67], v1 offset:22528
	v_mfma_f32_32x32x16_bf16 v[24:39], v[52:55], a[220:223], v[24:39]
	s_waitcnt lgkmcnt(2)
	v_mfma_f32_32x32x16_bf16 v[8:23], a[80:83], v[56:59], v[8:23]
	ds_read_b128 v[68:71], v1 offset:23552
	v_mfma_f32_32x32x16_bf16 v[24:39], v[56:59], a[224:227], v[24:39]
	s_waitcnt lgkmcnt(2)
	v_mfma_f32_32x32x16_bf16 v[8:23], a[84:87], v[60:63], v[8:23]
	s_waitcnt vmcnt(0)
	s_barrier
	v_mov_b32 v98, s28
	s_mov_b64 exec, 1
	buffer_store_dword v98, off, s[4:7], s32 sc1
	s_mov_b64 exec, -1
	v_cmp_gt_u32 vcc, s29, v96
	s_mov_b32 s40, 0
	s_cbranch_vccnz kv_late
	s_cmp_eq_u32 s28, 63
	s_cbranch_scc1 kv_late
	s_mov_b32 m0, s35
	s_nop 0
	buffer_load_dwordx4 v0, s[4:7], s30 offen offset:0 sc1 lds
	buffer_load_dwordx4 v0, s[4:7], s30 offen offset:1024 sc1 lds
	buffer_load_dwordx4 v0, s[4:7], s30 offen offset:2048 sc1 lds
	s_add_u32 m0, s35, 12288
	s_add_u32 s36, s30, 12288
	buffer_load_dwordx4 v0, s[4:7], s36 offen offset:0 sc1 lds
	buffer_load_dwordx4 v0, s[4:7], s36 offen offset:1024 sc1 lds
	buffer_load_dwordx4 v0, s[4:7], s36 offen offset:2048 sc1 lds
	s_add_u32 m0, s35, 24576
	s_add_u32 s36, s30, 24576
	buffer_load_dwordx4 v0, s[4:7], s36 offen offset:0 sc1 lds
	buffer_load_dwordx4 v0, s[4:7], s36 offen offset:1024 sc1 lds
	buffer_load_dwordx4 v0, s[4:7], s36 offen offset:2048 sc1 lds
	s_add_u32 s30, s30, 36864
	s_sub_u32 s35, s46, s35
	s_mov_b32 s40, 1
kv_late:
	ds_read_b128 v[40:43], v1 offset:24576
	v_mfma_f32_32x32x16_bf16 v[24:39], v[60:63], a[228:231], v[24:39]
	s_waitcnt lgkmcnt(2)
	v_mfma_f32_32x32x16_bf16 v[8:23], a[88:91], v[64:67], v[8:23]
	ds_read_b128 v[44:47], v1 offset:25600
	v_mfma_f32_32x32x16_bf16 v[24:39], v[64:67], a[232:235], v[24:39]
	s_waitcnt lgkmcnt(2)
	v_mfma_f32_32x32x16_bf16 v[8:23], a[92:95], v[68:71], v[8:23]
	ds_read_b128 v[48:51], v1 offset:26624
	v_mfma_f32_32x32x16_bf16 v[24:39], v[68:71], a[236:239], v[24:39]
	s_waitcnt lgkmcnt(2)
	v_mfma_f32_32x32x16_bf16 v[8:23], a[96:99], v[40:43], v[8:23]
	ds_read_b128 v[52:55], v1 offset:27648
	v_mfma_f32_32x32x16_bf16 v[24:39], v[40:43], a[240:243], v[24:39]
	s_waitcnt lgkmcnt(2)
	v_mfma_f32_32x32x16_bf16 v[8:23], a[100:103], v[44:47], v[8:23]
	ds_read_b128 v[56:59], v1 offset:28672
	v_mfma_f32_32x32x16_bf16 v[24:39], v[44:47], a[244:247], v[24:39]
	s_waitcnt lgkmcnt(2)
	v_mfma_f32_32x32x16_bf16 v[8:23], a[104:107], v[48:51], v[8:23]
	ds_read_b128 v[60:63], v1 offset:29696
	v_mfma_f32_32x32x16_bf16 v[24:39], v[48:51], a[248:251], v[24:39]
	s_waitcnt lgkmcnt(2)
	v_mfma_f32_32x32x16_bf16 v[8:23], a[108:111], v[52:55], v[8:23]
	ds_read_b128 v[64:67], v1 offset:30720
	v_mfma_f32_32x32x16_bf16 v[24:39], v[52:55], a[252:255], v[24:39]
	s_waitcnt lgkmcnt(2)
	v_mfma_f32_32x32x16_bf16 v[8:23], a[112:115], v[56:59], v[8:23]
	ds_read_b128 v[68:71], v1 offset:31744
	v_mfma_f32_32x32x16_bf16 v[24:39], v[56:59], v[112:115], v[24:39]
	s_waitcnt lgkmcnt(2)
	v_mfma_f32_32x32x16_bf16 v[8:23], a[116:119], v[60:63], v[8:23]
	ds_read_b128 v[40:43], v1 offset:32768
	v_mfma_f32_32x32x16_bf16 v[24:39], v[60:63], v[116:119], v[24:39]
	s_waitcnt lgkmcnt(2)
	v_mfma_f32_32x32x16_bf16 v[8:23], a[120:123], v[64:67], v[8:23]
	ds_read_b128 v[44:47], v1 offset:33792
	v_mfma_f32_32x32x16_bf16 v[24:39], v[64:67], v[120:123], v[24:39]
	s_waitcnt lgkmcnt(2)
	v_mfma_f32_32x32x16_bf16 v[8:23], a[124:127], v[68:71], v[8:23]
	ds_read_b128 v[48:51], v1 offset:34816
	v_mfma_f32_32x32x16_bf16 v[24:39], v[68:71], v[124:127], v[24:39]
	s_waitcnt lgkmcnt(2)
	v_mfma_f32_32x32x16_bf16 v[8:23], a[128:131], v[40:43], v[8:23]
	ds_read_b128 v[52:55], v1 offset:35840
	v_mfma_f32_32x32x16_bf16 v[24:39], v[40:43], v[128:131], v[24:39]
	s_waitcnt lgkmcnt(2)
	v_mfma_f32_32x32x16_bf16 v[8:23], a[132:135], v[44:47], v[8:23]
	v_mfma_f32_32x32x16_bf16 v[24:39], v[44:47], v[132:135], v[24:39]
	s_waitcnt lgkmcnt(1)
	v_mfma_f32_32x32x16_bf16 v[8:23], a[136:139], v[48:51], v[8:23]
	v_mfma_f32_32x32x16_bf16 v[24:39], v[48:51], v[136:139], v[24:39]
	s_waitcnt lgkmcnt(0)
	v_mfma_f32_32x32x16_bf16 v[8:23], a[140:143], v[52:55], v[8:23]
	v_mfma_f32_32x32x16_bf16 v[24:39], v[52:55], v[140:143], v[24:39]
	v_xor_b32 v1, v2, v1
	buffer_store_dwordx4 v[108:111], v0, s[4:7], s45 offen offset:0 sc1
	buffer_store_dwordx4 v[108:111], v0, s[4:7], s45 offen offset:1024 sc1
	s_add_u32 s45, s45, 262144
	v_cvt_pk_bf16_f32 v72, v8, v9
	v_cvt_pk_bf16_f32 v73, v10, v11
	v_cvt_pk_bf16_f32 v74, v12, v13
	v_cvt_pk_bf16_f32 v75, v14, v15
	v_cvt_pk_bf16_f32 v76, v16, v17
	v_cvt_pk_bf16_f32 v77, v18, v19
	v_cvt_pk_bf16_f32 v78, v20, v21
	v_cvt_pk_bf16_f32 v79, v22, v23
	buffer_store_dwordx4 v[72:75], v102, s[4:7], s31 offen offset:0 sc1
	buffer_store_dwordx4 v[76:79], v102, s[4:7], s31 offen offset:512 sc1
	v_cvt_pk_bf16_f32 v80, v24, v25
	v_cvt_pk_bf16_f32 v81, v26, v27
	v_cvt_pk_bf16_f32 v82, v28, v29
	v_cvt_pk_bf16_f32 v83, v30, v31
	v_cvt_pk_bf16_f32 v84, v32, v33
	v_cvt_pk_bf16_f32 v85, v34, v35
	v_cvt_pk_bf16_f32 v86, v36, v37
	v_cvt_pk_bf16_f32 v87, v38, v39
	buffer_store_dwordx4 v[80:83], v103, s[4:7], s31 offen offset:0 sc1
	buffer_store_dwordx4 v[84:87], v103, s[4:7], s31 offen offset:512 sc1
	s_add_u32 s31, s31, 524288
	s_add_u32 s28, s28, 1
	s_add_u32 s29, s29, 1
	s_add_u32 s33, s33, 128
	s_cmp_eq_u32 s40, 1
	s_cbranch_scc1 kv_loop
	s_waitcnt vmcnt(0)
	v_mov_b32 v98, s28
	s_mov_b64 exec, 1
	buffer_store_dword v98, off, s[4:7], s32 sc1
	s_mov_b64 exec, -1
	s_cmp_eq_u32 s28, 64
	s_cbranch_scc1 kv_more
	s_sub_u32 s29, s29, 1
	s_sub_u32 s33, s33, 128
kv_spin:
kv_sp:
	buffer_load_dword v96, v104, s[4:7], s33 offen sc1
	s_sub_u32 s34, s34, 1
	s_cbranch_scc1 all_exit
	s_waitcnt vmcnt(0)
	v_cmp_gt_u32 vcc, s29, v96
	s_cbranch_vccnz kv_sp
	s_mov_b32 m0, s35
	s_nop 0
	buffer_load_dwordx4 v0, s[4:7], s30 offen offset:0 sc1 lds
	buffer_load_dwordx4 v0, s[4:7], s30 offen offset:1024 sc1 lds
	buffer_load_dwordx4 v0, s[4:7], s30 offen offset:2048 sc1 lds
	s_add_u32 m0, s35, 12288
	s_add_u32 s36, s30, 12288
	buffer_load_dwordx4 v0, s[4:7], s36 offen offset:0 sc1 lds
	buffer_load_dwordx4 v0, s[4:7], s36 offen offset:1024 sc1 lds
	buffer_load_dwordx4 v0, s[4:7], s36 offen offset:2048 sc1 lds
	s_add_u32 m0, s35, 24576
	s_add_u32 s36, s30, 24576
	buffer_load_dwordx4 v0, s[4:7], s36 offen offset:0 sc1 lds
	buffer_load_dwordx4 v0, s[4:7], s36 offen offset:1024 sc1 lds
	buffer_load_dwordx4 v0, s[4:7], s36 offen offset:2048 sc1 lds
	s_add_u32 s30, s30, 36864
	s_sub_u32 s35, s46, s35
	buffer_load_dword v97, v104, s[4:7], s33 offen sc1
	s_waitcnt vmcnt(0)
	buffer_load_dword v97, v104, s[4:7], s33 offen sc1
	s_waitcnt vmcnt(0)
	buffer_load_dword v97, v104, s[4:7], s33 offen sc1
	s_waitcnt vmcnt(0)
	buffer_load_dword v97, v104, s[4:7], s33 offen sc1
	s_waitcnt vmcnt(0)
	buffer_load_dword v97, v104, s[4:7], s33 offen sc1
	s_waitcnt vmcnt(0)
	buffer_load_dword v97, v104, s[4:7], s33 offen sc1
	s_add_u32 s29, s29, 1
	s_add_u32 s33, s33, 128
	s_branch kv_loop
q_entry:
	v_add_u32 v8, 3072, v0
	global_load_dwordx4 v[100:103], v8, s[64:65]
	global_load_dwordx4 v[104:107], v8, s[64:65] offset:1024
	s_load_dwordx2 s[8:9], s[0:1], 16
	s_mov_b32 s10, 4718592
	s_mov_b32 s11, 0x00020000
	s_load_dwordx2 s[12:13], s[0:1], 16
	s_mov_b32 s14, 4718592
	s_mov_b32 s15, 0x00020000
	s_lshl_b32 s48, s26, 17
	s_lshl_b32 s36, s27, 9
	s_add_u32 s48, s48, s36
	s_add_u32 s49, s48, 256
	s_waitcnt vmcnt(0) lgkmcnt(0)
	s_add_u32 s36, s48, 0
	s_add_u32 m0, s44, 0
	s_nop 0
	buffer_load_dwordx4 v100, s[8:11], s36 offen nt lds
	s_add_u32 s36, s48, 32768
	s_add_u32 m0, s44, 1024
	s_nop 0
	buffer_load_dwordx4 v100, s[8:11], s36 offen nt lds
	s_add_u32 s36, s48, 65536
	s_add_u32 m0, s44, 2048
	s_nop 0
	buffer_load_dwordx4 v100, s[8:11], s36 offen nt lds
	s_add_u32 s36, s48, 98304
	s_add_u32 m0, s44, 3072
	s_nop 0
	buffer_load_dwordx4 v100, s[8:11], s36 offen nt lds
	s_add_u32 s36, s48, 524288
	s_add_u32 m0, s44, 16384
	s_nop 0
	buffer_load_dwordx4 v100, s[8:11], s36 offen nt lds
	s_add_u32 s36, s48, 557056
	s_add_u32 m0, s44, 17408
	s_nop 0
	buffer_load_dwordx4 v100, s[8:11], s36 offen nt lds
	s_add_u32 s36, s48, 589824
	s_add_u32 m0, s44, 18432
	s_nop 0
	buffer_load_dwordx4 v100, s[8:11], s36 offen nt lds
	s_add_u32 s36, s48, 622592
	s_add_u32 m0, s44, 19456
	s_nop 0
	buffer_load_dwordx4 v100, s[8:11], s36 offen nt lds
	s_add_u32 s36, s48, 1048576
	s_add_u32 m0, s44, 32768
	s_nop 0
	buffer_load_dwordx4 v100, s[8:11], s36 offen nt lds
	s_add_u32 s36, s48, 1081344
	s_add_u32 m0, s44, 33792
	s_nop 0
	buffer_load_dwordx4 v100, s[8:11], s36 offen nt lds
	s_add_u32 s36, s48, 1114112
	s_add_u32 m0, s44, 34816
	s_nop 0
	buffer_load_dwordx4 v100, s[8:11], s36 offen nt lds
	s_add_u32 s36, s48, 1146880
	s_add_u32 m0, s44, 35840
	s_nop 0
	buffer_load_dwordx4 v100, s[8:11], s36 offen nt lds
	s_add_u32 s36, s48, 1572864
	s_add_u32 m0, s44, 49152
	s_nop 0
	buffer_load_dwordx4 v100, s[8:11], s36 offen nt lds
	s_add_u32 s36, s48, 1605632
	s_add_u32 m0, s44, 50176
	s_nop 0
	buffer_load_dwordx4 v100, s[8:11], s36 offen nt lds
	s_add_u32 s36, s48, 1638400
	s_add_u32 m0, s44, 51200
	s_nop 0
	buffer_load_dwordx4 v100, s[8:11], s36 offen nt lds
	s_add_u32 s36, s48, 1671168
	s_add_u32 m0, s44, 52224
	s_nop 0
	buffer_load_dwordx4 v100, s[8:11], s36 offen nt lds
	s_add_u32 s36, s48, 2097152
	s_add_u32 m0, s44, 65536
	s_nop 0
	buffer_load_dwordx4 v100, s[8:11], s36 offen nt lds
	s_add_u32 s36, s48, 2129920
	s_add_u32 m0, s44, 66560
	s_nop 0
	buffer_load_dwordx4 v100, s[8:11], s36 offen nt lds
	s_add_u32 s36, s48, 2162688
	s_add_u32 m0, s44, 67584
	s_nop 0
	buffer_load_dwordx4 v100, s[8:11], s36 offen nt lds
	s_add_u32 s36, s48, 2195456
	s_add_u32 m0, s44, 68608
	s_nop 0
	buffer_load_dwordx4 v100, s[8:11], s36 offen nt lds
	s_add_u32 s36, s48, 2621440
	s_add_u32 m0, s44, 81920
	s_nop 0
	buffer_load_dwordx4 v100, s[8:11], s36 offen nt lds
	s_add_u32 s36, s48, 2654208
	s_add_u32 m0, s44, 82944
	s_nop 0
	buffer_load_dwordx4 v100, s[8:11], s36 offen nt lds
	s_add_u32 s36, s48, 2686976
	s_add_u32 m0, s44, 83968
	s_nop 0
	buffer_load_dwordx4 v100, s[8:11], s36 offen nt lds
	s_add_u32 s36, s48, 2719744
	s_add_u32 m0, s44, 84992
	s_nop 0
	buffer_load_dwordx4 v100, s[8:11], s36 offen nt lds
	s_add_u32 s36, s48, 3145728
	s_add_u32 m0, s44, 98304
	s_nop 0
	buffer_load_dwordx4 v100, s[8:11], s36 offen nt lds
	s_add_u32 s36, s48, 3178496
	s_add_u32 m0, s44, 99328
	s_nop 0
	buffer_load_dwordx4 v100, s[8:11], s36 offen nt lds
	s_add_u32 s36, s48, 3211264
	s_add_u32 m0, s44, 100352
	s_nop 0
	buffer_load_dwordx4 v100, s[8:11], s36 offen nt lds
	s_add_u32 s36, s48, 3244032
	s_add_u32 m0, s44, 101376
	s_nop 0
	buffer_load_dwordx4 v100, s[8:11], s36 offen nt lds
	s_add_u32 s36, s48, 3670016
	s_add_u32 m0, s44, 114688
	s_nop 0
	buffer_load_dwordx4 v100, s[8:11], s36 offen nt lds
	s_add_u32 s36, s48, 3702784
	s_add_u32 m0, s44, 115712
	s_nop 0
	buffer_load_dwordx4 v100, s[8:11], s36 offen nt lds
	s_add_u32 s36, s48, 3735552
	s_add_u32 m0, s44, 116736
	s_nop 0
	buffer_load_dwordx4 v100, s[8:11], s36 offen nt lds
	s_add_u32 s36, s48, 3768320
	s_add_u32 m0, s44, 117760
	s_nop 0
	buffer_load_dwordx4 v100, s[8:11], s36 offen nt lds
	s_add_u32 s36, s48, 4194304
	s_add_u32 m0, s44, 131072
	s_nop 0
	buffer_load_dwordx4 v100, s[8:11], s36 offen nt lds
	s_add_u32 s36, s48, 4227072
	s_add_u32 m0, s44, 132096
	s_nop 0
	buffer_load_dwordx4 v100, s[8:11], s36 offen nt lds
	s_add_u32 s36, s48, 4259840
	s_add_u32 m0, s44, 133120
	s_nop 0
	buffer_load_dwordx4 v100, s[8:11], s36 offen nt lds
	s_add_u32 s36, s48, 4292608
	s_add_u32 m0, s44, 134144
	s_nop 0
	buffer_load_dwordx4 v100, s[8:11], s36 offen nt lds
	s_lshl_b32 s36, s26, 6
	v_xor_b32 v101, s36, v101
	s_waitcnt vmcnt(32)
	s_waitcnt lgkmcnt(0)
	s_barrier
	s_add_u32 s36, s49, 0
	s_add_u32 m0, s44, 147456
	s_nop 0
	buffer_load_dwordx4 v100, s[12:15], s36 offen nt lds
	s_add_u32 s36, s49, 32768
	s_add_u32 m0, s44, 148480
	s_nop 0
	buffer_load_dwordx4 v100, s[12:15], s36 offen nt lds
	s_add_u32 s36, s49, 65536
	s_add_u32 m0, s44, 149504
	s_nop 0
	buffer_load_dwordx4 v100, s[12:15], s36 offen nt lds
	s_add_u32 s36, s49, 98304
	s_add_u32 m0, s44, 150528
	s_nop 0
	buffer_load_dwordx4 v100, s[12:15], s36 offen nt lds
	v_add_u32 v8, 0, v101
	ds_read_b64_tr_b16 a[0:1], v8 offset:0
	ds_read_b64_tr_b16 a[2:3], v8 offset:1024
	ds_read_b64_tr_b16 a[4:5], v8 offset:4096
	ds_read_b64_tr_b16 a[6:7], v8 offset:5120
	ds_read_b64_tr_b16 a[8:9], v8 offset:8192
	ds_read_b64_tr_b16 a[10:11], v8 offset:9216
	ds_read_b64_tr_b16 a[12:13], v8 offset:12288
	ds_read_b64_tr_b16 a[14:15], v8 offset:13312
	s_waitcnt vmcnt(32)
	s_waitcnt lgkmcnt(0)
	s_barrier
	s_add_u32 s36, s49, 524288
	s_add_u32 m0, s44, 0
	s_nop 0
	buffer_load_dwordx4 v100, s[12:15], s36 offen nt lds
	s_add_u32 s36, s49, 557056
	s_add_u32 m0, s44, 1024
	s_nop 0
	buffer_load_dwordx4 v100, s[12:15], s36 offen nt lds
	s_add_u32 s36, s49, 589824
	s_add_u32 m0, s44, 2048
	s_nop 0
	buffer_load_dwordx4 v100, s[12:15], s36 offen nt lds
	s_add_u32 s36, s49, 622592
	s_add_u32 m0, s44, 3072
	s_nop 0
	buffer_load_dwordx4 v100, s[12:15], s36 offen nt lds
	v_add_u32 v8, 16384, v101
	ds_read_b64_tr_b16 a[16:17], v8 offset:0
	ds_read_b64_tr_b16 a[18:19], v8 offset:1024
	ds_read_b64_tr_b16 a[20:21], v8 offset:4096
	ds_read_b64_tr_b16 a[22:23], v8 offset:5120
	ds_read_b64_tr_b16 a[24:25], v8 offset:8192
	ds_read_b64_tr_b16 a[26:27], v8 offset:9216
	ds_read_b64_tr_b16 a[28:29], v8 offset:12288
	ds_read_b64_tr_b16 a[30:31], v8 offset:13312
	s_waitcnt vmcnt(32)
	s_waitcnt lgkmcnt(0)
	s_barrier
	s_add_u32 s36, s49, 1048576
	s_add_u32 m0, s44, 16384
	s_nop 0
	buffer_load_dwordx4 v100, s[12:15], s36 offen nt lds
	s_add_u32 s36, s49, 1081344
	s_add_u32 m0, s44, 17408
	s_nop 0
	buffer_load_dwordx4 v100, s[12:15], s36 offen nt lds
	s_add_u32 s36, s49, 1114112
	s_add_u32 m0, s44, 18432
	s_nop 0
	buffer_load_dwordx4 v100, s[12:15], s36 offen nt lds
	s_add_u32 s36, s49, 1146880
	s_add_u32 m0, s44, 19456
	s_nop 0
	buffer_load_dwordx4 v100, s[12:15], s36 offen nt lds
	v_add_u32 v8, 32768, v101
	ds_read_b64_tr_b16 a[32:33], v8 offset:0
	ds_read_b64_tr_b16 a[34:35], v8 offset:1024
	ds_read_b64_tr_b16 a[36:37], v8 offset:4096
	ds_read_b64_tr_b16 a[38:39], v8 offset:5120
	ds_read_b64_tr_b16 a[40:41], v8 offset:8192
	ds_read_b64_tr_b16 a[42:43], v8 offset:9216
	ds_read_b64_tr_b16 a[44:45], v8 offset:12288
	ds_read_b64_tr_b16 a[46:47], v8 offset:13312
	s_waitcnt vmcnt(32)
	s_waitcnt lgkmcnt(0)
	s_barrier
	s_add_u32 s36, s49, 1572864
	s_add_u32 m0, s44, 32768
	s_nop 0
	buffer_load_dwordx4 v100, s[12:15], s36 offen nt lds
	s_add_u32 s36, s49, 1605632
	s_add_u32 m0, s44, 33792
	s_nop 0
	buffer_load_dwordx4 v100, s[12:15], s36 offen nt lds
	s_add_u32 s36, s49, 1638400
	s_add_u32 m0, s44, 34816
	s_nop 0
	buffer_load_dwordx4 v100, s[12:15], s36 offen nt lds
	s_add_u32 s36, s49, 1671168
	s_add_u32 m0, s44, 35840
	s_nop 0
	buffer_load_dwordx4 v100, s[12:15], s36 offen nt lds
	v_add_u32 v8, 49152, v101
	ds_read_b64_tr_b16 a[48:49], v8 offset:0
	ds_read_b64_tr_b16 a[50:51], v8 offset:1024
	ds_read_b64_tr_b16 a[52:53], v8 offset:4096
	ds_read_b64_tr_b16 a[54:55], v8 offset:5120
	ds_read_b64_tr_b16 a[56:57], v8 offset:8192
	ds_read_b64_tr_b16 a[58:59], v8 offset:9216
	ds_read_b64_tr_b16 a[60:61], v8 offset:12288
	ds_read_b64_tr_b16 a[62:63], v8 offset:13312
	s_waitcnt vmcnt(32)
	s_waitcnt lgkmcnt(0)
	s_barrier
	s_add_u32 s36, s49, 2097152
	s_add_u32 m0, s44, 49152
	s_nop 0
	buffer_load_dwordx4 v100, s[12:15], s36 offen nt lds
	s_add_u32 s36, s49, 2129920
	s_add_u32 m0, s44, 50176
	s_nop 0
	buffer_load_dwordx4 v100, s[12:15], s36 offen nt lds
	s_add_u32 s36, s49, 2162688
	s_add_u32 m0, s44, 51200
	s_nop 0
	buffer_load_dwordx4 v100, s[12:15], s36 offen nt lds
	s_add_u32 s36, s49, 2195456
	s_add_u32 m0, s44, 52224
	s_nop 0
	buffer_load_dwordx4 v100, s[12:15], s36 offen nt lds
	v_add_u32 v8, 65536, v101
	ds_read_b64_tr_b16 a[64:65], v8 offset:0
	ds_read_b64_tr_b16 a[66:67], v8 offset:1024
	ds_read_b64_tr_b16 a[68:69], v8 offset:4096
	ds_read_b64_tr_b16 a[70:71], v8 offset:5120
	ds_read_b64_tr_b16 a[72:73], v8 offset:8192
	ds_read_b64_tr_b16 a[74:75], v8 offset:9216
	ds_read_b64_tr_b16 a[76:77], v8 offset:12288
	ds_read_b64_tr_b16 a[78:79], v8 offset:13312
	s_waitcnt vmcnt(32)
	s_waitcnt lgkmcnt(0)
	s_barrier
	s_add_u32 s36, s49, 2621440
	s_add_u32 m0, s44, 65536
	s_nop 0
	buffer_load_dwordx4 v100, s[12:15], s36 offen nt lds
	s_add_u32 s36, s49, 2654208
	s_add_u32 m0, s44, 66560
	s_nop 0
	buffer_load_dwordx4 v100, s[12:15], s36 offen nt lds
	s_add_u32 s36, s49, 2686976
	s_add_u32 m0, s44, 67584
	s_nop 0
	buffer_load_dwordx4 v100, s[12:15], s36 offen nt lds
	s_add_u32 s36, s49, 2719744
	s_add_u32 m0, s44, 68608
	s_nop 0
	buffer_load_dwordx4 v100, s[12:15], s36 offen nt lds
	v_add_u32 v8, 81920, v101
	ds_read_b64_tr_b16 a[80:81], v8 offset:0
	ds_read_b64_tr_b16 a[82:83], v8 offset:1024
	ds_read_b64_tr_b16 a[84:85], v8 offset:4096
	ds_read_b64_tr_b16 a[86:87], v8 offset:5120
	ds_read_b64_tr_b16 a[88:89], v8 offset:8192
	ds_read_b64_tr_b16 a[90:91], v8 offset:9216
	ds_read_b64_tr_b16 a[92:93], v8 offset:12288
	ds_read_b64_tr_b16 a[94:95], v8 offset:13312
	s_waitcnt vmcnt(32)
	s_waitcnt lgkmcnt(0)
	s_barrier
	s_add_u32 s36, s49, 3145728
	s_add_u32 m0, s44, 81920
	s_nop 0
	buffer_load_dwordx4 v100, s[12:15], s36 offen nt lds
	s_add_u32 s36, s49, 3178496
	s_add_u32 m0, s44, 82944
	s_nop 0
	buffer_load_dwordx4 v100, s[12:15], s36 offen nt lds
	s_add_u32 s36, s49, 3211264
	s_add_u32 m0, s44, 83968
	s_nop 0
	buffer_load_dwordx4 v100, s[12:15], s36 offen nt lds
	s_add_u32 s36, s49, 3244032
	s_add_u32 m0, s44, 84992
	s_nop 0
	buffer_load_dwordx4 v100, s[12:15], s36 offen nt lds
	v_add_u32 v8, 98304, v101
	ds_read_b64_tr_b16 a[96:97], v8 offset:0
	ds_read_b64_tr_b16 a[98:99], v8 offset:1024
	ds_read_b64_tr_b16 a[100:101], v8 offset:4096
	ds_read_b64_tr_b16 a[102:103], v8 offset:5120
	ds_read_b64_tr_b16 a[104:105], v8 offset:8192
	ds_read_b64_tr_b16 a[106:107], v8 offset:9216
	ds_read_b64_tr_b16 a[108:109], v8 offset:12288
	ds_read_b64_tr_b16 a[110:111], v8 offset:13312
	s_waitcnt vmcnt(32)
	s_waitcnt lgkmcnt(0)
	s_barrier
	s_add_u32 s36, s49, 3670016
	s_add_u32 m0, s44, 98304
	s_nop 0
	buffer_load_dwordx4 v100, s[12:15], s36 offen nt lds
	s_add_u32 s36, s49, 3702784
	s_add_u32 m0, s44, 99328
	s_nop 0
	buffer_load_dwordx4 v100, s[12:15], s36 offen nt lds
	s_add_u32 s36, s49, 3735552
	s_add_u32 m0, s44, 100352
	s_nop 0
	buffer_load_dwordx4 v100, s[12:15], s36 offen nt lds
	s_add_u32 s36, s49, 3768320
	s_add_u32 m0, s44, 101376
	s_nop 0
	buffer_load_dwordx4 v100, s[12:15], s36 offen nt lds
	v_add_u32 v8, 114688, v101
	ds_read_b64_tr_b16 a[112:113], v8 offset:0
	ds_read_b64_tr_b16 a[114:115], v8 offset:1024
	ds_read_b64_tr_b16 a[116:117], v8 offset:4096
	ds_read_b64_tr_b16 a[118:119], v8 offset:5120
	ds_read_b64_tr_b16 a[120:121], v8 offset:8192
	ds_read_b64_tr_b16 a[122:123], v8 offset:9216
	ds_read_b64_tr_b16 a[124:125], v8 offset:12288
	ds_read_b64_tr_b16 a[126:127], v8 offset:13312
	s_waitcnt vmcnt(32)
	s_waitcnt lgkmcnt(0)
	s_barrier
	s_add_u32 s36, s49, 4194304
	s_add_u32 m0, s44, 114688
	s_nop 0
	buffer_load_dwordx4 v100, s[12:15], s36 offen nt lds
	s_add_u32 s36, s49, 4227072
	s_add_u32 m0, s44, 115712
	s_nop 0
	buffer_load_dwordx4 v100, s[12:15], s36 offen nt lds
	s_add_u32 s36, s49, 4259840
	s_add_u32 m0, s44, 116736
	s_nop 0
	buffer_load_dwordx4 v100, s[12:15], s36 offen nt lds
	s_add_u32 s36, s49, 4292608
	s_add_u32 m0, s44, 117760
	s_nop 0
	buffer_load_dwordx4 v100, s[12:15], s36 offen nt lds
	v_add_u32 v8, 131072, v101
	ds_read_b64_tr_b16 a[128:129], v8 offset:0
	ds_read_b64_tr_b16 a[130:131], v8 offset:1024
	ds_read_b64_tr_b16 a[132:133], v8 offset:4096
	ds_read_b64_tr_b16 a[134:135], v8 offset:5120
	ds_read_b64_tr_b16 a[136:137], v8 offset:8192
	ds_read_b64_tr_b16 a[138:139], v8 offset:9216
	ds_read_b64_tr_b16 a[140:141], v8 offset:12288
	ds_read_b64_tr_b16 a[142:143], v8 offset:13312
	s_waitcnt vmcnt(32)
	s_waitcnt lgkmcnt(0)
	s_barrier
	v_add_u32 v8, 147456, v101
	ds_read_b64_tr_b16 a[144:145], v8 offset:0
	ds_read_b64_tr_b16 a[146:147], v8 offset:1024
	ds_read_b64_tr_b16 a[148:149], v8 offset:4096
	ds_read_b64_tr_b16 a[150:151], v8 offset:5120
	ds_read_b64_tr_b16 a[152:153], v8 offset:8192
	ds_read_b64_tr_b16 a[154:155], v8 offset:9216
	ds_read_b64_tr_b16 a[156:157], v8 offset:12288
	ds_read_b64_tr_b16 a[158:159], v8 offset:13312
	s_waitcnt vmcnt(28)
	s_waitcnt lgkmcnt(0)
	s_barrier
	v_add_u32 v8, 0, v101
	ds_read_b64_tr_b16 a[160:161], v8 offset:0
	ds_read_b64_tr_b16 a[162:163], v8 offset:1024
	ds_read_b64_tr_b16 a[164:165], v8 offset:4096
	ds_read_b64_tr_b16 a[166:167], v8 offset:5120
	ds_read_b64_tr_b16 a[168:169], v8 offset:8192
	ds_read_b64_tr_b16 a[170:171], v8 offset:9216
	ds_read_b64_tr_b16 a[172:173], v8 offset:12288
	ds_read_b64_tr_b16 a[174:175], v8 offset:13312
	s_waitcnt vmcnt(24)
	s_waitcnt lgkmcnt(0)
	s_barrier
	v_add_u32 v8, 16384, v101
	ds_read_b64_tr_b16 a[176:177], v8 offset:0
	ds_read_b64_tr_b16 a[178:179], v8 offset:1024
	ds_read_b64_tr_b16 a[180:181], v8 offset:4096
	ds_read_b64_tr_b16 a[182:183], v8 offset:5120
	ds_read_b64_tr_b16 a[184:185], v8 offset:8192
	ds_read_b64_tr_b16 a[186:187], v8 offset:9216
	ds_read_b64_tr_b16 a[188:189], v8 offset:12288
	ds_read_b64_tr_b16 a[190:191], v8 offset:13312
	s_waitcnt vmcnt(20)
	s_waitcnt lgkmcnt(0)
	s_barrier
	v_add_u32 v8, 32768, v101
	ds_read_b64_tr_b16 a[192:193], v8 offset:0
	ds_read_b64_tr_b16 a[194:195], v8 offset:1024
	ds_read_b64_tr_b16 a[196:197], v8 offset:4096
	ds_read_b64_tr_b16 a[198:199], v8 offset:5120
	ds_read_b64_tr_b16 a[200:201], v8 offset:8192
	ds_read_b64_tr_b16 a[202:203], v8 offset:9216
	ds_read_b64_tr_b16 a[204:205], v8 offset:12288
	ds_read_b64_tr_b16 a[206:207], v8 offset:13312
	s_waitcnt vmcnt(16)
	s_waitcnt lgkmcnt(0)
	s_barrier
	v_add_u32 v8, 49152, v101
	ds_read_b64_tr_b16 a[208:209], v8 offset:0
	ds_read_b64_tr_b16 a[210:211], v8 offset:1024
	ds_read_b64_tr_b16 a[212:213], v8 offset:4096
	ds_read_b64_tr_b16 a[214:215], v8 offset:5120
	ds_read_b64_tr_b16 a[216:217], v8 offset:8192
	ds_read_b64_tr_b16 a[218:219], v8 offset:9216
	ds_read_b64_tr_b16 a[220:221], v8 offset:12288
	ds_read_b64_tr_b16 a[222:223], v8 offset:13312
	s_waitcnt vmcnt(12)
	s_waitcnt lgkmcnt(0)
	s_barrier
	v_add_u32 v8, 65536, v101
	ds_read_b64_tr_b16 a[224:225], v8 offset:0
	ds_read_b64_tr_b16 a[226:227], v8 offset:1024
	ds_read_b64_tr_b16 a[228:229], v8 offset:4096
	ds_read_b64_tr_b16 a[230:231], v8 offset:5120
	ds_read_b64_tr_b16 a[232:233], v8 offset:8192
	ds_read_b64_tr_b16 a[234:235], v8 offset:9216
	ds_read_b64_tr_b16 a[236:237], v8 offset:12288
	ds_read_b64_tr_b16 a[238:239], v8 offset:13312
	s_waitcnt vmcnt(8)
	s_waitcnt lgkmcnt(0)
	s_barrier
	v_add_u32 v8, 81920, v101
	ds_read_b64_tr_b16 a[240:241], v8 offset:0
	ds_read_b64_tr_b16 a[242:243], v8 offset:1024
	ds_read_b64_tr_b16 a[244:245], v8 offset:4096
	ds_read_b64_tr_b16 a[246:247], v8 offset:5120
	ds_read_b64_tr_b16 a[248:249], v8 offset:8192
	ds_read_b64_tr_b16 a[250:251], v8 offset:9216
	ds_read_b64_tr_b16 a[252:253], v8 offset:12288
	ds_read_b64_tr_b16 a[254:255], v8 offset:13312
	s_waitcnt vmcnt(4)
	s_waitcnt lgkmcnt(0)
	s_barrier
	v_add_u32 v8, 98304, v101
	ds_read_b64_tr_b16 v[112:113], v8 offset:0
	ds_read_b64_tr_b16 v[114:115], v8 offset:1024
	ds_read_b64_tr_b16 v[116:117], v8 offset:4096
	ds_read_b64_tr_b16 v[118:119], v8 offset:5120
	ds_read_b64_tr_b16 v[120:121], v8 offset:8192
	ds_read_b64_tr_b16 v[122:123], v8 offset:9216
	ds_read_b64_tr_b16 v[124:125], v8 offset:12288
	ds_read_b64_tr_b16 v[126:127], v8 offset:13312
	s_waitcnt vmcnt(0)
	s_waitcnt lgkmcnt(0)
	s_barrier
	v_add_u32 v8, 114688, v101
	ds_read_b64_tr_b16 v[128:129], v8 offset:0
	ds_read_b64_tr_b16 v[130:131], v8 offset:1024
	ds_read_b64_tr_b16 v[132:133], v8 offset:4096
	ds_read_b64_tr_b16 v[134:135], v8 offset:5120
	ds_read_b64_tr_b16 v[136:137], v8 offset:8192
	ds_read_b64_tr_b16 v[138:139], v8 offset:9216
	ds_read_b64_tr_b16 v[140:141], v8 offset:12288
	ds_read_b64_tr_b16 v[142:143], v8 offset:13312
	s_waitcnt lgkmcnt(0)
	s_barrier
	v_add_u32 v2, 36864, v0
	v_xor_b32 v2, v2, v0
	s_lshl_b32 s32, s27, 7
	s_lshl_b32 s36, s26, 2
	s_add_u32 s32, s32, s36
	s_add_u32 s32, s32, 0x3308000
	s_mov_b32 s30, 0x3400000
	s_mov_b32 s33, 0x3300000
	s_lshl_b32 s31, s27, 14
	s_lshl_b32 s36, s26, 10
	s_add_u32 s31, s31, s36
	s_add_u32 s31, s31, 0x9000000
	s_mul_i32 s36, s26, 3072
	s_add_u32 s30, s30, s36
	s_mov_b32 s35, s36
	s_lshl_b32 s46, s36, 1
	s_add_u32 s46, s46, 36864
	v_mov_b32 v1, v0
	s_mov_b32 s28, 0
	s_mov_b32 s29, 1
	v_mov_b32 v8, 0
q_init:
	global_load_dword v9, v8, s[24:25] offset:8 sc1
	s_sub_u32 s34, s34, 1
	s_cbranch_scc1 all_exit
	s_waitcnt vmcnt(0)
	v_readfirstlane_b32 s36, v9
	s_cmp_eq_u32 s36, 0
	s_cbranch_scc1 q_init
	s_branch q_spin
q_loop:
	s_waitcnt vmcnt(10)
	s_barrier
	buffer_load_dword v96, v104, s[4:7], s33 offen sc1
	ds_read_b128 v[40:43], v1 offset:0
	ds_read_b128 v[44:47], v1 offset:1024
	ds_read_b128 v[48:51], v1 offset:2048
	s_waitcnt lgkmcnt(2)
	v_mfma_f32_32x32x16_bf16 v[8:23], a[0:3], v[40:43], 0
	ds_read_b128 v[52:55], v1 offset:3072
	v_mfma_f32_32x32x16_bf16 v[24:39], a[144:147], v[40:43], 0
	s_waitcnt lgkmcnt(2)
	v_mfma_f32_32x32x16_bf16 v[8:23], a[4:7], v[44:47], v[8:23]
	ds_read_b128 v[56:59], v1 offset:4096
	v_mfma_f32_32x32x16_bf16 v[24:39], a[148:151], v[44:47], v[24:39]
	s_waitcnt lgkmcnt(2)
	v_mfma_f32_32x32x16_bf16 v[8:23], a[8:11], v[48:51], v[8:23]
	ds_read_b128 v[60:63], v1 offset:5120
	v_mfma_f32_32x32x16_bf16 v[24:39], a[152:155], v[48:51], v[24:39]
	s_waitcnt lgkmcnt(2)
	v_mfma_f32_32x32x16_bf16 v[8:23], a[12:15], v[52:55], v[8:23]
	ds_read_b128 v[64:67], v1 offset:6144
	v_mfma_f32_32x32x16_bf16 v[24:39], a[156:159], v[52:55], v[24:39]
	s_waitcnt lgkmcnt(2)
	v_mfma_f32_32x32x16_bf16 v[8:23], a[16:19], v[56:59], v[8:23]
	ds_read_b128 v[68:71], v1 offset:7168
	v_mfma_f32_32x32x16_bf16 v[24:39], a[160:163], v[56:59], v[24:39]
	s_waitcnt lgkmcnt(2)
	v_mfma_f32_32x32x16_bf16 v[8:23], a[20:23], v[60:63], v[8:23]
	ds_read_b128 v[40:43], v1 offset:8192
	v_mfma_f32_32x32x16_bf16 v[24:39], a[164:167], v[60:63], v[24:39]
	s_waitcnt lgkmcnt(2)
	v_mfma_f32_32x32x16_bf16 v[8:23], a[24:27], v[64:67], v[8:23]
	ds_read_b128 v[44:47], v1 offset:9216
	v_mfma_f32_32x32x16_bf16 v[24:39], a[168:171], v[64:67], v[24:39]
	s_waitcnt lgkmcnt(2)
	v_mfma_f32_32x32x16_bf16 v[8:23], a[28:31], v[68:71], v[8:23]
	ds_read_b128 v[48:51], v1 offset:10240
	v_mfma_f32_32x32x16_bf16 v[24:39], a[172:175], v[68:71], v[24:39]
	s_waitcnt lgkmcnt(2)
	v_mfma_f32_32x32x16_bf16 v[8:23], a[32:35], v[40:43], v[8:23]
	ds_read_b128 v[52:55], v1 offset:11264
	v_mfma_f32_32x32x16_bf16 v[24:39], a[176:179], v[40:43], v[24:39]
	s_waitcnt lgkmcnt(2)
	v_mfma_f32_32x32x16_bf16 v[8:23], a[36:39], v[44:47], v[8:23]
	s_waitcnt vmcnt(8)
	s_barrier
	ds_read_b128 v[56:59], v1 offset:12288
	v_mfma_f32_32x32x16_bf16 v[24:39], a[180:183], v[44:47], v[24:39]
	s_waitcnt lgkmcnt(2)
	v_mfma_f32_32x32x16_bf16 v[8:23], a[40:43], v[48:51], v[8:23]
	ds_read_b128 v[60:63], v1 offset:13312
	v_mfma_f32_32x32x16_bf16 v[24:39], a[184:187], v[48:51], v[24:39]
	s_waitcnt lgkmcnt(2)
	v_mfma_f32_32x32x16_bf16 v[8:23], a[44:47], v[52:55], v[8:23]
	ds_read_b128 v[64:67], v1 offset:14336
	v_mfma_f32_32x32x16_bf16 v[24:39], a[188:191], v[52:55], v[24:39]
	s_waitcnt lgkmcnt(2)
	v_mfma_f32_32x32x16_bf16 v[8:23], a[48:51], v[56:59], v[8:23]
	ds_read_b128 v[68:71], v1 offset:15360
	v_mfma_f32_32x32x16_bf16 v[24:39], a[192:195], v[56:59], v[24:39]
	s_waitcnt lgkmcnt(2)
	v_mfma_f32_32x32x16_bf16 v[8:23], a[52:55], v[60:63], v[8:23]
	ds_read_b128 v[40:43], v1 offset:16384
	v_mfma_f32_32x32x16_bf16 v[24:39], a[196:199], v[60:63], v[24:39]
	s_waitcnt lgkmcnt(2)
	v_mfma_f32_32x32x16_bf16 v[8:23], a[56:59], v[64:67], v[8:23]
	ds_read_b128 v[44:47], v1 offset:17408
	v_mfma_f32_32x32x16_bf16 v[24:39], a[200:203], v[64:67], v[24:39]
	s_waitcnt lgkmcnt(2)
	v_mfma_f32_32x32x16_bf16 v[8:23], a[60:63], v[68:71], v[8:23]
	ds_read_b128 v[48:51], v1 offset:18432
	v_mfma_f32_32x32x16_bf16 v[24:39], a[204:207], v[68:71], v[24:39]
	s_waitcnt lgkmcnt(2)
	v_mfma_f32_32x32x16_bf16 v[8:23], a[64:67], v[40:43], v[8:23]
	ds_read_b128 v[52:55], v1 offset:19456
	v_mfma_f32_32x32x16_bf16 v[24:39], a[208:211], v[40:43], v[24:39]
	s_waitcnt lgkmcnt(2)
	v_mfma_f32_32x32x16_bf16 v[8:23], a[68:71], v[44:47], v[8:23]
	ds_read_b128 v[56:59], v1 offset:20480
	v_mfma_f32_32x32x16_bf16 v[24:39], a[212:215], v[44:47], v[24:39]
	s_waitcnt lgkmcnt(2)
	v_mfma_f32_32x32x16_bf16 v[8:23], a[72:75], v[48:51], v[8:23]
	ds_read_b128 v[60:63], v1 offset:21504
	v_mfma_f32_32x32x16_bf16 v[24:39], a[216:219], v[48:51], v[24:39]
	s_waitcnt lgkmcnt(2)
	v_mfma_f32_32x32x16_bf16 v[8:23], a[76:79], v[52:55], v[8:23]
	ds_read_b128 v[64:67], v1 offset:22528
	v_mfma_f32_32x32x16_bf16 v[24:39], a[220:223], v[52:55], v[24:39]
	s_waitcnt lgkmcnt(2)
	v_mfma_f32_32x32x16_bf16 v[8:23], a[80:83], v[56:59], v[8:23]
	ds_read_b128 v[68:71], v1 offset:23552
	v_mfma_f32_32x32x16_bf16 v[24:39], a[224:227], v[56:59], v[24:39]
	s_waitcnt lgkmcnt(2)
	v_mfma_f32_32x32x16_bf16 v[8:23], a[84:87], v[60:63], v[8:23]
	s_waitcnt vmcnt(0)
	s_barrier
	v_mov_b32 v98, s28
	s_mov_b64 exec, 1
	buffer_store_dword v98, off, s[4:7], s32 sc1
	s_mov_b64 exec, -1
	v_cmp_gt_u32 vcc, s29, v96
	s_mov_b32 s40, 0
	s_cbranch_vccnz q_late
	s_cmp_eq_u32 s28, 63
	s_cbranch_scc1 q_late
	s_mov_b32 m0, s35
	s_nop 0
	buffer_load_dwordx4 v0, s[4:7], s30 offen offset:0 sc1 lds
	buffer_load_dwordx4 v0, s[4:7], s30 offen offset:1024 sc1 lds
	buffer_load_dwordx4 v0, s[4:7], s30 offen offset:2048 sc1 lds
	s_add_u32 m0, s35, 12288
	s_add_u32 s36, s30, 12288
	buffer_load_dwordx4 v0, s[4:7], s36 offen offset:0 sc1 lds
	buffer_load_dwordx4 v0, s[4:7], s36 offen offset:1024 sc1 lds
	buffer_load_dwordx4 v0, s[4:7], s36 offen offset:2048 sc1 lds
	s_add_u32 m0, s35, 24576
	s_add_u32 s36, s30, 24576
	buffer_load_dwordx4 v0, s[4:7], s36 offen offset:0 sc1 lds
	buffer_load_dwordx4 v0, s[4:7], s36 offen offset:1024 sc1 lds
	buffer_load_dwordx4 v0, s[4:7], s36 offen offset:2048 sc1 lds
	s_add_u32 s30, s30, 36864
	s_sub_u32 s35, s46, s35
	s_mov_b32 s40, 1
q_late:
	ds_read_b128 v[40:43], v1 offset:24576
	v_mfma_f32_32x32x16_bf16 v[24:39], a[228:231], v[60:63], v[24:39]
	s_waitcnt lgkmcnt(2)
	v_mfma_f32_32x32x16_bf16 v[8:23], a[88:91], v[64:67], v[8:23]
	ds_read_b128 v[44:47], v1 offset:25600
	v_mfma_f32_32x32x16_bf16 v[24:39], a[232:235], v[64:67], v[24:39]
	s_waitcnt lgkmcnt(2)
	v_mfma_f32_32x32x16_bf16 v[8:23], a[92:95], v[68:71], v[8:23]
	ds_read_b128 v[48:51], v1 offset:26624
	v_mfma_f32_32x32x16_bf16 v[24:39], a[236:239], v[68:71], v[24:39]
	s_waitcnt lgkmcnt(2)
	v_mfma_f32_32x32x16_bf16 v[8:23], a[96:99], v[40:43], v[8:23]
	ds_read_b128 v[52:55], v1 offset:27648
	v_mfma_f32_32x32x16_bf16 v[24:39], a[240:243], v[40:43], v[24:39]
	s_waitcnt lgkmcnt(2)
	v_mfma_f32_32x32x16_bf16 v[8:23], a[100:103], v[44:47], v[8:23]
	ds_read_b128 v[56:59], v1 offset:28672
	v_mfma_f32_32x32x16_bf16 v[24:39], a[244:247], v[44:47], v[24:39]
	s_waitcnt lgkmcnt(2)
	v_mfma_f32_32x32x16_bf16 v[8:23], a[104:107], v[48:51], v[8:23]
	ds_read_b128 v[60:63], v1 offset:29696
	v_mfma_f32_32x32x16_bf16 v[24:39], a[248:251], v[48:51], v[24:39]
	s_waitcnt lgkmcnt(2)
	v_mfma_f32_32x32x16_bf16 v[8:23], a[108:111], v[52:55], v[8:23]
	ds_read_b128 v[64:67], v1 offset:30720
	v_mfma_f32_32x32x16_bf16 v[24:39], a[252:255], v[52:55], v[24:39]
	s_waitcnt lgkmcnt(2)
	v_mfma_f32_32x32x16_bf16 v[8:23], a[112:115], v[56:59], v[8:23]
	ds_read_b128 v[68:71], v1 offset:31744
	v_mfma_f32_32x32x16_bf16 v[24:39], v[112:115], v[56:59], v[24:39]
	s_waitcnt lgkmcnt(2)
	v_mfma_f32_32x32x16_bf16 v[8:23], a[116:119], v[60:63], v[8:23]
	ds_read_b128 v[40:43], v1 offset:32768
	v_mfma_f32_32x32x16_bf16 v[24:39], v[116:119], v[60:63], v[24:39]
	s_waitcnt lgkmcnt(2)
	v_mfma_f32_32x32x16_bf16 v[8:23], a[120:123], v[64:67], v[8:23]
	ds_read_b128 v[44:47], v1 offset:33792
	v_mfma_f32_32x32x16_bf16 v[24:39], v[120:123], v[64:67], v[24:39]
	s_waitcnt lgkmcnt(2)
	v_mfma_f32_32x32x16_bf16 v[8:23], a[124:127], v[68:71], v[8:23]
	ds_read_b128 v[48:51], v1 offset:34816
	v_mfma_f32_32x32x16_bf16 v[24:39], v[124:127], v[68:71], v[24:39]
	s_waitcnt lgkmcnt(2)
	v_mfma_f32_32x32x16_bf16 v[8:23], a[128:131], v[40:43], v[8:23]
	ds_read_b128 v[52:55], v1 offset:35840
	v_mfma_f32_32x32x16_bf16 v[24:39], v[128:131], v[40:43], v[24:39]
	s_waitcnt lgkmcnt(2)
	v_mfma_f32_32x32x16_bf16 v[8:23], a[132:135], v[44:47], v[8:23]
	v_mfma_f32_32x32x16_bf16 v[24:39], v[132:135], v[44:47], v[24:39]
	s_waitcnt lgkmcnt(1)
	v_mfma_f32_32x32x16_bf16 v[8:23], a[136:139], v[48:51], v[8:23]
	v_mfma_f32_32x32x16_bf16 v[24:39], v[136:139], v[48:51], v[24:39]
	s_waitcnt lgkmcnt(0)
	v_mfma_f32_32x32x16_bf16 v[8:23], a[140:143], v[52:55], v[8:23]
	v_mfma_f32_32x32x16_bf16 v[24:39], v[140:143], v[52:55], v[24:39]
	v_xor_b32 v1, v2, v1
	s_nop 2
	v_cvt_pk_bf16_f32 v72, v8, v9
	v_cvt_pk_bf16_f32 v73, v10, v11
	v_cvt_pk_bf16_f32 v74, v12, v13
	v_cvt_pk_bf16_f32 v75, v14, v15
	v_cvt_pk_bf16_f32 v76, v16, v17
	v_cvt_pk_bf16_f32 v77, v18, v19
	v_cvt_pk_bf16_f32 v78, v20, v21
	v_cvt_pk_bf16_f32 v79, v22, v23
	buffer_store_dwordx4 v[72:75], v102, s[4:7], s31 offen offset:0 sc1
	buffer_store_dwordx4 v[76:79], v102, s[4:7], s31 offen offset:512 sc1
	v_cvt_pk_bf16_f32 v80, v24, v25
	v_cvt_pk_bf16_f32 v81, v26, v27
	v_cvt_pk_bf16_f32 v82, v28, v29
	v_cvt_pk_bf16_f32 v83, v30, v31
	v_cvt_pk_bf16_f32 v84, v32, v33
	v_cvt_pk_bf16_f32 v85, v34, v35
	v_cvt_pk_bf16_f32 v86, v36, v37
	v_cvt_pk_bf16_f32 v87, v38, v39
	buffer_store_dwordx4 v[80:83], v103, s[4:7], s31 offen offset:0 sc1
	buffer_store_dwordx4 v[84:87], v103, s[4:7], s31 offen offset:512 sc1
	s_add_u32 s31, s31, 262144
	s_add_u32 s28, s28, 1
	s_add_u32 s29, s29, 1
	s_add_u32 s33, s33, 128
	s_cmp_eq_u32 s40, 1
	s_cbranch_scc1 q_loop
	s_waitcnt vmcnt(0)
	v_mov_b32 v98, s28
	s_mov_b64 exec, 1
	buffer_store_dword v98, off, s[4:7], s32 sc1
	s_mov_b64 exec, -1
	s_cmp_eq_u32 s28, 64
	s_cbranch_scc1 q_more
	s_sub_u32 s29, s29, 1
	s_sub_u32 s33, s33, 128
q_spin:
q_sp:
	buffer_load_dword v96, v104, s[4:7], s33 offen sc1
	s_sub_u32 s34, s34, 1
	s_cbranch_scc1 all_exit
	s_waitcnt vmcnt(0)
	v_cmp_gt_u32 vcc, s29, v96
	s_cbranch_vccnz q_sp
	s_mov_b32 m0, s35
	s_nop 0
	buffer_load_dwordx4 v0, s[4:7], s30 offen offset:0 sc1 lds
	buffer_load_dwordx4 v0, s[4:7], s30 offen offset:1024 sc1 lds
	buffer_load_dwordx4 v0, s[4:7], s30 offen offset:2048 sc1 lds
	s_add_u32 m0, s35, 12288
	s_add_u32 s36, s30, 12288
	buffer_load_dwordx4 v0, s[4:7], s36 offen offset:0 sc1 lds
	buffer_load_dwordx4 v0, s[4:7], s36 offen offset:1024 sc1 lds
	buffer_load_dwordx4 v0, s[4:7], s36 offen offset:2048 sc1 lds
	s_add_u32 m0, s35, 24576
	s_add_u32 s36, s30, 24576
	buffer_load_dwordx4 v0, s[4:7], s36 offen offset:0 sc1 lds
	buffer_load_dwordx4 v0, s[4:7], s36 offen offset:1024 sc1 lds
	buffer_load_dwordx4 v0, s[4:7], s36 offen offset:2048 sc1 lds
	s_add_u32 s30, s30, 36864
	s_sub_u32 s35, s46, s35
	buffer_load_dword v97, v104, s[4:7], s33 offen sc1
	s_waitcnt vmcnt(0)
	buffer_load_dword v97, v104, s[4:7], s33 offen sc1
	s_waitcnt vmcnt(0)
	buffer_load_dword v97, v104, s[4:7], s33 offen sc1
	s_waitcnt vmcnt(0)
	buffer_load_dword v97, v104, s[4:7], s33 offen sc1
	s_add_u32 s29, s29, 1
	s_add_u32 s33, s33, 128
	s_branch q_loop
q_more:
	s_cmp_ge_u32 s27, 4
	s_cbranch_scc1 all_exit
	s_add_u32 s27, s27, 32
kv_more:
	s_mov_b32 s41, 1
	s_waitcnt vmcnt(0) lgkmcnt(0)
	s_barrier
	s_branch gu_both
gu_entry:
	s_mov_b32 s41, 0
gu_both:
	v_add_u32 v8, 5120, v0
	global_load_dwordx4 v[100:103], v8, s[64:65]
	global_load_dwordx4 v[104:107], v8, s[64:65] offset:1024
	s_load_dwordx2 s[8:9], s[0:1], 64
	s_mov_b32 s10, 5308416
	s_mov_b32 s11, 0x00020000
	s_load_dwordx2 s[12:13], s[0:1], 72
	s_mov_b32 s14, 5308416
	s_mov_b32 s15, 0x00020000
	s_mul_i32 s48, s26, 147456
	s_lshl_b32 s36, s27, 8
	s_add_u32 s48, s48, s36
	s_waitcnt vmcnt(0) lgkmcnt(0)
	s_cmp_eq_u32 s41, 1
	s_cbranch_scc1 gu_go
	v_mov_b32 v8, 0
gu_hold:
	global_load_dword v9, v8, s[24:25] offset:128 sc1
	s_sub_u32 s34, s34, 1
	s_cbranch_scc1 all_exit
	s_waitcnt vmcnt(0)
	v_readfirstlane_b32 s36, v9
	s_cmp_lt_u32 s36, 32
	s_cbranch_scc1 gu_hold
gu_go:
	s_add_u32 s36, s48, 0
	s_add_u32 m0, s44, 0
	s_nop 0
	buffer_load_dwordx4 v100, s[8:11], s36 offen nt lds
	s_add_u32 s36, s48, 36864
	s_add_u32 m0, s44, 1024
	s_nop 0
	buffer_load_dwordx4 v100, s[8:11], s36 offen nt lds
	s_add_u32 s36, s48, 73728
	s_add_u32 m0, s44, 2048
	s_nop 0
	buffer_load_dwordx4 v100, s[8:11], s36 offen nt lds
	s_add_u32 s36, s48, 110592
	s_add_u32 m0, s44, 3072
	s_nop 0
	buffer_load_dwordx4 v100, s[8:11], s36 offen nt lds
	s_add_u32 s36, s48, 589824
	s_add_u32 m0, s44, 16384
	s_nop 0
	buffer_load_dwordx4 v100, s[8:11], s36 offen nt lds
	s_add_u32 s36, s48, 626688
	s_add_u32 m0, s44, 17408
	s_nop 0
	buffer_load_dwordx4 v100, s[8:11], s36 offen nt lds
	s_add_u32 s36, s48, 663552
	s_add_u32 m0, s44, 18432
	s_nop 0
	buffer_load_dwordx4 v100, s[8:11], s36 offen nt lds
	s_add_u32 s36, s48, 700416
	s_add_u32 m0, s44, 19456
	s_nop 0
	buffer_load_dwordx4 v100, s[8:11], s36 offen nt lds
	s_add_u32 s36, s48, 1179648
	s_add_u32 m0, s44, 32768
	s_nop 0
	buffer_load_dwordx4 v100, s[8:11], s36 offen nt lds
	s_add_u32 s36, s48, 1216512
	s_add_u32 m0, s44, 33792
	s_nop 0
	buffer_load_dwordx4 v100, s[8:11], s36 offen nt lds
	s_add_u32 s36, s48, 1253376
	s_add_u32 m0, s44, 34816
	s_nop 0
	buffer_load_dwordx4 v100, s[8:11], s36 offen nt lds
	s_add_u32 s36, s48, 1290240
	s_add_u32 m0, s44, 35840
	s_nop 0
	buffer_load_dwordx4 v100, s[8:11], s36 offen nt lds
	s_add_u32 s36, s48, 1769472
	s_add_u32 m0, s44, 49152
	s_nop 0
	buffer_load_dwordx4 v100, s[8:11], s36 offen nt lds
	s_add_u32 s36, s48, 1806336
	s_add_u32 m0, s44, 50176
	s_nop 0
	buffer_load_dwordx4 v100, s[8:11], s36 offen nt lds
	s_add_u32 s36, s48, 1843200
	s_add_u32 m0, s44, 51200
	s_nop 0
	buffer_load_dwordx4 v100, s[8:11], s36 offen nt lds
	s_add_u32 s36, s48, 1880064
	s_add_u32 m0, s44, 52224
	s_nop 0
	buffer_load_dwordx4 v100, s[8:11], s36 offen nt lds
	s_add_u32 s36, s48, 2359296
	s_add_u32 m0, s44, 65536
	s_nop 0
	buffer_load_dwordx4 v100, s[8:11], s36 offen nt lds
	s_add_u32 s36, s48, 2396160
	s_add_u32 m0, s44, 66560
	s_nop 0
	buffer_load_dwordx4 v100, s[8:11], s36 offen nt lds
	s_add_u32 s36, s48, 2433024
	s_add_u32 m0, s44, 67584
	s_nop 0
	buffer_load_dwordx4 v100, s[8:11], s36 offen nt lds
	s_add_u32 s36, s48, 2469888
	s_add_u32 m0, s44, 68608
	s_nop 0
	buffer_load_dwordx4 v100, s[8:11], s36 offen nt lds
	s_add_u32 s36, s48, 2949120
	s_add_u32 m0, s44, 81920
	s_nop 0
	buffer_load_dwordx4 v100, s[8:11], s36 offen nt lds
	s_add_u32 s36, s48, 2985984
	s_add_u32 m0, s44, 82944
	s_nop 0
	buffer_load_dwordx4 v100, s[8:11], s36 offen nt lds
	s_add_u32 s36, s48, 3022848
	s_add_u32 m0, s44, 83968
	s_nop 0
	buffer_load_dwordx4 v100, s[8:11], s36 offen nt lds
	s_add_u32 s36, s48, 3059712
	s_add_u32 m0, s44, 84992
	s_nop 0
	buffer_load_dwordx4 v100, s[8:11], s36 offen nt lds
	s_add_u32 s36, s48, 3538944
	s_add_u32 m0, s44, 98304
	s_nop 0
	buffer_load_dwordx4 v100, s[8:11], s36 offen nt lds
	s_add_u32 s36, s48, 3575808
	s_add_u32 m0, s44, 99328
	s_nop 0
	buffer_load_dwordx4 v100, s[8:11], s36 offen nt lds
	s_add_u32 s36, s48, 3612672
	s_add_u32 m0, s44, 100352
	s_nop 0
	buffer_load_dwordx4 v100, s[8:11], s36 offen nt lds
	s_add_u32 s36, s48, 3649536
	s_add_u32 m0, s44, 101376
	s_nop 0
	buffer_load_dwordx4 v100, s[8:11], s36 offen nt lds
	s_add_u32 s36, s48, 4128768
	s_add_u32 m0, s44, 114688
	s_nop 0
	buffer_load_dwordx4 v100, s[8:11], s36 offen nt lds
	s_add_u32 s36, s48, 4165632
	s_add_u32 m0, s44, 115712
	s_nop 0
	buffer_load_dwordx4 v100, s[8:11], s36 offen nt lds
	s_add_u32 s36, s48, 4202496
	s_add_u32 m0, s44, 116736
	s_nop 0
	buffer_load_dwordx4 v100, s[8:11], s36 offen nt lds
	s_add_u32 s36, s48, 4239360
	s_add_u32 m0, s44, 117760
	s_nop 0
	buffer_load_dwordx4 v100, s[8:11], s36 offen nt lds
	s_add_u32 s36, s48, 4718592
	s_add_u32 m0, s44, 131072
	s_nop 0
	buffer_load_dwordx4 v100, s[8:11], s36 offen nt lds
	s_add_u32 s36, s48, 4755456
	s_add_u32 m0, s44, 132096
	s_nop 0
	buffer_load_dwordx4 v100, s[8:11], s36 offen nt lds
	s_add_u32 s36, s48, 4792320
	s_add_u32 m0, s44, 133120
	s_nop 0
	buffer_load_dwordx4 v100, s[8:11], s36 offen nt lds
	s_add_u32 s36, s48, 4829184
	s_add_u32 m0, s44, 134144
	s_nop 0
	buffer_load_dwordx4 v100, s[8:11], s36 offen nt lds
	s_lshl_b32 s36, s26, 6
	v_xor_b32 v101, s36, v101
	s_waitcnt vmcnt(32)
	s_waitcnt lgkmcnt(0)
	s_barrier
	s_add_u32 s36, s48, 0
	s_add_u32 m0, s44, 147456
	s_nop 0
	buffer_load_dwordx4 v100, s[12:15], s36 offen nt lds
	s_add_u32 s36, s48, 36864
	s_add_u32 m0, s44, 148480
	s_nop 0
	buffer_load_dwordx4 v100, s[12:15], s36 offen nt lds
	s_add_u32 s36, s48, 73728
	s_add_u32 m0, s44, 149504
	s_nop 0
	buffer_load_dwordx4 v100, s[12:15], s36 offen nt lds
	s_add_u32 s36, s48, 110592
	s_add_u32 m0, s44, 150528
	s_nop 0
	buffer_load_dwordx4 v100, s[12:15], s36 offen nt lds
	v_add_u32 v8, 0, v101
	ds_read_b64_tr_b16 a[0:1], v8 offset:0
	ds_read_b64_tr_b16 a[2:3], v8 offset:2048
	ds_read_b64_tr_b16 a[4:5], v8 offset:4096
	ds_read_b64_tr_b16 a[6:7], v8 offset:6144
	ds_read_b64_tr_b16 a[8:9], v8 offset:8192
	ds_read_b64_tr_b16 a[10:11], v8 offset:10240
	ds_read_b64_tr_b16 a[12:13], v8 offset:12288
	ds_read_b64_tr_b16 a[14:15], v8 offset:14336
	s_waitcnt vmcnt(32)
	s_waitcnt lgkmcnt(0)
	s_barrier
	s_add_u32 s36, s48, 589824
	s_add_u32 m0, s44, 0
	s_nop 0
	buffer_load_dwordx4 v100, s[12:15], s36 offen nt lds
	s_add_u32 s36, s48, 626688
	s_add_u32 m0, s44, 1024
	s_nop 0
	buffer_load_dwordx4 v100, s[12:15], s36 offen nt lds
	s_add_u32 s36, s48, 663552
	s_add_u32 m0, s44, 2048
	s_nop 0
	buffer_load_dwordx4 v100, s[12:15], s36 offen nt lds
	s_add_u32 s36, s48, 700416
	s_add_u32 m0, s44, 3072
	s_nop 0
	buffer_load_dwordx4 v100, s[12:15], s36 offen nt lds
	v_add_u32 v8, 16384, v101
	ds_read_b64_tr_b16 a[16:17], v8 offset:0
	ds_read_b64_tr_b16 a[18:19], v8 offset:2048
	ds_read_b64_tr_b16 a[20:21], v8 offset:4096
	ds_read_b64_tr_b16 a[22:23], v8 offset:6144
	ds_read_b64_tr_b16 a[24:25], v8 offset:8192
	ds_read_b64_tr_b16 a[26:27], v8 offset:10240
	ds_read_b64_tr_b16 a[28:29], v8 offset:12288
	ds_read_b64_tr_b16 a[30:31], v8 offset:14336
	s_waitcnt vmcnt(32)
	s_waitcnt lgkmcnt(0)
	s_barrier
	s_add_u32 s36, s48, 1179648
	s_add_u32 m0, s44, 16384
	s_nop 0
	buffer_load_dwordx4 v100, s[12:15], s36 offen nt lds
	s_add_u32 s36, s48, 1216512
	s_add_u32 m0, s44, 17408
	s_nop 0
	buffer_load_dwordx4 v100, s[12:15], s36 offen nt lds
	s_add_u32 s36, s48, 1253376
	s_add_u32 m0, s44, 18432
	s_nop 0
	buffer_load_dwordx4 v100, s[12:15], s36 offen nt lds
	s_add_u32 s36, s48, 1290240
	s_add_u32 m0, s44, 19456
	s_nop 0
	buffer_load_dwordx4 v100, s[12:15], s36 offen nt lds
	v_add_u32 v8, 32768, v101
	ds_read_b64_tr_b16 a[32:33], v8 offset:0
	ds_read_b64_tr_b16 a[34:35], v8 offset:2048
	ds_read_b64_tr_b16 a[36:37], v8 offset:4096
	ds_read_b64_tr_b16 a[38:39], v8 offset:6144
	ds_read_b64_tr_b16 a[40:41], v8 offset:8192
	ds_read_b64_tr_b16 a[42:43], v8 offset:10240
	ds_read_b64_tr_b16 a[44:45], v8 offset:12288
	ds_read_b64_tr_b16 a[46:47], v8 offset:14336
	s_waitcnt vmcnt(32)
	s_waitcnt lgkmcnt(0)
	s_barrier
	s_add_u32 s36, s48, 1769472
	s_add_u32 m0, s44, 32768
	s_nop 0
	buffer_load_dwordx4 v100, s[12:15], s36 offen nt lds
	s_add_u32 s36, s48, 1806336
	s_add_u32 m0, s44, 33792
	s_nop 0
	buffer_load_dwordx4 v100, s[12:15], s36 offen nt lds
	s_add_u32 s36, s48, 1843200
	s_add_u32 m0, s44, 34816
	s_nop 0
	buffer_load_dwordx4 v100, s[12:15], s36 offen nt lds
	s_add_u32 s36, s48, 1880064
	s_add_u32 m0, s44, 35840
	s_nop 0
	buffer_load_dwordx4 v100, s[12:15], s36 offen nt lds
	v_add_u32 v8, 49152, v101
	ds_read_b64_tr_b16 a[48:49], v8 offset:0
	ds_read_b64_tr_b16 a[50:51], v8 offset:2048
	ds_read_b64_tr_b16 a[52:53], v8 offset:4096
	ds_read_b64_tr_b16 a[54:55], v8 offset:6144
	ds_read_b64_tr_b16 a[56:57], v8 offset:8192
	ds_read_b64_tr_b16 a[58:59], v8 offset:10240
	ds_read_b64_tr_b16 a[60:61], v8 offset:12288
	ds_read_b64_tr_b16 a[62:63], v8 offset:14336
	s_waitcnt vmcnt(32)
	s_waitcnt lgkmcnt(0)
	s_barrier
	s_add_u32 s36, s48, 2359296
	s_add_u32 m0, s44, 49152
	s_nop 0
	buffer_load_dwordx4 v100, s[12:15], s36 offen nt lds
	s_add_u32 s36, s48, 2396160
	s_add_u32 m0, s44, 50176
	s_nop 0
	buffer_load_dwordx4 v100, s[12:15], s36 offen nt lds
	s_add_u32 s36, s48, 2433024
	s_add_u32 m0, s44, 51200
	s_nop 0
	buffer_load_dwordx4 v100, s[12:15], s36 offen nt lds
	s_add_u32 s36, s48, 2469888
	s_add_u32 m0, s44, 52224
	s_nop 0
	buffer_load_dwordx4 v100, s[12:15], s36 offen nt lds
	v_add_u32 v8, 65536, v101
	ds_read_b64_tr_b16 a[64:65], v8 offset:0
	ds_read_b64_tr_b16 a[66:67], v8 offset:2048
	ds_read_b64_tr_b16 a[68:69], v8 offset:4096
	ds_read_b64_tr_b16 a[70:71], v8 offset:6144
	ds_read_b64_tr_b16 a[72:73], v8 offset:8192
	ds_read_b64_tr_b16 a[74:75], v8 offset:10240
	ds_read_b64_tr_b16 a[76:77], v8 offset:12288
	ds_read_b64_tr_b16 a[78:79], v8 offset:14336
	s_waitcnt vmcnt(32)
	s_waitcnt lgkmcnt(0)
	s_barrier
	s_add_u32 s36, s48, 2949120
	s_add_u32 m0, s44, 65536
	s_nop 0
	buffer_load_dwordx4 v100, s[12:15], s36 offen nt lds
	s_add_u32 s36, s48, 2985984
	s_add_u32 m0, s44, 66560
	s_nop 0
	buffer_load_dwordx4 v100, s[12:15], s36 offen nt lds
	s_add_u32 s36, s48, 3022848
	s_add_u32 m0, s44, 67584
	s_nop 0
	buffer_load_dwordx4 v100, s[12:15], s36 offen nt lds
	s_add_u32 s36, s48, 3059712
	s_add_u32 m0, s44, 68608
	s_nop 0
	buffer_load_dwordx4 v100, s[12:15], s36 offen nt lds
	v_add_u32 v8, 81920, v101
	ds_read_b64_tr_b16 a[80:81], v8 offset:0
	ds_read_b64_tr_b16 a[82:83], v8 offset:2048
	ds_read_b64_tr_b16 a[84:85], v8 offset:4096
	ds_read_b64_tr_b16 a[86:87], v8 offset:6144
	ds_read_b64_tr_b16 a[88:89], v8 offset:8192
	ds_read_b64_tr_b16 a[90:91], v8 offset:10240
	ds_read_b64_tr_b16 a[92:93], v8 offset:12288
	ds_read_b64_tr_b16 a[94:95], v8 offset:14336
	s_waitcnt vmcnt(32)
	s_waitcnt lgkmcnt(0)
	s_barrier
	s_add_u32 s36, s48, 3538944
	s_add_u32 m0, s44, 81920
	s_nop 0
	buffer_load_dwordx4 v100, s[12:15], s36 offen nt lds
	s_add_u32 s36, s48, 3575808
	s_add_u32 m0, s44, 82944
	s_nop 0
	buffer_load_dwordx4 v100, s[12:15], s36 offen nt lds
	s_add_u32 s36, s48, 3612672
	s_add_u32 m0, s44, 83968
	s_nop 0
	buffer_load_dwordx4 v100, s[12:15], s36 offen nt lds
	s_add_u32 s36, s48, 3649536
	s_add_u32 m0, s44, 84992
	s_nop 0
	buffer_load_dwordx4 v100, s[12:15], s36 offen nt lds
	v_add_u32 v8, 98304, v101
	ds_read_b64_tr_b16 a[96:97], v8 offset:0
	ds_read_b64_tr_b16 a[98:99], v8 offset:2048
	ds_read_b64_tr_b16 a[100:101], v8 offset:4096
	ds_read_b64_tr_b16 a[102:103], v8 offset:6144
	ds_read_b64_tr_b16 a[104:105], v8 offset:8192
	ds_read_b64_tr_b16 a[106:107], v8 offset:10240
	ds_read_b64_tr_b16 a[108:109], v8 offset:12288
	ds_read_b64_tr_b16 a[110:111], v8 offset:14336
	s_waitcnt vmcnt(32)
	s_waitcnt lgkmcnt(0)
	s_barrier
	s_add_u32 s36, s48, 4128768
	s_add_u32 m0, s44, 98304
	s_nop 0
	buffer_load_dwordx4 v100, s[12:15], s36 offen nt lds
	s_add_u32 s36, s48, 4165632
	s_add_u32 m0, s44, 99328
	s_nop 0
	buffer_load_dwordx4 v100, s[12:15], s36 offen nt lds
	s_add_u32 s36, s48, 4202496
	s_add_u32 m0, s44, 100352
	s_nop 0
	buffer_load_dwordx4 v100, s[12:15], s36 offen nt lds
	s_add_u32 s36, s48, 4239360
	s_add_u32 m0, s44, 101376
	s_nop 0
	buffer_load_dwordx4 v100, s[12:15], s36 offen nt lds
	v_add_u32 v8, 114688, v101
	ds_read_b64_tr_b16 a[112:113], v8 offset:0
	ds_read_b64_tr_b16 a[114:115], v8 offset:2048
	ds_read_b64_tr_b16 a[116:117], v8 offset:4096
	ds_read_b64_tr_b16 a[118:119], v8 offset:6144
	ds_read_b64_tr_b16 a[120:121], v8 offset:8192
	ds_read_b64_tr_b16 a[122:123], v8 offset:10240
	ds_read_b64_tr_b16 a[124:125], v8 offset:12288
	ds_read_b64_tr_b16 a[126:127], v8 offset:14336
	s_waitcnt vmcnt(32)
	s_waitcnt lgkmcnt(0)
	s_barrier
	s_add_u32 s36, s48, 4718592
	s_add_u32 m0, s44, 114688
	s_nop 0
	buffer_load_dwordx4 v100, s[12:15], s36 offen nt lds
	s_add_u32 s36, s48, 4755456
	s_add_u32 m0, s44, 115712
	s_nop 0
	buffer_load_dwordx4 v100, s[12:15], s36 offen nt lds
	s_add_u32 s36, s48, 4792320
	s_add_u32 m0, s44, 116736
	s_nop 0
	buffer_load_dwordx4 v100, s[12:15], s36 offen nt lds
	s_add_u32 s36, s48, 4829184
	s_add_u32 m0, s44, 117760
	s_nop 0
	buffer_load_dwordx4 v100, s[12:15], s36 offen nt lds
	v_add_u32 v8, 131072, v101
	ds_read_b64_tr_b16 a[128:129], v8 offset:0
	ds_read_b64_tr_b16 a[130:131], v8 offset:2048
	ds_read_b64_tr_b16 a[132:133], v8 offset:4096
	ds_read_b64_tr_b16 a[134:135], v8 offset:6144
	ds_read_b64_tr_b16 a[136:137], v8 offset:8192
	ds_read_b64_tr_b16 a[138:139], v8 offset:10240
	ds_read_b64_tr_b16 a[140:141], v8 offset:12288
	ds_read_b64_tr_b16 a[142:143], v8 offset:14336
	s_waitcnt vmcnt(32)
	s_waitcnt lgkmcnt(0)
	s_barrier
	v_add_u32 v8, 147456, v101
	ds_read_b64_tr_b16 a[144:145], v8 offset:0
	ds_read_b64_tr_b16 a[146:147], v8 offset:2048
	ds_read_b64_tr_b16 a[148:149], v8 offset:4096
	ds_read_b64_tr_b16 a[150:151], v8 offset:6144
	ds_read_b64_tr_b16 a[152:153], v8 offset:8192
	ds_read_b64_tr_b16 a[154:155], v8 offset:10240
	ds_read_b64_tr_b16 a[156:157], v8 offset:12288
	ds_read_b64_tr_b16 a[158:159], v8 offset:14336
	s_waitcnt vmcnt(28)
	s_waitcnt lgkmcnt(0)
	s_barrier
	v_add_u32 v8, 0, v101
	ds_read_b64_tr_b16 a[160:161], v8 offset:0
	ds_read_b64_tr_b16 a[162:163], v8 offset:2048
	ds_read_b64_tr_b16 a[164:165], v8 offset:4096
	ds_read_b64_tr_b16 a[166:167], v8 offset:6144
	ds_read_b64_tr_b16 a[168:169], v8 offset:8192
	ds_read_b64_tr_b16 a[170:171], v8 offset:10240
	ds_read_b64_tr_b16 a[172:173], v8 offset:12288
	ds_read_b64_tr_b16 a[174:175], v8 offset:14336
	s_waitcnt vmcnt(24)
	s_waitcnt lgkmcnt(0)
	s_barrier
	v_add_u32 v8, 16384, v101
	ds_read_b64_tr_b16 a[176:177], v8 offset:0
	ds_read_b64_tr_b16 a[178:179], v8 offset:2048
	ds_read_b64_tr_b16 a[180:181], v8 offset:4096
	ds_read_b64_tr_b16 a[182:183], v8 offset:6144
	ds_read_b64_tr_b16 a[184:185], v8 offset:8192
	ds_read_b64_tr_b16 a[186:187], v8 offset:10240
	ds_read_b64_tr_b16 a[188:189], v8 offset:12288
	ds_read_b64_tr_b16 a[190:191], v8 offset:14336
	s_waitcnt vmcnt(20)
	s_waitcnt lgkmcnt(0)
	s_barrier
	v_add_u32 v8, 32768, v101
	ds_read_b64_tr_b16 a[192:193], v8 offset:0
	ds_read_b64_tr_b16 a[194:195], v8 offset:2048
	ds_read_b64_tr_b16 a[196:197], v8 offset:4096
	ds_read_b64_tr_b16 a[198:199], v8 offset:6144
	ds_read_b64_tr_b16 a[200:201], v8 offset:8192
	ds_read_b64_tr_b16 a[202:203], v8 offset:10240
	ds_read_b64_tr_b16 a[204:205], v8 offset:12288
	ds_read_b64_tr_b16 a[206:207], v8 offset:14336
	s_waitcnt vmcnt(16)
	s_waitcnt lgkmcnt(0)
	s_barrier
	v_add_u32 v8, 49152, v101
	ds_read_b64_tr_b16 a[208:209], v8 offset:0
	ds_read_b64_tr_b16 a[210:211], v8 offset:2048
	ds_read_b64_tr_b16 a[212:213], v8 offset:4096
	ds_read_b64_tr_b16 a[214:215], v8 offset:6144
	ds_read_b64_tr_b16 a[216:217], v8 offset:8192
	ds_read_b64_tr_b16 a[218:219], v8 offset:10240
	ds_read_b64_tr_b16 a[220:221], v8 offset:12288
	ds_read_b64_tr_b16 a[222:223], v8 offset:14336
	s_waitcnt vmcnt(12)
	s_waitcnt lgkmcnt(0)
	s_barrier
	v_add_u32 v8, 65536, v101
	ds_read_b64_tr_b16 a[224:225], v8 offset:0
	ds_read_b64_tr_b16 a[226:227], v8 offset:2048
	ds_read_b64_tr_b16 a[228:229], v8 offset:4096
	ds_read_b64_tr_b16 a[230:231], v8 offset:6144
	ds_read_b64_tr_b16 a[232:233], v8 offset:8192
	ds_read_b64_tr_b16 a[234:235], v8 offset:10240
	ds_read_b64_tr_b16 a[236:237], v8 offset:12288
	ds_read_b64_tr_b16 a[238:239], v8 offset:14336
	s_waitcnt vmcnt(8)
	s_waitcnt lgkmcnt(0)
	s_barrier
	v_add_u32 v8, 81920, v101
	ds_read_b64_tr_b16 a[240:241], v8 offset:0
	ds_read_b64_tr_b16 a[242:243], v8 offset:2048
	ds_read_b64_tr_b16 a[244:245], v8 offset:4096
	ds_read_b64_tr_b16 a[246:247], v8 offset:6144
	ds_read_b64_tr_b16 a[248:249], v8 offset:8192
	ds_read_b64_tr_b16 a[250:251], v8 offset:10240
	ds_read_b64_tr_b16 a[252:253], v8 offset:12288
	ds_read_b64_tr_b16 a[254:255], v8 offset:14336
	s_waitcnt vmcnt(4)
	s_waitcnt lgkmcnt(0)
	s_barrier
	v_add_u32 v8, 98304, v101
	ds_read_b64_tr_b16 v[112:113], v8 offset:0
	ds_read_b64_tr_b16 v[114:115], v8 offset:2048
	ds_read_b64_tr_b16 v[116:117], v8 offset:4096
	ds_read_b64_tr_b16 v[118:119], v8 offset:6144
	ds_read_b64_tr_b16 v[120:121], v8 offset:8192
	ds_read_b64_tr_b16 v[122:123], v8 offset:10240
	ds_read_b64_tr_b16 v[124:125], v8 offset:12288
	ds_read_b64_tr_b16 v[126:127], v8 offset:14336
	s_waitcnt vmcnt(0)
	s_waitcnt lgkmcnt(0)
	s_barrier
	v_add_u32 v8, 114688, v101
	ds_read_b64_tr_b16 v[128:129], v8 offset:0
	ds_read_b64_tr_b16 v[130:131], v8 offset:2048
	ds_read_b64_tr_b16 v[132:133], v8 offset:4096
	ds_read_b64_tr_b16 v[134:135], v8 offset:6144
	ds_read_b64_tr_b16 v[136:137], v8 offset:8192
	ds_read_b64_tr_b16 v[138:139], v8 offset:10240
	ds_read_b64_tr_b16 v[140:141], v8 offset:12288
	ds_read_b64_tr_b16 v[142:143], v8 offset:14336
	s_waitcnt lgkmcnt(0)
	s_barrier
	v_add_u32 v2, 36864, v0
	v_xor_b32 v2, v2, v0
	s_lshl_b32 s32, s27, 7
	s_lshl_b32 s36, s26, 2
	s_add_u32 s32, s32, s36
	s_add_u32 s32, s32, 0x3305a00
	s_mov_b32 s30, 0x3a00000
	s_mov_b32 s33, 0x3305400
	s_lshl_b32 s31, s27, 13
	s_lshl_b32 s36, s26, 11
	s_add_u32 s31, s31, s36
	s_add_u32 s31, s31, 0x5200000
	s_add_u32 s43, s31, 18874368
	v_mov_b64 v[108:109], -1
	v_mov_b64 v[110:111], -1
	s_cmp_eq_u32 s41, 1
	s_cbranch_scc1 gu_marked
	v_mov_b64 v[108:109], -1
	v_mov_b64 v[110:111], -1
	s_add_u32 s36, s31, 0
	buffer_store_dwordx4 v[108:111], v0, s[4:7], s36 offen offset:0 sc1
	buffer_store_dwordx4 v[108:111], v0, s[4:7], s36 offen offset:1024 sc1
	s_add_u32 s36, s31, 294912
	buffer_store_dwordx4 v[108:111], v0, s[4:7], s36 offen offset:0 sc1
	buffer_store_dwordx4 v[108:111], v0, s[4:7], s36 offen offset:1024 sc1
	s_add_u32 s36, s31, 589824
	buffer_store_dwordx4 v[108:111], v0, s[4:7], s36 offen offset:0 sc1
	buffer_store_dwordx4 v[108:111], v0, s[4:7], s36 offen offset:1024 sc1
	s_add_u32 s36, s31, 884736
	buffer_store_dwordx4 v[108:111], v0, s[4:7], s36 offen offset:0 sc1
	buffer_store_dwordx4 v[108:111], v0, s[4:7], s36 offen offset:1024 sc1
	s_add_u32 s36, s31, 17104896
	buffer_store_dwordx4 v[108:111], v0, s[4:7], s36 offen offset:0 sc1
	buffer_store_dwordx4 v[108:111], v0, s[4:7], s36 offen offset:1024 sc1
	s_add_u32 s36, s31, 17399808
	buffer_store_dwordx4 v[108:111], v0, s[4:7], s36 offen offset:0 sc1
	buffer_store_dwordx4 v[108:111], v0, s[4:7], s36 offen offset:1024 sc1
	s_add_u32 s36, s31, 17694720
	buffer_store_dwordx4 v[108:111], v0, s[4:7], s36 offen offset:0 sc1
	buffer_store_dwordx4 v[108:111], v0, s[4:7], s36 offen offset:1024 sc1
	s_add_u32 s36, s31, 17989632
	buffer_store_dwordx4 v[108:111], v0, s[4:7], s36 offen offset:0 sc1
	buffer_store_dwordx4 v[108:111], v0, s[4:7], s36 offen offset:1024 sc1
	s_add_u32 s36, s31, 18284544
	buffer_store_dwordx4 v[108:111], v0, s[4:7], s36 offen offset:0 sc1
	buffer_store_dwordx4 v[108:111], v0, s[4:7], s36 offen offset:1024 sc1
	s_add_u32 s36, s31, 18579456
	buffer_store_dwordx4 v[108:111], v0, s[4:7], s36 offen offset:0 sc1
	buffer_store_dwordx4 v[108:111], v0, s[4:7], s36 offen offset:1024 sc1
gu_marked:
	s_mov_b32 s49, 0x3f803f80
	v_mov_b32 v40, s49
	v_mov_b32 v41, s49
	v_mov_b32 v42, s49
	v_mov_b32 v43, s49
	s_nop 1
	v_mfma_f32_32x32x16_bf16 v[144:159], a[0:3], v[40:43], 0
	v_mfma_f32_32x32x16_bf16 v[160:175], a[144:147], v[40:43], 0
	v_mfma_f32_32x32x16_bf16 v[144:159], a[4:7], v[40:43], v[144:159]
	v_mfma_f32_32x32x16_bf16 v[160:175], a[148:151], v[40:43], v[160:175]
	v_mfma_f32_32x32x16_bf16 v[144:159], a[8:11], v[40:43], v[144:159]
	v_mfma_f32_32x32x16_bf16 v[160:175], a[152:155], v[40:43], v[160:175]
	v_mfma_f32_32x32x16_bf16 v[144:159], a[12:15], v[40:43], v[144:159]
	v_mfma_f32_32x32x16_bf16 v[160:175], a[156:159], v[40:43], v[160:175]
	v_mfma_f32_32x32x16_bf16 v[144:159], a[16:19], v[40:43], v[144:159]
	v_mfma_f32_32x32x16_bf16 v[160:175], a[160:163], v[40:43], v[160:175]
	v_mfma_f32_32x32x16_bf16 v[144:159], a[20:23], v[40:43], v[144:159]
	v_mfma_f32_32x32x16_bf16 v[160:175], a[164:167], v[40:43], v[160:175]
	v_mfma_f32_32x32x16_bf16 v[144:159], a[24:27], v[40:43], v[144:159]
	v_mfma_f32_32x32x16_bf16 v[160:175], a[168:171], v[40:43], v[160:175]
	v_mfma_f32_32x32x16_bf16 v[144:159], a[28:31], v[40:43], v[144:159]
	v_mfma_f32_32x32x16_bf16 v[160:175], a[172:175], v[40:43], v[160:175]
	v_mfma_f32_32x32x16_bf16 v[144:159], a[32:35], v[40:43], v[144:159]
	v_mfma_f32_32x32x16_bf16 v[160:175], a[176:179], v[40:43], v[160:175]
	v_mfma_f32_32x32x16_bf16 v[144:159], a[36:39], v[40:43], v[144:159]
	v_mfma_f32_32x32x16_bf16 v[160:175], a[180:183], v[40:43], v[160:175]
	v_mfma_f32_32x32x16_bf16 v[144:159], a[40:43], v[40:43], v[144:159]
	v_mfma_f32_32x32x16_bf16 v[160:175], a[184:187], v[40:43], v[160:175]
	v_mfma_f32_32x32x16_bf16 v[144:159], a[44:47], v[40:43], v[144:159]
	v_mfma_f32_32x32x16_bf16 v[160:175], a[188:191], v[40:43], v[160:175]
	v_mfma_f32_32x32x16_bf16 v[144:159], a[48:51], v[40:43], v[144:159]
	v_mfma_f32_32x32x16_bf16 v[160:175], a[192:195], v[40:43], v[160:175]
	v_mfma_f32_32x32x16_bf16 v[144:159], a[52:55], v[40:43], v[144:159]
	v_mfma_f32_32x32x16_bf16 v[160:175], a[196:199], v[40:43], v[160:175]
	v_mfma_f32_32x32x16_bf16 v[144:159], a[56:59], v[40:43], v[144:159]
	v_mfma_f32_32x32x16_bf16 v[160:175], a[200:203], v[40:43], v[160:175]
	v_mfma_f32_32x32x16_bf16 v[144:159], a[60:63], v[40:43], v[144:159]
	v_mfma_f32_32x32x16_bf16 v[160:175], a[204:207], v[40:43], v[160:175]
	v_mfma_f32_32x32x16_bf16 v[144:159], a[64:67], v[40:43], v[144:159]
	v_mfma_f32_32x32x16_bf16 v[160:175], a[208:211], v[40:43], v[160:175]
	v_mfma_f32_32x32x16_bf16 v[144:159], a[68:71], v[40:43], v[144:159]
	v_mfma_f32_32x32x16_bf16 v[160:175], a[212:215], v[40:43], v[160:175]
	v_mfma_f32_32x32x16_bf16 v[144:159], a[72:75], v[40:43], v[144:159]
	v_mfma_f32_32x32x16_bf16 v[160:175], a[216:219], v[40:43], v[160:175]
	v_mfma_f32_32x32x16_bf16 v[144:159], a[76:79], v[40:43], v[144:159]
	v_mfma_f32_32x32x16_bf16 v[160:175], a[220:223], v[40:43], v[160:175]
	v_mfma_f32_32x32x16_bf16 v[144:159], a[80:83], v[40:43], v[144:159]
	v_mfma_f32_32x32x16_bf16 v[160:175], a[224:227], v[40:43], v[160:175]
	v_mfma_f32_32x32x16_bf16 v[144:159], a[84:87], v[40:43], v[144:159]
	v_mfma_f32_32x32x16_bf16 v[160:175], a[228:231], v[40:43], v[160:175]
	v_mfma_f32_32x32x16_bf16 v[144:159], a[88:91], v[40:43], v[144:159]
	v_mfma_f32_32x32x16_bf16 v[160:175], a[232:235], v[40:43], v[160:175]
	v_mfma_f32_32x32x16_bf16 v[144:159], a[92:95], v[40:43], v[144:159]
	v_mfma_f32_32x32x16_bf16 v[160:175], a[236:239], v[40:43], v[160:175]
	v_mfma_f32_32x32x16_bf16 v[144:159], a[96:99], v[40:43], v[144:159]
	v_mfma_f32_32x32x16_bf16 v[160:175], a[240:243], v[40:43], v[160:175]
	v_mfma_f32_32x32x16_bf16 v[144:159], a[100:103], v[40:43], v[144:159]
	v_mfma_f32_32x32x16_bf16 v[160:175], a[244:247], v[40:43], v[160:175]
	v_mfma_f32_32x32x16_bf16 v[144:159], a[104:107], v[40:43], v[144:159]
	v_mfma_f32_32x32x16_bf16 v[160:175], a[248:251], v[40:43], v[160:175]
	v_mfma_f32_32x32x16_bf16 v[144:159], a[108:111], v[40:43], v[144:159]
	v_mfma_f32_32x32x16_bf16 v[160:175], a[252:255], v[40:43], v[160:175]
	v_mfma_f32_32x32x16_bf16 v[144:159], a[112:115], v[40:43], v[144:159]
	v_mfma_f32_32x32x16_bf16 v[160:175], v[112:115], v[40:43], v[160:175]
	v_mfma_f32_32x32x16_bf16 v[144:159], a[116:119], v[40:43], v[144:159]
	v_mfma_f32_32x32x16_bf16 v[160:175], v[116:119], v[40:43], v[160:175]
	v_mfma_f32_32x32x16_bf16 v[144:159], a[120:123], v[40:43], v[144:159]
	v_mfma_f32_32x32x16_bf16 v[160:175], v[120:123], v[40:43], v[160:175]
	v_mfma_f32_32x32x16_bf16 v[144:159], a[124:127], v[40:43], v[144:159]
	v_mfma_f32_32x32x16_bf16 v[160:175], v[124:127], v[40:43], v[160:175]
	v_mfma_f32_32x32x16_bf16 v[144:159], a[128:131], v[40:43], v[144:159]
	v_mfma_f32_32x32x16_bf16 v[160:175], v[128:131], v[40:43], v[160:175]
	v_mfma_f32_32x32x16_bf16 v[144:159], a[132:135], v[40:43], v[144:159]
	v_mfma_f32_32x32x16_bf16 v[160:175], v[132:135], v[40:43], v[160:175]
	v_mfma_f32_32x32x16_bf16 v[144:159], a[136:139], v[40:43], v[144:159]
	v_mfma_f32_32x32x16_bf16 v[160:175], v[136:139], v[40:43], v[160:175]
	v_mfma_f32_32x32x16_bf16 v[144:159], a[140:143], v[40:43], v[144:159]
	v_mfma_f32_32x32x16_bf16 v[160:175], v[140:143], v[40:43], v[160:175]
	v_and_b32 v4, 496, v0
	v_and_b32 v5, 512, v0
	v_lshl_add_u32 v5, v5, 2, v4
	v_add_u32 v4, 2048, v4
	s_mov_b32 s45, 0x3d00000
	s_mul_i32 s28, s41, 59
	s_mul_i32 s36, s28, 36864
	s_add_u32 s30, s30, s36
	s_mul_i32 s36, s28, 294912
	s_add_u32 s31, s31, s36
	s_mul_i32 s36, s28, 8192
	s_add_u32 s45, s45, s36
	s_cmp_eq_u32 s41, 0
	s_cbranch_scc1 gu_first
	v_mov_b32 v8, 0
gu_spm:
	buffer_load_dword v96, v8, s[4:7], s32 offen sc1
	s_sub_u32 s34, s34, 1
	s_cbranch_scc1 all_exit
	s_waitcnt vmcnt(0)
	v_cmp_gt_u32 vcc, 1, v96
	s_cbranch_vccnz gu_spm
	s_branch gu_set
gu_first:
	s_waitcnt vmcnt(0)
	v_mov_b32 v8, 0
gu_init:
	global_load_dword v9, v8, s[24:25] offset:8 sc1
	s_sub_u32 s34, s34, 1
	s_cbranch_scc1 all_exit
	s_waitcnt vmcnt(0)
	v_readfirstlane_b32 s36, v9
	s_cmp_eq_u32 s36, 0
	s_cbranch_scc1 gu_init
	v_mov_b32 v98, 1
	s_mov_b64 exec, 1
	buffer_store_dword v98, off, s[4:7], s32 sc1
	s_mov_b64 exec, -1
	s_waitcnt vmcnt(0)
gu_set:
	s_mul_i32 s47, s26, 9216
	s_add_u32 s30, s30, s47
	s_mov_b32 s35, s47
	s_lshl_b32 s46, s47, 1
	s_add_u32 s46, s46, 36864
	v_mov_b32 v1, v0
gu_sp:
	buffer_load_dword v96, v104, s[4:7], s33 offen sc1
	s_sub_u32 s34, s34, 1
	s_cbranch_scc1 all_exit
	s_waitcnt vmcnt(0)
	v_cmp_gt_u32 vcc, 1, v96
	s_cbranch_vccnz gu_sp
	v_add_u32 v3, s47, v1
	s_mov_b32 s29, 0
gu_again:
	s_cmp_eq_u32 s29, 1
	s_cbranch_scc1 gu_seen
	s_mov_b64 exec, 1
gu_look:
	buffer_load_dword v92, v105, s[4:7], s30 offen offset:0 sc1
	s_sub_u32 s34, s34, 1
	s_cbranch_scc1 all_exit
	s_waitcnt vmcnt(0)
	v_cmp_eq_u32 vcc, -1, v92
	s_cbranch_vccnz gu_look
	s_mov_b64 exec, -1
	s_mov_b32 s29, 1
gu_seen:
	s_mov_b32 m0, s35
	s_nop 0
	buffer_load_dwordx4 v0, s[4:7], s30 offen offset:0 sc1 lds
	buffer_load_dwordx4 v0, s[4:7], s30 offen offset:1024 sc1 lds
	buffer_load_dwordx4 v0, s[4:7], s30 offen offset:2048 sc1 lds
	buffer_load_dwordx4 v0, s[4:7], s30 offen offset:3072 sc1 lds
	s_add_u32 m0, s35, 4096
	s_add_u32 s36, s30, 4096
	buffer_load_dwordx4 v0, s[4:7], s36 offen offset:0 sc1 lds
	buffer_load_dwordx4 v0, s[4:7], s36 offen offset:1024 sc1 lds
	buffer_load_dwordx4 v0, s[4:7], s36 offen offset:2048 sc1 lds
	buffer_load_dwordx4 v0, s[4:7], s36 offen offset:3072 sc1 lds
	s_add_u32 m0, s35, 8192
	s_add_u32 s36, s30, 8192
	buffer_load_dwordx4 v0, s[4:7], s36 offen offset:0 sc1 lds
	buffer_load_dwordx2 v[176:177], v5, s[4:7], s45 offen offset:0 sc1
	buffer_load_dwordx2 v[178:179], v5, s[4:7], s45 offen offset:512 sc1
	buffer_load_dwordx2 v[180:181], v5, s[4:7], s45 offen offset:1024 sc1
	buffer_load_dwordx2 v[182:183], v5, s[4:7], s45 offen offset:1536 sc1
	buffer_load_dwordx2 v[184:185], v4, s[4:7], s45 offen offset:2048 sc1
	s_sub_u32 s34, s34, 1
	s_cbranch_scc1 all_exit
	s_waitcnt vmcnt(0)
gu_loop:
	s_waitcnt vmcnt(2)
	ds_read2st64_b32 v[88:89], v3 offset0:0 offset1:4
	ds_read2st64_b32 v[90:91], v3 offset0:8 offset1:12
	ds_read2st64_b32 v[92:93], v3 offset0:16 offset1:20
	ds_read2st64_b32 v[94:95], v3 offset0:24 offset1:28
	ds_read_b32 v96, v3 offset:8192
	v_max3_u32 v98, v176, v178, v180
	v_max3_u32 v98, v98, v182, v184
	s_waitcnt lgkmcnt(3)
	v_max3_u32 v88, v88, v89, v90
	s_waitcnt lgkmcnt(2)
	v_max3_u32 v91, v91, v92, v93
	s_waitcnt lgkmcnt(0)
	v_max3_u32 v94, v94, v95, v96
	v_max3_u32 v88, v88, v91, v94
	v_max_u32 v88, v88, v98
	v_cmp_eq_u32 vcc, -1, v88
	s_cbranch_vccnz gu_again
	s_barrier
	ds_read_b128 v[40:43], v1 offset:0
	ds_read_b128 v[44:47], v1 offset:1024
	ds_read_b128 v[48:51], v1 offset:2048
	s_mov_b32 s29, 0
	s_cmp_ge_u32 s28, 58
	s_cselect_b32 s40, 1, 0
	s_lshl_b32 s38, 36864, s40
	s_add_u32 s30, s30, s38
	s_sub_u32 s35, s46, s35
	s_waitcnt lgkmcnt(2)
	v_mfma_f32_32x32x16_bf16 v[8:23], a[0:3], v[40:43], 0
	ds_read_b128 v[52:55], v1 offset:3072
	v_pk_add_f32 v[176:177], v[176:177], v[178:179]
	v_pk_add_f32 v[180:181], v[180:181], v[182:183]
	v_mfma_f32_32x32x16_bf16 v[24:39], a[144:147], v[40:43], 0
	v_pk_add_f32 v[178:179], v[176:177], v[180:181]
	v_pk_add_f32 v[176:177], v[176:177], v[180:181]
	s_waitcnt lgkmcnt(2)
	v_mfma_f32_32x32x16_bf16 v[8:23], a[4:7], v[44:47], v[8:23]
	ds_read_b128 v[56:59], v1 offset:4096
	s_lshl_b32 s38, 8192, s40
	s_add_u32 s45, s45, s38
	v_mfma_f32_32x32x16_bf16 v[24:39], a[148:151], v[44:47], v[24:39]
	v_permlane32_swap_b32 v176, v178
	v_permlane32_swap_b32 v177, v179
	s_waitcnt lgkmcnt(2)
	v_mfma_f32_32x32x16_bf16 v[8:23], a[8:11], v[48:51], v[8:23]
	ds_read_b128 v[60:63], v1 offset:5120
	v_pk_add_f32 v[176:177], v[176:177], v[184:185]
	v_pk_add_f32 v[176:177], v[176:177], v[178:179]
	v_mfma_f32_32x32x16_bf16 v[24:39], a[152:155], v[48:51], v[24:39]
	v_mul_f32 v186, 0x3ae38e39, v176
	v_mul_f32 v188, 0x3ae38e39, v177
	s_waitcnt lgkmcnt(2)
	v_mfma_f32_32x32x16_bf16 v[8:23], a[12:15], v[52:55], v[8:23]
	ds_read_b128 v[64:67], v1 offset:6144
	v_fma_f32 v188, -v186, v186, v188
	v_max_f32 v188, 0, v188
	v_mfma_f32_32x32x16_bf16 v[24:39], a[156:159], v[52:55], v[24:39]
	v_cvt_pk_bf16_f32 v186, v186, v186
	v_lshlrev_b32 v186, 16, v186
	s_waitcnt lgkmcnt(2)
	v_mfma_f32_32x32x16_bf16 v[8:23], a[16:19], v[56:59], v[8:23]
	ds_read_b128 v[68:71], v1 offset:7168
	v_cvt_pk_bf16_f32 v188, v188, v188
	v_lshlrev_b32 v188, 16, v188
	v_mfma_f32_32x32x16_bf16 v[24:39], a[160:163], v[56:59], v[24:39]
	v_add_f32 v188, 0x3727c5ac, v188
	v_cvt_pk_bf16_f32 v188, v188, v188
	s_waitcnt lgkmcnt(2)
	v_mfma_f32_32x32x16_bf16 v[8:23], a[20:23], v[60:63], v[8:23]
	ds_read_b128 v[40:43], v1 offset:8192
	v_lshlrev_b32 v188, 16, v188
	v_sqrt_f32 v188, v188
	v_mfma_f32_32x32x16_bf16 v[24:39], a[164:167], v[60:63], v[24:39]
	s_nop 0
	v_cvt_pk_bf16_f32 v188, v188, v188
	s_waitcnt lgkmcnt(2)
	v_mfma_f32_32x32x16_bf16 v[8:23], a[24:27], v[64:67], v[8:23]
	ds_read_b128 v[44:47], v1 offset:9216
	v_lshlrev_b32 v188, 16, v188
	v_rcp_f32 v188, v188
	v_mfma_f32_32x32x16_bf16 v[24:39], a[168:171], v[64:67], v[24:39]
	s_nop 0
	v_mul_f32 v188, v188, v188
	s_waitcnt lgkmcnt(2)
	v_mfma_f32_32x32x16_bf16 v[8:23], a[28:31], v[68:71], v[8:23]
	ds_read_b128 v[48:51], v1 offset:10240
	s_add_u32 s37, s31, 1179648
	s_cmp_ge_u32 s28, 54
	v_mfma_f32_32x32x16_bf16 v[24:39], a[172:175], v[68:71], v[24:39]
	s_cselect_b32 s37, s43, s37
	buffer_store_dwordx4 v[108:111], v0, s[4:7], s37 offen offset:0 sc1
	s_waitcnt lgkmcnt(2)
	v_mfma_f32_32x32x16_bf16 v[8:23], a[32:35], v[40:43], v[8:23]
	ds_read_b128 v[52:55], v1 offset:11264
	v_mfma_f32_32x32x16_bf16 v[24:39], a[176:179], v[40:43], v[24:39]
	buffer_store_dwordx4 v[108:111], v0, s[4:7], s37 offen offset:1024 sc1
	s_waitcnt lgkmcnt(2)
	v_mfma_f32_32x32x16_bf16 v[8:23], a[36:39], v[44:47], v[8:23]
	ds_read_b128 v[56:59], v1 offset:12288
	v_mfma_f32_32x32x16_bf16 v[24:39], a[180:183], v[44:47], v[24:39]
	s_mov_b32 m0, s35
	s_waitcnt lgkmcnt(2)
	v_mfma_f32_32x32x16_bf16 v[8:23], a[40:43], v[48:51], v[8:23]
	ds_read_b128 v[60:63], v1 offset:13312
	buffer_load_dwordx4 v0, s[4:7], s30 offen offset:0 sc1 lds
	v_mfma_f32_32x32x16_bf16 v[24:39], a[184:187], v[48:51], v[24:39]
	s_waitcnt lgkmcnt(2)
	v_mfma_f32_32x32x16_bf16 v[8:23], a[44:47], v[52:55], v[8:23]
	ds_read_b128 v[64:67], v1 offset:14336
	buffer_load_dwordx4 v0, s[4:7], s30 offen offset:1024 sc1 lds
	v_mfma_f32_32x32x16_bf16 v[24:39], a[188:191], v[52:55], v[24:39]
	s_waitcnt lgkmcnt(2)
	v_mfma_f32_32x32x16_bf16 v[8:23], a[48:51], v[56:59], v[8:23]
	ds_read_b128 v[68:71], v1 offset:15360
	buffer_load_dwordx4 v0, s[4:7], s30 offen offset:2048 sc1 lds
	v_mfma_f32_32x32x16_bf16 v[24:39], a[192:195], v[56:59], v[24:39]
	s_waitcnt lgkmcnt(2)
	v_mfma_f32_32x32x16_bf16 v[8:23], a[52:55], v[60:63], v[8:23]
	ds_read_b128 v[40:43], v1 offset:16384
	buffer_load_dwordx4 v0, s[4:7], s30 offen offset:3072 sc1 lds
	v_mfma_f32_32x32x16_bf16 v[24:39], a[196:199], v[60:63], v[24:39]
	s_waitcnt lgkmcnt(2)
	v_mfma_f32_32x32x16_bf16 v[8:23], a[56:59], v[64:67], v[8:23]
	ds_read_b128 v[44:47], v1 offset:17408
	s_add_u32 m0, s35, 4096
	s_add_u32 s36, s30, 4096
	v_mfma_f32_32x32x16_bf16 v[24:39], a[200:203], v[64:67], v[24:39]
	buffer_load_dwordx4 v0, s[4:7], s36 offen offset:0 sc1 lds
	s_waitcnt lgkmcnt(2)
	v_mfma_f32_32x32x16_bf16 v[8:23], a[60:63], v[68:71], v[8:23]
	ds_read_b128 v[48:51], v1 offset:18432
	v_mfma_f32_32x32x16_bf16 v[24:39], a[204:207], v[68:71], v[24:39]
	buffer_load_dwordx4 v0, s[4:7], s36 offen offset:1024 sc1 lds
	s_waitcnt lgkmcnt(2)
	v_mfma_f32_32x32x16_bf16 v[8:23], a[64:67], v[40:43], v[8:23]
	ds_read_b128 v[52:55], v1 offset:19456
	v_mfma_f32_32x32x16_bf16 v[24:39], a[208:211], v[40:43], v[24:39]
	buffer_load_dwordx4 v0, s[4:7], s36 offen offset:2048 sc1 lds
	s_waitcnt lgkmcnt(2)
	v_mfma_f32_32x32x16_bf16 v[8:23], a[68:71], v[44:47], v[8:23]
	ds_read_b128 v[56:59], v1 offset:20480
	v_mfma_f32_32x32x16_bf16 v[24:39], a[212:215], v[44:47], v[24:39]
	buffer_load_dwordx4 v0, s[4:7], s36 offen offset:3072 sc1 lds
	s_waitcnt lgkmcnt(2)
	v_mfma_f32_32x32x16_bf16 v[8:23], a[72:75], v[48:51], v[8:23]
	ds_read_b128 v[60:63], v1 offset:21504
	v_mfma_f32_32x32x16_bf16 v[24:39], a[216:219], v[48:51], v[24:39]
	s_add_u32 m0, s35, 8192
	s_add_u32 s36, s30, 8192
	s_waitcnt lgkmcnt(2)
	v_mfma_f32_32x32x16_bf16 v[8:23], a[76:79], v[52:55], v[8:23]
	ds_read_b128 v[64:67], v1 offset:22528
	buffer_load_dwordx4 v0, s[4:7], s36 offen offset:0 sc1 lds
	v_mfma_f32_32x32x16_bf16 v[24:39], a[220:223], v[52:55], v[24:39]
	s_waitcnt lgkmcnt(2)
	v_mfma_f32_32x32x16_bf16 v[8:23], a[80:83], v[56:59], v[8:23]
	ds_read_b128 v[68:71], v1 offset:23552
	buffer_load_dwordx2 v[176:177], v5, s[4:7], s45 offen offset:0 sc1
	v_mfma_f32_32x32x16_bf16 v[24:39], a[224:227], v[56:59], v[24:39]
	s_waitcnt lgkmcnt(2)
	v_mfma_f32_32x32x16_bf16 v[8:23], a[84:87], v[60:63], v[8:23]
	ds_read_b128 v[40:43], v1 offset:24576
	buffer_load_dwordx2 v[178:179], v5, s[4:7], s45 offen offset:512 sc1
	v_mfma_f32_32x32x16_bf16 v[24:39], a[228:231], v[60:63], v[24:39]
	s_waitcnt lgkmcnt(2)
	v_mfma_f32_32x32x16_bf16 v[8:23], a[88:91], v[64:67], v[8:23]
	ds_read_b128 v[44:47], v1 offset:25600
	buffer_load_dwordx2 v[180:181], v5, s[4:7], s45 offen offset:1024 sc1
	v_mfma_f32_32x32x16_bf16 v[24:39], a[232:235], v[64:67], v[24:39]
	s_waitcnt lgkmcnt(2)
	v_mfma_f32_32x32x16_bf16 v[8:23], a[92:95], v[68:71], v[8:23]
	ds_read_b128 v[48:51], v1 offset:26624
	buffer_load_dwordx2 v[182:183], v5, s[4:7], s45 offen offset:1536 sc1
	v_mfma_f32_32x32x16_bf16 v[24:39], a[236:239], v[68:71], v[24:39]
	s_waitcnt lgkmcnt(2)
	v_mfma_f32_32x32x16_bf16 v[8:23], a[96:99], v[40:43], v[8:23]
	ds_read_b128 v[52:55], v1 offset:27648
	buffer_load_dwordx2 v[184:185], v4, s[4:7], s45 offen offset:2048 sc1
	v_mfma_f32_32x32x16_bf16 v[24:39], a[240:243], v[40:43], v[24:39]
	s_waitcnt lgkmcnt(2)
	v_mfma_f32_32x32x16_bf16 v[8:23], a[100:103], v[44:47], v[8:23]
	ds_read_b128 v[56:59], v1 offset:28672
	v_mfma_f32_32x32x16_bf16 v[24:39], a[244:247], v[44:47], v[24:39]
	s_waitcnt lgkmcnt(2)
	v_mfma_f32_32x32x16_bf16 v[8:23], a[104:107], v[48:51], v[8:23]
	ds_read_b128 v[60:63], v1 offset:29696
	v_mfma_f32_32x32x16_bf16 v[24:39], a[248:251], v[48:51], v[24:39]
	s_waitcnt lgkmcnt(2)
	v_mfma_f32_32x32x16_bf16 v[8:23], a[108:111], v[52:55], v[8:23]
	ds_read_b128 v[64:67], v1 offset:30720
	v_mfma_f32_32x32x16_bf16 v[24:39], a[252:255], v[52:55], v[24:39]
	s_waitcnt lgkmcnt(2)
	v_mfma_f32_32x32x16_bf16 v[8:23], a[112:115], v[56:59], v[8:23]
	ds_read_b128 v[68:71], v1 offset:31744
	v_mfma_f32_32x32x16_bf16 v[24:39], v[112:115], v[56:59], v[24:39]
	s_waitcnt lgkmcnt(2)
	v_mfma_f32_32x32x16_bf16 v[8:23], a[116:119], v[60:63], v[8:23]
	ds_read_b128 v[40:43], v1 offset:32768
	v_mfma_f32_32x32x16_bf16 v[24:39], v[116:119], v[60:63], v[24:39]
	s_waitcnt lgkmcnt(2)
	v_mfma_f32_32x32x16_bf16 v[8:23], a[120:123], v[64:67], v[8:23]
	ds_read_b128 v[44:47], v1 offset:33792
	v_mfma_f32_32x32x16_bf16 v[24:39], v[120:123], v[64:67], v[24:39]
	s_waitcnt lgkmcnt(2)
	v_mfma_f32_32x32x16_bf16 v[8:23], a[124:127], v[68:71], v[8:23]
	ds_read_b128 v[48:51], v1 offset:34816
	v_mfma_f32_32x32x16_bf16 v[24:39], v[124:127], v[68:71], v[24:39]
	s_waitcnt lgkmcnt(2)
	v_mfma_f32_32x32x16_bf16 v[8:23], a[128:131], v[40:43], v[8:23]
	ds_read_b128 v[52:55], v1 offset:35840
	v_mfma_f32_32x32x16_bf16 v[24:39], v[128:131], v[40:43], v[24:39]
	s_waitcnt lgkmcnt(2)
	v_mfma_f32_32x32x16_bf16 v[8:23], a[132:135], v[44:47], v[8:23]
	v_mfma_f32_32x32x16_bf16 v[24:39], v[132:135], v[44:47], v[24:39]
	s_waitcnt lgkmcnt(1)
	v_mfma_f32_32x32x16_bf16 v[8:23], a[136:139], v[48:51], v[8:23]
	v_mfma_f32_32x32x16_bf16 v[24:39], v[136:139], v[48:51], v[24:39]
	s_waitcnt lgkmcnt(0)
	v_mfma_f32_32x32x16_bf16 v[8:23], a[140:143], v[52:55], v[8:23]
	v_mfma_f32_32x32x16_bf16 v[24:39], v[140:143], v[52:55], v[24:39]
	v_xor_b32 v1, v2, v1
	v_add_u32 v3, s47, v1
	s_nop 1
	v_pk_fma_f32 v[8:9], v[144:145], v[186:187], v[8:9] op_sel_hi:[1,0,1] neg_lo:[0,1,0] neg_hi:[0,1,0]
	v_pk_fma_f32 v[10:11], v[146:147], v[186:187], v[10:11] op_sel_hi:[1,0,1] neg_lo:[0,1,0] neg_hi:[0,1,0]
	v_pk_fma_f32 v[12:13], v[148:149], v[186:187], v[12:13] op_sel_hi:[1,0,1] neg_lo:[0,1,0] neg_hi:[0,1,0]
	v_pk_fma_f32 v[14:15], v[150:151], v[186:187], v[14:15] op_sel_hi:[1,0,1] neg_lo:[0,1,0] neg_hi:[0,1,0]
	v_pk_fma_f32 v[16:17], v[152:153], v[186:187], v[16:17] op_sel_hi:[1,0,1] neg_lo:[0,1,0] neg_hi:[0,1,0]
	v_pk_fma_f32 v[18:19], v[154:155], v[186:187], v[18:19] op_sel_hi:[1,0,1] neg_lo:[0,1,0] neg_hi:[0,1,0]
	v_pk_fma_f32 v[20:21], v[156:157], v[186:187], v[20:21] op_sel_hi:[1,0,1] neg_lo:[0,1,0] neg_hi:[0,1,0]
	v_pk_fma_f32 v[22:23], v[158:159], v[186:187], v[22:23] op_sel_hi:[1,0,1] neg_lo:[0,1,0] neg_hi:[0,1,0]
	v_pk_fma_f32 v[24:25], v[160:161], v[186:187], v[24:25] op_sel_hi:[1,0,1] neg_lo:[0,1,0] neg_hi:[0,1,0]
	v_pk_fma_f32 v[26:27], v[162:163], v[186:187], v[26:27] op_sel_hi:[1,0,1] neg_lo:[0,1,0] neg_hi:[0,1,0]
	v_pk_fma_f32 v[28:29], v[164:165], v[186:187], v[28:29] op_sel_hi:[1,0,1] neg_lo:[0,1,0] neg_hi:[0,1,0]
	v_pk_fma_f32 v[30:31], v[166:167], v[186:187], v[30:31] op_sel_hi:[1,0,1] neg_lo:[0,1,0] neg_hi:[0,1,0]
	v_pk_fma_f32 v[32:33], v[168:169], v[186:187], v[32:33] op_sel_hi:[1,0,1] neg_lo:[0,1,0] neg_hi:[0,1,0]
	v_pk_fma_f32 v[34:35], v[170:171], v[186:187], v[34:35] op_sel_hi:[1,0,1] neg_lo:[0,1,0] neg_hi:[0,1,0]
	v_pk_fma_f32 v[36:37], v[172:173], v[186:187], v[36:37] op_sel_hi:[1,0,1] neg_lo:[0,1,0] neg_hi:[0,1,0]
	v_pk_fma_f32 v[38:39], v[174:175], v[186:187], v[38:39] op_sel_hi:[1,0,1] neg_lo:[0,1,0] neg_hi:[0,1,0]
	v_pk_mul_f32 v[8:9], v[8:9], v[24:25]
	v_pk_mul_f32 v[10:11], v[10:11], v[26:27]
	v_pk_mul_f32 v[12:13], v[12:13], v[28:29]
	v_pk_mul_f32 v[14:15], v[14:15], v[30:31]
	v_pk_mul_f32 v[16:17], v[16:17], v[32:33]
	v_pk_mul_f32 v[18:19], v[18:19], v[34:35]
	v_pk_mul_f32 v[20:21], v[20:21], v[36:37]
	v_pk_mul_f32 v[22:23], v[22:23], v[38:39]
	v_pk_mul_f32 v[8:9], v[8:9], v[188:189] op_sel_hi:[1,0]
	v_pk_mul_f32 v[10:11], v[10:11], v[188:189] op_sel_hi:[1,0]
	v_pk_mul_f32 v[12:13], v[12:13], v[188:189] op_sel_hi:[1,0]
	v_pk_mul_f32 v[14:15], v[14:15], v[188:189] op_sel_hi:[1,0]
	v_pk_mul_f32 v[16:17], v[16:17], v[188:189] op_sel_hi:[1,0]
	v_pk_mul_f32 v[18:19], v[18:19], v[188:189] op_sel_hi:[1,0]
	v_pk_mul_f32 v[20:21], v[20:21], v[188:189] op_sel_hi:[1,0]
	v_pk_mul_f32 v[22:23], v[22:23], v[188:189] op_sel_hi:[1,0]
	v_cvt_pk_bf16_f32 v72, v8, v9
	v_cvt_pk_bf16_f32 v73, v10, v11
	v_cvt_pk_bf16_f32 v74, v12, v13
	v_cvt_pk_bf16_f32 v75, v14, v15
	v_cvt_pk_bf16_f32 v76, v16, v17
	v_cvt_pk_bf16_f32 v77, v18, v19
	v_cvt_pk_bf16_f32 v78, v20, v21
	v_cvt_pk_bf16_f32 v79, v22, v23
	buffer_store_dwordx4 v[72:75], v0, s[4:7], s31 offen offset:0 sc1
	buffer_store_dwordx4 v[76:79], v0, s[4:7], s31 offen offset:1024 sc1
	s_lshl_b32 s38, 294912, s40
	s_add_u32 s31, s31, s38
	s_add_u32 s28, s28, 1
	s_add_u32 s28, s28, s40
	s_cmp_lt_u32 s28, 64
	s_cbranch_scc1 gu_loop
	s_branch all_exit
wo_entry:
	v_add_u32 v8, 7168, v0
	global_load_dwordx4 v[100:103], v8, s[64:65]
	global_load_dwordx4 v[104:107], v8, s[64:65] offset:1024
	s_load_dwordx2 s[8:9], s[0:1], 40
	s_mov_b32 s10, 4718592
	s_mov_b32 s11, 0x00020000
	s_mul_i32 s47, s27, 52
	s_lshr_b32 s47, s47, 8
	s_mul_i32 s36, s47, 5
	s_sub_u32 s49, s27, s36
	s_mul_i32 s48, s47, 589824
	s_mul_i32 s36, s26, 18432
	s_add_u32 s48, s48, s36
	s_lshl_b32 s36, s49, 8
	s_add_u32 s48, s48, s36
	s_waitcnt vmcnt(0) lgkmcnt(0)
	s_add_u32 s36, s48, 0
	s_add_u32 m0, s44, 0
	s_nop 0
	buffer_load_dwordx4 v100, s[8:11], s36 offen nt lds
	s_add_u32 s36, s48, 4608
	s_add_u32 m0, s44, 1024
	s_nop 0
	buffer_load_dwordx4 v100, s[8:11], s36 offen nt lds
	s_add_u32 s36, s48, 9216
	s_add_u32 m0, s44, 2048
	s_nop 0
	buffer_load_dwordx4 v100, s[8:11], s36 offen nt lds
	s_add_u32 s36, s48, 13824
	s_add_u32 m0, s44, 3072
	s_nop 0
	buffer_load_dwordx4 v100, s[8:11], s36 offen nt lds
	s_add_u32 s36, s48, 73728
	s_add_u32 m0, s44, 16384
	s_nop 0
	buffer_load_dwordx4 v100, s[8:11], s36 offen nt lds
	s_add_u32 s36, s48, 78336
	s_add_u32 m0, s44, 17408
	s_nop 0
	buffer_load_dwordx4 v100, s[8:11], s36 offen nt lds
	s_add_u32 s36, s48, 82944
	s_add_u32 m0, s44, 18432
	s_nop 0
	buffer_load_dwordx4 v100, s[8:11], s36 offen nt lds
	s_add_u32 s36, s48, 87552
	s_add_u32 m0, s44, 19456
	s_nop 0
	buffer_load_dwordx4 v100, s[8:11], s36 offen nt lds
	s_add_u32 s36, s48, 147456
	s_add_u32 m0, s44, 32768
	s_nop 0
	buffer_load_dwordx4 v100, s[8:11], s36 offen nt lds
	s_add_u32 s36, s48, 152064
	s_add_u32 m0, s44, 33792
	s_nop 0
	buffer_load_dwordx4 v100, s[8:11], s36 offen nt lds
	s_add_u32 s36, s48, 156672
	s_add_u32 m0, s44, 34816
	s_nop 0
	buffer_load_dwordx4 v100, s[8:11], s36 offen nt lds
	s_add_u32 s36, s48, 161280
	s_add_u32 m0, s44, 35840
	s_nop 0
	buffer_load_dwordx4 v100, s[8:11], s36 offen nt lds
	s_add_u32 s36, s48, 221184
	s_add_u32 m0, s44, 49152
	s_nop 0
	buffer_load_dwordx4 v100, s[8:11], s36 offen nt lds
	s_add_u32 s36, s48, 225792
	s_add_u32 m0, s44, 50176
	s_nop 0
	buffer_load_dwordx4 v100, s[8:11], s36 offen nt lds
	s_add_u32 s36, s48, 230400
	s_add_u32 m0, s44, 51200
	s_nop 0
	buffer_load_dwordx4 v100, s[8:11], s36 offen nt lds
	s_add_u32 s36, s48, 235008
	s_add_u32 m0, s44, 52224
	s_nop 0
	buffer_load_dwordx4 v100, s[8:11], s36 offen nt lds
	s_add_u32 s36, s48, 294912
	s_add_u32 m0, s44, 65536
	s_nop 0
	buffer_load_dwordx4 v100, s[8:11], s36 offen nt lds
	s_add_u32 s36, s48, 299520
	s_add_u32 m0, s44, 66560
	s_nop 0
	buffer_load_dwordx4 v100, s[8:11], s36 offen nt lds
	s_add_u32 s36, s48, 304128
	s_add_u32 m0, s44, 67584
	s_nop 0
	buffer_load_dwordx4 v100, s[8:11], s36 offen nt lds
	s_add_u32 s36, s48, 308736
	s_add_u32 m0, s44, 68608
	s_nop 0
	buffer_load_dwordx4 v100, s[8:11], s36 offen nt lds
	s_add_u32 s36, s48, 368640
	s_add_u32 m0, s44, 81920
	s_nop 0
	buffer_load_dwordx4 v100, s[8:11], s36 offen nt lds
	s_add_u32 s36, s48, 373248
	s_add_u32 m0, s44, 82944
	s_nop 0
	buffer_load_dwordx4 v100, s[8:11], s36 offen nt lds
	s_add_u32 s36, s48, 377856
	s_add_u32 m0, s44, 83968
	s_nop 0
	buffer_load_dwordx4 v100, s[8:11], s36 offen nt lds
	s_add_u32 s36, s48, 382464
	s_add_u32 m0, s44, 84992
	s_nop 0
	buffer_load_dwordx4 v100, s[8:11], s36 offen nt lds
	s_add_u32 s36, s48, 442368
	s_add_u32 m0, s44, 98304
	s_nop 0
	buffer_load_dwordx4 v100, s[8:11], s36 offen nt lds
	s_add_u32 s36, s48, 446976
	s_add_u32 m0, s44, 99328
	s_nop 0
	buffer_load_dwordx4 v100, s[8:11], s36 offen nt lds
	s_add_u32 s36, s48, 451584
	s_add_u32 m0, s44, 100352
	s_nop 0
	buffer_load_dwordx4 v100, s[8:11], s36 offen nt lds
	s_add_u32 s36, s48, 456192
	s_add_u32 m0, s44, 101376
	s_nop 0
	buffer_load_dwordx4 v100, s[8:11], s36 offen nt lds
	s_add_u32 s36, s48, 516096
	s_add_u32 m0, s44, 114688
	s_nop 0
	buffer_load_dwordx4 v100, s[8:11], s36 offen nt lds
	s_add_u32 s36, s48, 520704
	s_add_u32 m0, s44, 115712
	s_nop 0
	buffer_load_dwordx4 v100, s[8:11], s36 offen nt lds
	s_add_u32 s36, s48, 525312
	s_add_u32 m0, s44, 116736
	s_nop 0
	buffer_load_dwordx4 v100, s[8:11], s36 offen nt lds
	s_add_u32 s36, s48, 529920
	s_add_u32 m0, s44, 117760
	s_nop 0
	buffer_load_dwordx4 v100, s[8:11], s36 offen nt lds
	s_lshl_b32 s36, s26, 6
	v_xor_b32 v101, s36, v101
	s_waitcnt vmcnt(28)
	s_waitcnt lgkmcnt(0)
	s_barrier
	v_add_u32 v8, 0, v101
	ds_read_b64_tr_b16 a[0:1], v8 offset:0
	ds_read_b64_tr_b16 a[2:3], v8 offset:4096
	ds_read_b64_tr_b16 a[4:5], v8 offset:2048
	ds_read_b64_tr_b16 a[6:7], v8 offset:6144
	ds_read_b64_tr_b16 a[8:9], v8 offset:8192
	ds_read_b64_tr_b16 a[10:11], v8 offset:12288
	ds_read_b64_tr_b16 a[12:13], v8 offset:10240
	ds_read_b64_tr_b16 a[14:15], v8 offset:14336
	s_waitcnt vmcnt(24)
	s_waitcnt lgkmcnt(0)
	s_barrier
	v_add_u32 v8, 16384, v101
	ds_read_b64_tr_b16 a[16:17], v8 offset:0
	ds_read_b64_tr_b16 a[18:19], v8 offset:4096
	ds_read_b64_tr_b16 a[20:21], v8 offset:2048
	ds_read_b64_tr_b16 a[22:23], v8 offset:6144
	ds_read_b64_tr_b16 a[24:25], v8 offset:8192
	ds_read_b64_tr_b16 a[26:27], v8 offset:12288
	ds_read_b64_tr_b16 a[28:29], v8 offset:10240
	ds_read_b64_tr_b16 a[30:31], v8 offset:14336
	s_waitcnt vmcnt(20)
	s_waitcnt lgkmcnt(0)
	s_barrier
	v_add_u32 v8, 32768, v101
	ds_read_b64_tr_b16 a[32:33], v8 offset:0
	ds_read_b64_tr_b16 a[34:35], v8 offset:4096
	ds_read_b64_tr_b16 a[36:37], v8 offset:2048
	ds_read_b64_tr_b16 a[38:39], v8 offset:6144
	ds_read_b64_tr_b16 a[40:41], v8 offset:8192
	ds_read_b64_tr_b16 a[42:43], v8 offset:12288
	ds_read_b64_tr_b16 a[44:45], v8 offset:10240
	ds_read_b64_tr_b16 a[46:47], v8 offset:14336
	s_waitcnt vmcnt(16)
	s_waitcnt lgkmcnt(0)
	s_barrier
	v_add_u32 v8, 49152, v101
	ds_read_b64_tr_b16 a[48:49], v8 offset:0
	ds_read_b64_tr_b16 a[50:51], v8 offset:4096
	ds_read_b64_tr_b16 a[52:53], v8 offset:2048
	ds_read_b64_tr_b16 a[54:55], v8 offset:6144
	ds_read_b64_tr_b16 a[56:57], v8 offset:8192
	ds_read_b64_tr_b16 a[58:59], v8 offset:12288
	ds_read_b64_tr_b16 a[60:61], v8 offset:10240
	ds_read_b64_tr_b16 a[62:63], v8 offset:14336
	s_waitcnt vmcnt(12)
	s_waitcnt lgkmcnt(0)
	s_barrier
	v_add_u32 v8, 65536, v101
	ds_read_b64_tr_b16 a[64:65], v8 offset:0
	ds_read_b64_tr_b16 a[66:67], v8 offset:4096
	ds_read_b64_tr_b16 a[68:69], v8 offset:2048
	ds_read_b64_tr_b16 a[70:71], v8 offset:6144
	ds_read_b64_tr_b16 a[72:73], v8 offset:8192
	ds_read_b64_tr_b16 a[74:75], v8 offset:12288
	ds_read_b64_tr_b16 a[76:77], v8 offset:10240
	ds_read_b64_tr_b16 a[78:79], v8 offset:14336
	s_waitcnt vmcnt(8)
	s_waitcnt lgkmcnt(0)
	s_barrier
	v_add_u32 v8, 81920, v101
	ds_read_b64_tr_b16 a[80:81], v8 offset:0
	ds_read_b64_tr_b16 a[82:83], v8 offset:4096
	ds_read_b64_tr_b16 a[84:85], v8 offset:2048
	ds_read_b64_tr_b16 a[86:87], v8 offset:6144
	ds_read_b64_tr_b16 a[88:89], v8 offset:8192
	ds_read_b64_tr_b16 a[90:91], v8 offset:12288
	ds_read_b64_tr_b16 a[92:93], v8 offset:10240
	ds_read_b64_tr_b16 a[94:95], v8 offset:14336
	s_waitcnt vmcnt(4)
	s_waitcnt lgkmcnt(0)
	s_barrier
	v_add_u32 v8, 98304, v101
	ds_read_b64_tr_b16 a[96:97], v8 offset:0
	ds_read_b64_tr_b16 a[98:99], v8 offset:4096
	ds_read_b64_tr_b16 a[100:101], v8 offset:2048
	ds_read_b64_tr_b16 a[102:103], v8 offset:6144
	ds_read_b64_tr_b16 a[104:105], v8 offset:8192
	ds_read_b64_tr_b16 a[106:107], v8 offset:12288
	ds_read_b64_tr_b16 a[108:109], v8 offset:10240
	ds_read_b64_tr_b16 a[110:111], v8 offset:14336
	s_waitcnt vmcnt(0)
	s_waitcnt lgkmcnt(0)
	s_barrier
	v_add_u32 v8, 114688, v101
	ds_read_b64_tr_b16 a[112:113], v8 offset:0
	ds_read_b64_tr_b16 a[114:115], v8 offset:4096
	ds_read_b64_tr_b16 a[116:117], v8 offset:2048
	ds_read_b64_tr_b16 a[118:119], v8 offset:6144
	ds_read_b64_tr_b16 a[120:121], v8 offset:8192
	ds_read_b64_tr_b16 a[122:123], v8 offset:12288
	ds_read_b64_tr_b16 a[124:125], v8 offset:10240
	ds_read_b64_tr_b16 a[126:127], v8 offset:14336
	s_waitcnt lgkmcnt(0)
	s_barrier
	v_add_u32 v2, 36864, v0
	v_xor_b32 v2, v2, v0
	s_lshl_b32 s32, s27, 7
	s_lshl_b32 s36, s26, 2
	s_add_u32 s32, s32, s36
	s_add_u32 s32, s32, 0x3304000
	s_mul_i32 s30, s47, 32768
	s_add_u32 s30, s30, 0x4000000
	s_lshl_b32 s33, s47, 9
	s_add_u32 s33, s33, 0x3303000
	s_lshl_b32 s36, s49, 2
	s_add_u32 s36, s36, s26
	s_lshl_b32 s31, s36, 11
	s_mul_i32 s37, s47, 36864
	s_add_u32 s31, s31, s37
	s_add_u32 s31, s31, 0x6600000
	s_add_u32 s37, s31, 0x4000000
	s_cmp_lt_u32 s36, 18
	s_cselect_b32 s31, s31, s37
	v_mov_b64 v[108:109], -1
	v_mov_b64 v[110:111], -1
	s_add_u32 s36, s31, 0
	buffer_store_dwordx4 v[108:111], v0, s[4:7], s36 offen offset:0 sc1
	buffer_store_dwordx4 v[108:111], v0, s[4:7], s36 offen offset:1024 sc1
	s_add_u32 s36, s31, 294912
	buffer_store_dwordx4 v[108:111], v0, s[4:7], s36 offen offset:0 sc1
	buffer_store_dwordx4 v[108:111], v0, s[4:7], s36 offen offset:1024 sc1
	s_add_u32 s36, s31, 589824
	buffer_store_dwordx4 v[108:111], v0, s[4:7], s36 offen offset:0 sc1
	buffer_store_dwordx4 v[108:111], v0, s[4:7], s36 offen offset:1024 sc1
	s_add_u32 s36, s31, 884736
	buffer_store_dwordx4 v[108:111], v0, s[4:7], s36 offen offset:0 sc1
	buffer_store_dwordx4 v[108:111], v0, s[4:7], s36 offen offset:1024 sc1
	s_waitcnt vmcnt(0)
	v_mov_b32 v8, 0
wo_init:
	global_load_dword v9, v8, s[24:25] offset:8 sc1
	s_sub_u32 s34, s34, 1
	s_cbranch_scc1 all_exit
	s_waitcnt vmcnt(0)
	v_readfirstlane_b32 s36, v9
	s_cmp_eq_u32 s36, 0
	s_cbranch_scc1 wo_init
	v_mov_b32 v98, 1
	s_mov_b64 exec, 1
	buffer_store_dword v98, off, s[4:7], s32 sc1
	s_mov_b64 exec, -1
	s_mul_i32 s47, s26, 8192
	s_add_u32 s30, s30, s47
	s_mov_b32 s35, s47
	s_lshl_b32 s46, s47, 1
	s_add_u32 s46, s46, 36864
	v_mov_b32 v1, v0
	s_mov_b32 s28, 0
wo_sp:
	buffer_load_dword v96, v104, s[4:7], s33 offen sc1
	s_sub_u32 s34, s34, 1
	s_cbranch_scc1 all_exit
	s_waitcnt vmcnt(0)
	v_cmp_gt_u32 vcc, 1, v96
	s_cbranch_vccnz wo_sp
	v_add_u32 v3, s47, v1
wo_again:
	s_mov_b32 m0, s35
	s_nop 0
	buffer_load_dwordx4 v0, s[4:7], s30 offen offset:0 sc1 lds
	buffer_load_dwordx4 v0, s[4:7], s30 offen offset:1024 sc1 lds
	buffer_load_dwordx4 v0, s[4:7], s30 offen offset:2048 sc1 lds
	buffer_load_dwordx4 v0, s[4:7], s30 offen offset:3072 sc1 lds
	s_add_u32 m0, s35, 4096
	s_add_u32 s36, s30, 4096
	buffer_load_dwordx4 v0, s[4:7], s36 offen offset:0 sc1 lds
	buffer_load_dwordx4 v0, s[4:7], s36 offen offset:1024 sc1 lds
	buffer_load_dwordx4 v0, s[4:7], s36 offen offset:2048 sc1 lds
	buffer_load_dwordx4 v0, s[4:7], s36 offen offset:3072 sc1 lds
	s_sub_u32 s34, s34, 1
	s_cbranch_scc1 all_exit
	s_waitcnt vmcnt(0)
wo_loop:
	s_waitcnt vmcnt(2)
	ds_read2st64_b32 v[88:89], v3 offset0:0 offset1:4
	ds_read2st64_b32 v[90:91], v3 offset0:8 offset1:12
	ds_read2st64_b32 v[92:93], v3 offset0:16 offset1:20
	ds_read2st64_b32 v[94:95], v3 offset0:24 offset1:28
	s_waitcnt lgkmcnt(2)
	v_max3_u32 v88, v88, v89, v90
	s_waitcnt lgkmcnt(1)
	v_max3_u32 v91, v91, v92, v93
	s_waitcnt lgkmcnt(0)
	v_max3_u32 v94, v94, v95, v95
	v_max3_u32 v88, v88, v91, v94
	v_cmp_eq_u32 vcc, -1, v88
	s_cbranch_vccnz wo_again
	s_barrier
	ds_read_b128 v[40:43], v1 offset:0
	ds_read_b128 v[44:47], v1 offset:1024
	ds_read_b128 v[48:51], v1 offset:2048
	ds_read_b128 v[52:55], v1 offset:3072
	ds_read_b128 v[56:59], v1 offset:4096
	ds_read_b128 v[60:63], v1 offset:5120
	s_add_u32 s30, s30, 262144
	s_sub_u32 s35, s46, s35
	s_waitcnt lgkmcnt(5)
	v_mfma_f32_32x32x16_bf16 v[8:23], a[0:3], v[40:43], 0
	ds_read_b128 v[64:67], v1 offset:6144
	s_add_u32 s37, s31, 1179648
	buffer_store_dwordx4 v[108:111], v0, s[4:7], s37 offen offset:0 sc1
	s_waitcnt lgkmcnt(5)
	v_mfma_f32_32x32x16_bf16 v[8:23], a[4:7], v[44:47], v[8:23]
	ds_read_b128 v[68:71], v1 offset:7168
	s_waitcnt lgkmcnt(5)
	v_mfma_f32_32x32x16_bf16 v[8:23], a[8:11], v[48:51], v[8:23]
	ds_read_b128 v[40:43], v1 offset:8192
	buffer_store_dwordx4 v[108:111], v0, s[4:7], s37 offen offset:1024 sc1
	s_waitcnt lgkmcnt(5)
	v_mfma_f32_32x32x16_bf16 v[8:23], a[12:15], v[52:55], v[8:23]
	ds_read_b128 v[44:47], v1 offset:9216
	s_waitcnt lgkmcnt(5)
	v_mfma_f32_32x32x16_bf16 v[8:23], a[16:19], v[56:59], v[8:23]
	ds_read_b128 v[48:51], v1 offset:10240
	s_mov_b32 m0, s35
	s_waitcnt lgkmcnt(5)
	v_mfma_f32_32x32x16_bf16 v[8:23], a[20:23], v[60:63], v[8:23]
	ds_read_b128 v[52:55], v1 offset:11264
	buffer_load_dwordx4 v0, s[4:7], s30 offen offset:0 sc1 lds
	s_waitcnt lgkmcnt(5)
	v_mfma_f32_32x32x16_bf16 v[8:23], a[24:27], v[64:67], v[8:23]
	ds_read_b128 v[56:59], v1 offset:12288
	s_waitcnt lgkmcnt(5)
	v_mfma_f32_32x32x16_bf16 v[8:23], a[28:31], v[68:71], v[8:23]
	ds_read_b128 v[60:63], v1 offset:13312
	buffer_load_dwordx4 v0, s[4:7], s30 offen offset:1024 sc1 lds
	s_waitcnt lgkmcnt(5)
	v_mfma_f32_32x32x16_bf16 v[8:23], a[32:35], v[40:43], v[8:23]
	ds_read_b128 v[64:67], v1 offset:14336
	s_waitcnt lgkmcnt(5)
	v_mfma_f32_32x32x16_bf16 v[8:23], a[36:39], v[44:47], v[8:23]
	ds_read_b128 v[68:71], v1 offset:15360
	buffer_load_dwordx4 v0, s[4:7], s30 offen offset:2048 sc1 lds
	s_waitcnt lgkmcnt(5)
	v_mfma_f32_32x32x16_bf16 v[8:23], a[40:43], v[48:51], v[8:23]
	ds_read_b128 v[40:43], v1 offset:16384
	s_waitcnt lgkmcnt(5)
	v_mfma_f32_32x32x16_bf16 v[8:23], a[44:47], v[52:55], v[8:23]
	ds_read_b128 v[44:47], v1 offset:17408
	buffer_load_dwordx4 v0, s[4:7], s30 offen offset:3072 sc1 lds
	s_waitcnt lgkmcnt(5)
	v_mfma_f32_32x32x16_bf16 v[8:23], a[48:51], v[56:59], v[8:23]
	ds_read_b128 v[48:51], v1 offset:18432
	s_waitcnt lgkmcnt(5)
	v_mfma_f32_32x32x16_bf16 v[8:23], a[52:55], v[60:63], v[8:23]
	ds_read_b128 v[52:55], v1 offset:19456
	s_add_u32 m0, s35, 4096
	s_add_u32 s36, s30, 4096
	s_waitcnt lgkmcnt(5)
	v_mfma_f32_32x32x16_bf16 v[8:23], a[56:59], v[64:67], v[8:23]
	ds_read_b128 v[56:59], v1 offset:20480
	buffer_load_dwordx4 v0, s[4:7], s36 offen offset:0 sc1 lds
	s_waitcnt lgkmcnt(5)
	v_mfma_f32_32x32x16_bf16 v[8:23], a[60:63], v[68:71], v[8:23]
	ds_read_b128 v[60:63], v1 offset:21504
	s_waitcnt lgkmcnt(5)
	v_mfma_f32_32x32x16_bf16 v[8:23], a[64:67], v[40:43], v[8:23]
	ds_read_b128 v[64:67], v1 offset:22528
	buffer_load_dwordx4 v0, s[4:7], s36 offen offset:1024 sc1 lds
	s_waitcnt lgkmcnt(5)
	v_mfma_f32_32x32x16_bf16 v[8:23], a[68:71], v[44:47], v[8:23]
	ds_read_b128 v[68:71], v1 offset:23552
	s_waitcnt lgkmcnt(5)
	v_mfma_f32_32x32x16_bf16 v[8:23], a[72:75], v[48:51], v[8:23]
	ds_read_b128 v[40:43], v1 offset:24576
	buffer_load_dwordx4 v0, s[4:7], s36 offen offset:2048 sc1 lds
	s_waitcnt lgkmcnt(5)
	v_mfma_f32_32x32x16_bf16 v[8:23], a[76:79], v[52:55], v[8:23]
	ds_read_b128 v[44:47], v1 offset:25600
	s_waitcnt lgkmcnt(5)
	v_mfma_f32_32x32x16_bf16 v[8:23], a[80:83], v[56:59], v[8:23]
	ds_read_b128 v[48:51], v1 offset:26624
	buffer_load_dwordx4 v0, s[4:7], s36 offen offset:3072 sc1 lds
	s_waitcnt lgkmcnt(5)
	v_mfma_f32_32x32x16_bf16 v[8:23], a[84:87], v[60:63], v[8:23]
	ds_read_b128 v[52:55], v1 offset:27648
	s_waitcnt lgkmcnt(5)
	v_mfma_f32_32x32x16_bf16 v[8:23], a[88:91], v[64:67], v[8:23]
	ds_read_b128 v[56:59], v1 offset:28672
	s_waitcnt lgkmcnt(5)
	v_mfma_f32_32x32x16_bf16 v[8:23], a[92:95], v[68:71], v[8:23]
	ds_read_b128 v[60:63], v1 offset:29696
	s_waitcnt lgkmcnt(5)
	v_mfma_f32_32x32x16_bf16 v[8:23], a[96:99], v[40:43], v[8:23]
	ds_read_b128 v[64:67], v1 offset:30720
	s_waitcnt lgkmcnt(5)
	v_mfma_f32_32x32x16_bf16 v[8:23], a[100:103], v[44:47], v[8:23]
	ds_read_b128 v[68:71], v1 offset:31744
	s_waitcnt lgkmcnt(5)
	v_mfma_f32_32x32x16_bf16 v[8:23], a[104:107], v[48:51], v[8:23]
	s_waitcnt lgkmcnt(4)
	v_mfma_f32_32x32x16_bf16 v[8:23], a[108:111], v[52:55], v[8:23]
	s_waitcnt lgkmcnt(3)
	v_mfma_f32_32x32x16_bf16 v[8:23], a[112:115], v[56:59], v[8:23]
	s_waitcnt lgkmcnt(2)
	v_mfma_f32_32x32x16_bf16 v[8:23], a[116:119], v[60:63], v[8:23]
	s_waitcnt lgkmcnt(1)
	v_mfma_f32_32x32x16_bf16 v[8:23], a[120:123], v[64:67], v[8:23]
	s_waitcnt lgkmcnt(0)
	v_mfma_f32_32x32x16_bf16 v[8:23], a[124:127], v[68:71], v[8:23]
	v_xor_b32 v1, v2, v1
	v_add_u32 v3, s47, v1
	s_nop 9
	v_cvt_pk_bf16_f32 v72, v8, v9
	v_cvt_pk_bf16_f32 v73, v10, v11
	v_cvt_pk_bf16_f32 v74, v12, v13
	v_cvt_pk_bf16_f32 v75, v14, v15
	v_cvt_pk_bf16_f32 v76, v16, v17
	v_cvt_pk_bf16_f32 v77, v18, v19
	v_cvt_pk_bf16_f32 v78, v20, v21
	v_cvt_pk_bf16_f32 v79, v22, v23
	buffer_store_dwordx4 v[72:75], v0, s[4:7], s31 offen offset:0 sc1
	buffer_store_dwordx4 v[76:79], v0, s[4:7], s31 offen offset:1024 sc1
	s_add_u32 s31, s31, 294912
	s_add_u32 s28, s28, 1
	s_cmp_lt_u32 s28, 64
	s_cbranch_scc1 wo_loop
	s_branch all_exit
dn_entry:
	v_add_u32 v8, 9216, v0
	global_load_dwordx4 v[100:103], v8, s[64:65]
	global_load_dwordx4 v[104:107], v8, s[64:65] offset:1024
	s_load_dwordx2 s[8:9], s[0:1], 80
	s_mov_b32 s10, 5308416
	s_mov_b32 s11, 0x00020000
	s_mul_i32 s47, s27, 52
	s_lshr_b32 s47, s47, 8
	s_mul_i32 s36, s47, 5
	s_sub_u32 s49, s27, s36
	s_mul_i32 s48, s47, 663552
	s_mul_i32 s36, s26, 18432
	s_add_u32 s48, s48, s36
	s_lshl_b32 s36, s49, 8
	s_add_u32 s48, s48, s36
	s_waitcnt vmcnt(0) lgkmcnt(0)
	v_mov_b32 v8, 0
dn_hold:
	global_load_dword v9, v8, s[24:25] offset:128 sc1
	s_sub_u32 s34, s34, 1
	s_cbranch_scc1 all_exit
	s_waitcnt vmcnt(0)
	v_readfirstlane_b32 s36, v9
	s_cmp_lt_u32 s36, 32
	s_cbranch_scc1 dn_hold
	s_add_u32 s36, s48, 0
	s_add_u32 m0, s44, 0
	s_nop 0
	buffer_load_dwordx4 v100, s[8:11], s36 offen nt lds
	s_add_u32 s36, s48, 4608
	s_add_u32 m0, s44, 1024
	s_nop 0
	buffer_load_dwordx4 v100, s[8:11], s36 offen nt lds
	s_add_u32 s36, s48, 9216
	s_add_u32 m0, s44, 2048
	s_nop 0
	buffer_load_dwordx4 v100, s[8:11], s36 offen nt lds
	s_add_u32 s36, s48, 13824
	s_add_u32 m0, s44, 3072
	s_nop 0
	buffer_load_dwordx4 v100, s[8:11], s36 offen nt lds
	s_add_u32 s36, s48, 73728
	s_add_u32 m0, s44, 16384
	s_nop 0
	buffer_load_dwordx4 v100, s[8:11], s36 offen nt lds
	s_add_u32 s36, s48, 78336
	s_add_u32 m0, s44, 17408
	s_nop 0
	buffer_load_dwordx4 v100, s[8:11], s36 offen nt lds
	s_add_u32 s36, s48, 82944
	s_add_u32 m0, s44, 18432
	s_nop 0
	buffer_load_dwordx4 v100, s[8:11], s36 offen nt lds
	s_add_u32 s36, s48, 87552
	s_add_u32 m0, s44, 19456
	s_nop 0
	buffer_load_dwordx4 v100, s[8:11], s36 offen nt lds
	s_add_u32 s36, s48, 147456
	s_add_u32 m0, s44, 32768
	s_nop 0
	buffer_load_dwordx4 v100, s[8:11], s36 offen nt lds
	s_add_u32 s36, s48, 152064
	s_add_u32 m0, s44, 33792
	s_nop 0
	buffer_load_dwordx4 v100, s[8:11], s36 offen nt lds
	s_add_u32 s36, s48, 156672
	s_add_u32 m0, s44, 34816
	s_nop 0
	buffer_load_dwordx4 v100, s[8:11], s36 offen nt lds
	s_add_u32 s36, s48, 161280
	s_add_u32 m0, s44, 35840
	s_nop 0
	buffer_load_dwordx4 v100, s[8:11], s36 offen nt lds
	s_add_u32 s36, s48, 221184
	s_add_u32 m0, s44, 49152
	s_nop 0
	buffer_load_dwordx4 v100, s[8:11], s36 offen nt lds
	s_add_u32 s36, s48, 225792
	s_add_u32 m0, s44, 50176
	s_nop 0
	buffer_load_dwordx4 v100, s[8:11], s36 offen nt lds
	s_add_u32 s36, s48, 230400
	s_add_u32 m0, s44, 51200
	s_nop 0
	buffer_load_dwordx4 v100, s[8:11], s36 offen nt lds
	s_add_u32 s36, s48, 235008
	s_add_u32 m0, s44, 52224
	s_nop 0
	buffer_load_dwordx4 v100, s[8:11], s36 offen nt lds
	s_add_u32 s36, s48, 294912
	s_add_u32 m0, s44, 65536
	s_nop 0
	buffer_load_dwordx4 v100, s[8:11], s36 offen nt lds
	s_add_u32 s36, s48, 299520
	s_add_u32 m0, s44, 66560
	s_nop 0
	buffer_load_dwordx4 v100, s[8:11], s36 offen nt lds
	s_add_u32 s36, s48, 304128
	s_add_u32 m0, s44, 67584
	s_nop 0
	buffer_load_dwordx4 v100, s[8:11], s36 offen nt lds
	s_add_u32 s36, s48, 308736
	s_add_u32 m0, s44, 68608
	s_nop 0
	buffer_load_dwordx4 v100, s[8:11], s36 offen nt lds
	s_add_u32 s36, s48, 368640
	s_add_u32 m0, s44, 81920
	s_nop 0
	buffer_load_dwordx4 v100, s[8:11], s36 offen nt lds
	s_add_u32 s36, s48, 373248
	s_add_u32 m0, s44, 82944
	s_nop 0
	buffer_load_dwordx4 v100, s[8:11], s36 offen nt lds
	s_add_u32 s36, s48, 377856
	s_add_u32 m0, s44, 83968
	s_nop 0
	buffer_load_dwordx4 v100, s[8:11], s36 offen nt lds
	s_add_u32 s36, s48, 382464
	s_add_u32 m0, s44, 84992
	s_nop 0
	buffer_load_dwordx4 v100, s[8:11], s36 offen nt lds
	s_add_u32 s36, s48, 442368
	s_add_u32 m0, s44, 98304
	s_nop 0
	buffer_load_dwordx4 v100, s[8:11], s36 offen nt lds
	s_add_u32 s36, s48, 446976
	s_add_u32 m0, s44, 99328
	s_nop 0
	buffer_load_dwordx4 v100, s[8:11], s36 offen nt lds
	s_add_u32 s36, s48, 451584
	s_add_u32 m0, s44, 100352
	s_nop 0
	buffer_load_dwordx4 v100, s[8:11], s36 offen nt lds
	s_add_u32 s36, s48, 456192
	s_add_u32 m0, s44, 101376
	s_nop 0
	buffer_load_dwordx4 v100, s[8:11], s36 offen nt lds
	s_add_u32 s36, s48, 516096
	s_add_u32 m0, s44, 114688
	s_nop 0
	buffer_load_dwordx4 v100, s[8:11], s36 offen nt lds
	s_add_u32 s36, s48, 520704
	s_add_u32 m0, s44, 115712
	s_nop 0
	buffer_load_dwordx4 v100, s[8:11], s36 offen nt lds
	s_add_u32 s36, s48, 525312
	s_add_u32 m0, s44, 116736
	s_nop 0
	buffer_load_dwordx4 v100, s[8:11], s36 offen nt lds
	s_add_u32 s36, s48, 529920
	s_add_u32 m0, s44, 117760
	s_nop 0
	buffer_load_dwordx4 v100, s[8:11], s36 offen nt lds
	s_add_u32 s36, s48, 589824
	s_add_u32 m0, s44, 131072
	s_nop 0
	buffer_load_dwordx4 v100, s[8:11], s36 offen nt lds
	s_add_u32 s36, s48, 594432
	s_add_u32 m0, s44, 132096
	s_nop 0
	buffer_load_dwordx4 v100, s[8:11], s36 offen nt lds
	s_add_u32 s36, s48, 599040
	s_add_u32 m0, s44, 133120
	s_nop 0
	buffer_load_dwordx4 v100, s[8:11], s36 offen nt lds
	s_add_u32 s36, s48, 603648
	s_add_u32 m0, s44, 134144
	s_nop 0
	buffer_load_dwordx4 v100, s[8:11], s36 offen nt lds
	s_lshl_b32 s36, s26, 6
	v_xor_b32 v101, s36, v101
	s_waitcnt vmcnt(32)
	s_waitcnt lgkmcnt(0)
	s_barrier
	v_add_u32 v8, 0, v101
	ds_read_b64_tr_b16 a[0:1], v8 offset:0
	ds_read_b64_tr_b16 a[2:3], v8 offset:2048
	ds_read_b64_tr_b16 a[4:5], v8 offset:4096
	ds_read_b64_tr_b16 a[6:7], v8 offset:6144
	ds_read_b64_tr_b16 a[8:9], v8 offset:8192
	ds_read_b64_tr_b16 a[10:11], v8 offset:10240
	ds_read_b64_tr_b16 a[12:13], v8 offset:12288
	ds_read_b64_tr_b16 a[14:15], v8 offset:14336
	s_waitcnt vmcnt(28)
	s_waitcnt lgkmcnt(0)
	s_barrier
	v_add_u32 v8, 16384, v101
	ds_read_b64_tr_b16 a[16:17], v8 offset:0
	ds_read_b64_tr_b16 a[18:19], v8 offset:2048
	ds_read_b64_tr_b16 a[20:21], v8 offset:4096
	ds_read_b64_tr_b16 a[22:23], v8 offset:6144
	ds_read_b64_tr_b16 a[24:25], v8 offset:8192
	ds_read_b64_tr_b16 a[26:27], v8 offset:10240
	ds_read_b64_tr_b16 a[28:29], v8 offset:12288
	ds_read_b64_tr_b16 a[30:31], v8 offset:14336
	s_waitcnt vmcnt(24)
	s_waitcnt lgkmcnt(0)
	s_barrier
	v_add_u32 v8, 32768, v101
	ds_read_b64_tr_b16 a[32:33], v8 offset:0
	ds_read_b64_tr_b16 a[34:35], v8 offset:2048
	ds_read_b64_tr_b16 a[36:37], v8 offset:4096
	ds_read_b64_tr_b16 a[38:39], v8 offset:6144
	ds_read_b64_tr_b16 a[40:41], v8 offset:8192
	ds_read_b64_tr_b16 a[42:43], v8 offset:10240
	ds_read_b64_tr_b16 a[44:45], v8 offset:12288
	ds_read_b64_tr_b16 a[46:47], v8 offset:14336
	s_waitcnt vmcnt(20)
	s_waitcnt lgkmcnt(0)
	s_barrier
	v_add_u32 v8, 49152, v101
	ds_read_b64_tr_b16 a[48:49], v8 offset:0
	ds_read_b64_tr_b16 a[50:51], v8 offset:2048
	ds_read_b64_tr_b16 a[52:53], v8 offset:4096
	ds_read_b64_tr_b16 a[54:55], v8 offset:6144
	ds_read_b64_tr_b16 a[56:57], v8 offset:8192
	ds_read_b64_tr_b16 a[58:59], v8 offset:10240
	ds_read_b64_tr_b16 a[60:61], v8 offset:12288
	ds_read_b64_tr_b16 a[62:63], v8 offset:14336
	s_waitcnt vmcnt(16)
	s_waitcnt lgkmcnt(0)
	s_barrier
	v_add_u32 v8, 65536, v101
	ds_read_b64_tr_b16 a[64:65], v8 offset:0
	ds_read_b64_tr_b16 a[66:67], v8 offset:2048
	ds_read_b64_tr_b16 a[68:69], v8 offset:4096
	ds_read_b64_tr_b16 a[70:71], v8 offset:6144
	ds_read_b64_tr_b16 a[72:73], v8 offset:8192
	ds_read_b64_tr_b16 a[74:75], v8 offset:10240
	ds_read_b64_tr_b16 a[76:77], v8 offset:12288
	ds_read_b64_tr_b16 a[78:79], v8 offset:14336
	s_waitcnt vmcnt(12)
	s_waitcnt lgkmcnt(0)
	s_barrier
	v_add_u32 v8, 81920, v101
	ds_read_b64_tr_b16 a[80:81], v8 offset:0
	ds_read_b64_tr_b16 a[82:83], v8 offset:2048
	ds_read_b64_tr_b16 a[84:85], v8 offset:4096
	ds_read_b64_tr_b16 a[86:87], v8 offset:6144
	ds_read_b64_tr_b16 a[88:89], v8 offset:8192
	ds_read_b64_tr_b16 a[90:91], v8 offset:10240
	ds_read_b64_tr_b16 a[92:93], v8 offset:12288
	ds_read_b64_tr_b16 a[94:95], v8 offset:14336
	s_waitcnt vmcnt(8)
	s_waitcnt lgkmcnt(0)
	s_barrier
	v_add_u32 v8, 98304, v101
	ds_read_b64_tr_b16 a[96:97], v8 offset:0
	ds_read_b64_tr_b16 a[98:99], v8 offset:2048
	ds_read_b64_tr_b16 a[100:101], v8 offset:4096
	ds_read_b64_tr_b16 a[102:103], v8 offset:6144
	ds_read_b64_tr_b16 a[104:105], v8 offset:8192
	ds_read_b64_tr_b16 a[106:107], v8 offset:10240
	ds_read_b64_tr_b16 a[108:109], v8 offset:12288
	ds_read_b64_tr_b16 a[110:111], v8 offset:14336
	s_waitcnt vmcnt(4)
	s_waitcnt lgkmcnt(0)
	s_barrier
	v_add_u32 v8, 114688, v101
	ds_read_b64_tr_b16 a[112:113], v8 offset:0
	ds_read_b64_tr_b16 a[114:115], v8 offset:2048
	ds_read_b64_tr_b16 a[116:117], v8 offset:4096
	ds_read_b64_tr_b16 a[118:119], v8 offset:6144
	ds_read_b64_tr_b16 a[120:121], v8 offset:8192
	ds_read_b64_tr_b16 a[122:123], v8 offset:10240
	ds_read_b64_tr_b16 a[124:125], v8 offset:12288
	ds_read_b64_tr_b16 a[126:127], v8 offset:14336
	s_waitcnt vmcnt(0)
	s_waitcnt lgkmcnt(0)
	s_barrier
	v_add_u32 v8, 131072, v101
	ds_read_b64_tr_b16 a[128:129], v8 offset:0
	ds_read_b64_tr_b16 a[130:131], v8 offset:2048
	ds_read_b64_tr_b16 a[132:133], v8 offset:4096
	ds_read_b64_tr_b16 a[134:135], v8 offset:6144
	ds_read_b64_tr_b16 a[136:137], v8 offset:8192
	ds_read_b64_tr_b16 a[138:139], v8 offset:10240
	ds_read_b64_tr_b16 a[140:141], v8 offset:12288
	ds_read_b64_tr_b16 a[142:143], v8 offset:14336
	s_waitcnt lgkmcnt(0)
	s_barrier
	v_add_u32 v2, 36864, v0
	v_xor_b32 v2, v2, v0
	s_lshl_b32 s32, s27, 7
	s_lshl_b32 s36, s26, 2
	s_add_u32 s32, s32, s36
	s_add_u32 s32, s32, 0x3306c00
	s_mul_i32 s30, s47, 36864
	s_add_u32 s30, s30, 0x5200000
	s_mul_i32 s36, s47, 18
	v_add_u32 v104, s36, v104
	v_lshrrev_b32 v8, 2, v104
	v_and_b32 v104, 3, v104
	v_lshlrev_b32 v104, 2, v104
	v_lshl_add_u32 v104, v8, 7, v104
	s_mov_b32 s33, 0x3305a00
	s_lshl_b32 s36, s49, 2
	s_add_u32 s36, s36, s26
	s_lshl_b32 s31, s36, 11
	s_mul_i32 s37, s47, 36864
	s_add_u32 s31, s31, s37
	s_add_u32 s31, s31, 0x7a00000
	s_add_u32 s37, s31, 0x4000000
	s_cmp_lt_u32 s36, 18
	s_cselect_b32 s31, s31, s37
	v_mov_b64 v[108:109], -1
	v_mov_b64 v[110:111], -1
	s_add_u32 s36, s31, 0
	buffer_store_dwordx4 v[108:111], v0, s[4:7], s36 offen offset:0 sc1
	buffer_store_dwordx4 v[108:111], v0, s[4:7], s36 offen offset:1024 sc1
	s_add_u32 s36, s31, 294912
	buffer_store_dwordx4 v[108:111], v0, s[4:7], s36 offen offset:0 sc1
	buffer_store_dwordx4 v[108:111], v0, s[4:7], s36 offen offset:1024 sc1
	s_add_u32 s36, s31, 589824
	buffer_store_dwordx4 v[108:111], v0, s[4:7], s36 offen offset:0 sc1
	buffer_store_dwordx4 v[108:111], v0, s[4:7], s36 offen offset:1024 sc1
	s_add_u32 s36, s31, 884736
	buffer_store_dwordx4 v[108:111], v0, s[4:7], s36 offen offset:0 sc1
	buffer_store_dwordx4 v[108:111], v0, s[4:7], s36 offen offset:1024 sc1
	s_waitcnt vmcnt(0)
	v_mov_b32 v8, 0
dn_init:
	global_load_dword v9, v8, s[24:25] offset:8 sc1
	s_sub_u32 s34, s34, 1
	s_cbranch_scc1 all_exit
	s_waitcnt vmcnt(0)
	v_readfirstlane_b32 s36, v9
	s_cmp_eq_u32 s36, 0
	s_cbranch_scc1 dn_init
	v_mov_b32 v98, 1
	s_mov_b64 exec, 1
	buffer_store_dword v98, off, s[4:7], s32 sc1
	s_mov_b64 exec, -1
	s_mul_i32 s47, s26, 9216
	s_add_u32 s30, s30, s47
	s_mov_b32 s35, s47
	s_lshl_b32 s46, s47, 1
	s_add_u32 s46, s46, 36864
	v_mov_b32 v1, v0
	s_mov_b32 s28, 0
dn_sp:
	buffer_load_dword v96, v104, s[4:7], s33 offen sc1
	s_sub_u32 s34, s34, 1
	s_cbranch_scc1 all_exit
	s_waitcnt vmcnt(0)
	v_cmp_gt_u32 vcc, 1, v96
	s_cbranch_vccnz dn_sp
	v_add_u32 v3, s47, v1
	s_mov_b32 s29, 0
dn_again:
	s_cmp_eq_u32 s29, 1
	s_cbranch_scc1 dn_seen
	s_mov_b64 exec, 1
dn_look:
	buffer_load_dword v92, v105, s[4:7], s30 offen offset:0 sc1
	s_sub_u32 s34, s34, 1
	s_cbranch_scc1 all_exit
	s_waitcnt vmcnt(0)
	v_cmp_eq_u32 vcc, -1, v92
	s_cbranch_vccnz dn_look
	s_mov_b64 exec, -1
	s_mov_b32 s29, 1
dn_seen:
	s_mov_b32 m0, s35
	s_nop 0
	buffer_load_dwordx4 v0, s[4:7], s30 offen offset:0 sc1 lds
	buffer_load_dwordx4 v0, s[4:7], s30 offen offset:1024 sc1 lds
	buffer_load_dwordx4 v0, s[4:7], s30 offen offset:2048 sc1 lds
	buffer_load_dwordx4 v0, s[4:7], s30 offen offset:3072 sc1 lds
	s_add_u32 m0, s35, 4096
	s_add_u32 s36, s30, 4096
	buffer_load_dwordx4 v0, s[4:7], s36 offen offset:0 sc1 lds
	buffer_load_dwordx4 v0, s[4:7], s36 offen offset:1024 sc1 lds
	buffer_load_dwordx4 v0, s[4:7], s36 offen offset:2048 sc1 lds
	buffer_load_dwordx4 v0, s[4:7], s36 offen offset:3072 sc1 lds
	s_add_u32 m0, s35, 8192
	s_add_u32 s36, s30, 8192
	buffer_load_dwordx4 v0, s[4:7], s36 offen offset:0 sc1 lds
	s_sub_u32 s34, s34, 1
	s_cbranch_scc1 all_exit
	s_waitcnt vmcnt(0)
dn_loop:
	s_waitcnt vmcnt(2)
	ds_read2st64_b32 v[88:89], v3 offset0:0 offset1:4
	ds_read2st64_b32 v[90:91], v3 offset0:8 offset1:12
	ds_read2st64_b32 v[92:93], v3 offset0:16 offset1:20
	ds_read2st64_b32 v[94:95], v3 offset0:24 offset1:28
	ds_read_b32 v96, v3 offset:8192
	s_waitcnt lgkmcnt(3)
	v_max3_u32 v88, v88, v89, v90
	s_waitcnt lgkmcnt(2)
	v_max3_u32 v91, v91, v92, v93
	s_waitcnt lgkmcnt(0)
	v_max3_u32 v94, v94, v95, v96
	v_max3_u32 v88, v88, v91, v94
	v_cmp_eq_u32 vcc, -1, v88
	s_cbranch_vccnz dn_again
	s_barrier
	ds_read_b128 v[40:43], v1 offset:0
	ds_read_b128 v[44:47], v1 offset:1024
	ds_read_b128 v[48:51], v1 offset:2048
	ds_read_b128 v[52:55], v1 offset:3072
	ds_read_b128 v[56:59], v1 offset:4096
	ds_read_b128 v[60:63], v1 offset:5120
	s_mov_b32 s29, 0
	s_add_u32 s30, s30, 294912
	s_sub_u32 s35, s46, s35
	s_waitcnt lgkmcnt(5)
	v_mfma_f32_32x32x16_bf16 v[8:23], a[0:3], v[40:43], 0
	ds_read_b128 v[64:67], v1 offset:6144
	s_add_u32 s37, s31, 1179648
	buffer_store_dwordx4 v[108:111], v0, s[4:7], s37 offen offset:0 sc1
	s_waitcnt lgkmcnt(5)
	v_mfma_f32_32x32x16_bf16 v[8:23], a[4:7], v[44:47], v[8:23]
	ds_read_b128 v[68:71], v1 offset:7168
	s_waitcnt lgkmcnt(5)
	v_mfma_f32_32x32x16_bf16 v[8:23], a[8:11], v[48:51], v[8:23]
	ds_read_b128 v[40:43], v1 offset:8192
	buffer_store_dwordx4 v[108:111], v0, s[4:7], s37 offen offset:1024 sc1
	s_waitcnt lgkmcnt(5)
	v_mfma_f32_32x32x16_bf16 v[8:23], a[12:15], v[52:55], v[8:23]
	ds_read_b128 v[44:47], v1 offset:9216
	s_waitcnt lgkmcnt(5)
	v_mfma_f32_32x32x16_bf16 v[8:23], a[16:19], v[56:59], v[8:23]
	ds_read_b128 v[48:51], v1 offset:10240
	s_mov_b32 m0, s35
	s_waitcnt lgkmcnt(5)
	v_mfma_f32_32x32x16_bf16 v[8:23], a[20:23], v[60:63], v[8:23]
	ds_read_b128 v[52:55], v1 offset:11264
	buffer_load_dwordx4 v0, s[4:7], s30 offen offset:0 sc1 lds
	s_waitcnt lgkmcnt(5)
	v_mfma_f32_32x32x16_bf16 v[8:23], a[24:27], v[64:67], v[8:23]
	ds_read_b128 v[56:59], v1 offset:12288
	s_waitcnt lgkmcnt(5)
	v_mfma_f32_32x32x16_bf16 v[8:23], a[28:31], v[68:71], v[8:23]
	ds_read_b128 v[60:63], v1 offset:13312
	buffer_load_dwordx4 v0, s[4:7], s30 offen offset:1024 sc1 lds
	s_waitcnt lgkmcnt(5)
	v_mfma_f32_32x32x16_bf16 v[8:23], a[32:35], v[40:43], v[8:23]
	ds_read_b128 v[64:67], v1 offset:14336
	s_waitcnt lgkmcnt(5)
	v_mfma_f32_32x32x16_bf16 v[8:23], a[36:39], v[44:47], v[8:23]
	ds_read_b128 v[68:71], v1 offset:15360
	buffer_load_dwordx4 v0, s[4:7], s30 offen offset:2048 sc1 lds
	s_waitcnt lgkmcnt(5)
	v_mfma_f32_32x32x16_bf16 v[8:23], a[40:43], v[48:51], v[8:23]
	ds_read_b128 v[40:43], v1 offset:16384
	s_waitcnt lgkmcnt(5)
	v_mfma_f32_32x32x16_bf16 v[8:23], a[44:47], v[52:55], v[8:23]
	ds_read_b128 v[44:47], v1 offset:17408
	buffer_load_dwordx4 v0, s[4:7], s30 offen offset:3072 sc1 lds
	s_waitcnt lgkmcnt(5)
	v_mfma_f32_32x32x16_bf16 v[8:23], a[48:51], v[56:59], v[8:23]
	ds_read_b128 v[48:51], v1 offset:18432
	s_waitcnt lgkmcnt(5)
	v_mfma_f32_32x32x16_bf16 v[8:23], a[52:55], v[60:63], v[8:23]
	ds_read_b128 v[52:55], v1 offset:19456
	s_add_u32 m0, s35, 4096
	s_add_u32 s36, s30, 4096
	s_waitcnt lgkmcnt(5)
	v_mfma_f32_32x32x16_bf16 v[8:23], a[56:59], v[64:67], v[8:23]
	ds_read_b128 v[56:59], v1 offset:20480
	buffer_load_dwordx4 v0, s[4:7], s36 offen offset:0 sc1 lds
	s_waitcnt lgkmcnt(5)
	v_mfma_f32_32x32x16_bf16 v[8:23], a[60:63], v[68:71], v[8:23]
	ds_read_b128 v[60:63], v1 offset:21504
	s_waitcnt lgkmcnt(5)
	v_mfma_f32_32x32x16_bf16 v[8:23], a[64:67], v[40:43], v[8:23]
	ds_read_b128 v[64:67], v1 offset:22528
	buffer_load_dwordx4 v0, s[4:7], s36 offen offset:1024 sc1 lds
	s_waitcnt lgkmcnt(5)
	v_mfma_f32_32x32x16_bf16 v[8:23], a[68:71], v[44:47], v[8:23]
	ds_read_b128 v[68:71], v1 offset:23552
	s_waitcnt lgkmcnt(5)
	v_mfma_f32_32x32x16_bf16 v[8:23], a[72:75], v[48:51], v[8:23]
	ds_read_b128 v[40:43], v1 offset:24576
	buffer_load_dwordx4 v0, s[4:7], s36 offen offset:2048 sc1 lds
	s_waitcnt lgkmcnt(5)
	v_mfma_f32_32x32x16_bf16 v[8:23], a[76:79], v[52:55], v[8:23]
	ds_read_b128 v[44:47], v1 offset:25600
	s_waitcnt lgkmcnt(5)
	v_mfma_f32_32x32x16_bf16 v[8:23], a[80:83], v[56:59], v[8:23]
	ds_read_b128 v[48:51], v1 offset:26624
	buffer_load_dwordx4 v0, s[4:7], s36 offen offset:3072 sc1 lds
	s_waitcnt lgkmcnt(5)
	v_mfma_f32_32x32x16_bf16 v[8:23], a[84:87], v[60:63], v[8:23]
	ds_read_b128 v[52:55], v1 offset:27648
	s_waitcnt lgkmcnt(5)
	v_mfma_f32_32x32x16_bf16 v[8:23], a[88:91], v[64:67], v[8:23]
	ds_read_b128 v[56:59], v1 offset:28672
	s_add_u32 m0, s35, 8192
	s_add_u32 s36, s30, 8192
	s_waitcnt lgkmcnt(5)
	v_mfma_f32_32x32x16_bf16 v[8:23], a[92:95], v[68:71], v[8:23]
	ds_read_b128 v[60:63], v1 offset:29696
	buffer_load_dwordx4 v0, s[4:7], s36 offen offset:0 sc1 lds
	s_waitcnt lgkmcnt(5)
	v_mfma_f32_32x32x16_bf16 v[8:23], a[96:99], v[40:43], v[8:23]
	ds_read_b128 v[64:67], v1 offset:30720
	s_waitcnt lgkmcnt(5)
	v_mfma_f32_32x32x16_bf16 v[8:23], a[100:103], v[44:47], v[8:23]
	ds_read_b128 v[68:71], v1 offset:31744
	s_waitcnt lgkmcnt(5)
	v_mfma_f32_32x32x16_bf16 v[8:23], a[104:107], v[48:51], v[8:23]
	ds_read_b128 v[40:43], v1 offset:32768
	s_waitcnt lgkmcnt(5)
	v_mfma_f32_32x32x16_bf16 v[8:23], a[108:111], v[52:55], v[8:23]
	ds_read_b128 v[44:47], v1 offset:33792
	s_waitcnt lgkmcnt(5)
	v_mfma_f32_32x32x16_bf16 v[8:23], a[112:115], v[56:59], v[8:23]
	ds_read_b128 v[48:51], v1 offset:34816
	s_waitcnt lgkmcnt(5)
	v_mfma_f32_32x32x16_bf16 v[8:23], a[116:119], v[60:63], v[8:23]
	ds_read_b128 v[52:55], v1 offset:35840
	s_waitcnt lgkmcnt(5)
	v_mfma_f32_32x32x16_bf16 v[8:23], a[120:123], v[64:67], v[8:23]
	s_waitcnt lgkmcnt(4)
	v_mfma_f32_32x32x16_bf16 v[8:23], a[124:127], v[68:71], v[8:23]
	s_waitcnt lgkmcnt(3)
	v_mfma_f32_32x32x16_bf16 v[8:23], a[128:131], v[40:43], v[8:23]
	s_waitcnt lgkmcnt(2)
	v_mfma_f32_32x32x16_bf16 v[8:23], a[132:135], v[44:47], v[8:23]
	s_waitcnt lgkmcnt(1)
	v_mfma_f32_32x32x16_bf16 v[8:23], a[136:139], v[48:51], v[8:23]
	s_waitcnt lgkmcnt(0)
	v_mfma_f32_32x32x16_bf16 v[8:23], a[140:143], v[52:55], v[8:23]
	v_xor_b32 v1, v2, v1
	v_add_u32 v3, s47, v1
	s_nop 9
	v_cvt_pk_bf16_f32 v72, v8, v9
	v_cvt_pk_bf16_f32 v73, v10, v11
	v_cvt_pk_bf16_f32 v74, v12, v13
	v_cvt_pk_bf16_f32 v75, v14, v15
	v_cvt_pk_bf16_f32 v76, v16, v17
	v_cvt_pk_bf16_f32 v77, v18, v19
	v_cvt_pk_bf16_f32 v78, v20, v21
	v_cvt_pk_bf16_f32 v79, v22, v23
	buffer_store_dwordx4 v[72:75], v0, s[4:7], s31 offen offset:0 sc1
	buffer_store_dwordx4 v[76:79], v0, s[4:7], s31 offen offset:1024 sc1
	s_add_u32 s31, s31, 294912
	s_add_u32 s28, s28, 1
	s_cmp_lt_u32 s28, 64
	s_cbranch_scc1 dn_loop
	s_branch all_exit
ln_entry:
	v_add_u32 v8, 13312, v0
	global_load_dwordx4 v[100:103], v8, s[64:65]
	global_load_dwordx4 v[104:107], v8, s[64:65] offset:1024
	s_cmp_lg_u32 s41, 0
	s_cbranch_scc1 ln_go
	v_mov_b64 v[8:9], 0
	v_mov_b64 v[10:11], 0
	s_mul_i32 s36, s26, 10240
	s_add_u32 s36, s36, 0x3300000
	buffer_store_dwordx4 v[8:11], v0, s[4:7], s36 offen offset:0 sc1
	buffer_store_dwordx4 v[8:11], v0, s[4:7], s36 offen offset:1024 sc1
	buffer_store_dwordx4 v[8:11], v0, s[4:7], s36 offen offset:2048 sc1
	buffer_store_dwordx4 v[8:11], v0, s[4:7], s36 offen offset:3072 sc1
	s_add_u32 s36, s36, 4096
	buffer_store_dwordx4 v[8:11], v0, s[4:7], s36 offen offset:0 sc1
	buffer_store_dwordx4 v[8:11], v0, s[4:7], s36 offen offset:1024 sc1
	buffer_store_dwordx4 v[8:11], v0, s[4:7], s36 offen offset:2048 sc1
	buffer_store_dwordx4 v[8:11], v0, s[4:7], s36 offen offset:3072 sc1
	s_add_u32 s36, s36, 4096
	buffer_store_dwordx4 v[8:11], v0, s[4:7], s36 offen offset:0 sc1
	buffer_store_dwordx4 v[8:11], v0, s[4:7], s36 offen offset:1024 sc1
	s_waitcnt vmcnt(0)
	s_barrier
	v_mov_b32 v9, 1
	s_mov_b64 exec, 1
	global_store_dword v8, v9, s[24:25] offset:8 sc1
	s_mov_b64 exec, -1
ln_go:
	s_waitcnt vmcnt(0)
ln_loop:
	s_lshl_b32 s36, s41, 2
	s_add_u32 s36, s36, s26
	s_mul_i32 s36, s36, 9216
	buffer_load_dwordx4 v[8:11], v102, s[16:19], s36 offen offset:0
	buffer_load_dwordx4 v[12:15], v102, s[16:19], s36 offen offset:128
	buffer_load_dwordx4 v[16:19], v102, s[16:19], s36 offen offset:256
	buffer_load_dwordx4 v[20:23], v102, s[16:19], s36 offen offset:384
	buffer_load_dwordx4 v[24:27], v102, s[16:19], s36 offen offset:512
	buffer_load_dwordx4 v[28:31], v102, s[16:19], s36 offen offset:640
	buffer_load_dwordx4 v[32:35], v102, s[16:19], s36 offen offset:768
	buffer_load_dwordx4 v[36:39], v102, s[16:19], s36 offen offset:896
	buffer_load_dwordx4 v[40:43], v102, s[16:19], s36 offen offset:1024
	s_waitcnt vmcnt(8)
	v_lshlrev_b32 v112, 16, v8
	v_and_b32 v113, 0xffff0000, v8
	v_lshlrev_b32 v114, 16, v9
	v_and_b32 v115, 0xffff0000, v9
	v_lshlrev_b32 v116, 16, v10
	v_and_b32 v117, 0xffff0000, v10
	v_lshlrev_b32 v118, 16, v11
	v_and_b32 v119, 0xffff0000, v11
	s_waitcnt vmcnt(7)
	v_lshlrev_b32 v120, 16, v12
	v_and_b32 v121, 0xffff0000, v12
	v_lshlrev_b32 v122, 16, v13
	v_and_b32 v123, 0xffff0000, v13
	v_lshlrev_b32 v124, 16, v14
	v_and_b32 v125, 0xffff0000, v14
	v_lshlrev_b32 v126, 16, v15
	v_and_b32 v127, 0xffff0000, v15
	s_waitcnt vmcnt(6)
	v_lshlrev_b32 v128, 16, v16
	v_and_b32 v129, 0xffff0000, v16
	v_lshlrev_b32 v130, 16, v17
	v_and_b32 v131, 0xffff0000, v17
	v_lshlrev_b32 v132, 16, v18
	v_and_b32 v133, 0xffff0000, v18
	v_lshlrev_b32 v134, 16, v19
	v_and_b32 v135, 0xffff0000, v19
	s_waitcnt vmcnt(5)
	v_lshlrev_b32 v136, 16, v20
	v_and_b32 v137, 0xffff0000, v20
	v_lshlrev_b32 v138, 16, v21
	v_and_b32 v139, 0xffff0000, v21
	v_lshlrev_b32 v140, 16, v22
	v_and_b32 v141, 0xffff0000, v22
	v_lshlrev_b32 v142, 16, v23
	v_and_b32 v143, 0xffff0000, v23
	s_waitcnt vmcnt(4)
	v_lshlrev_b32 v144, 16, v24
	v_and_b32 v145, 0xffff0000, v24
	v_lshlrev_b32 v146, 16, v25
	v_and_b32 v147, 0xffff0000, v25
	v_lshlrev_b32 v148, 16, v26
	v_and_b32 v149, 0xffff0000, v26
	v_lshlrev_b32 v150, 16, v27
	v_and_b32 v151, 0xffff0000, v27
	s_waitcnt vmcnt(3)
	v_lshlrev_b32 v152, 16, v28
	v_and_b32 v153, 0xffff0000, v28
	v_lshlrev_b32 v154, 16, v29
	v_and_b32 v155, 0xffff0000, v29
	v_lshlrev_b32 v156, 16, v30
	v_and_b32 v157, 0xffff0000, v30
	v_lshlrev_b32 v158, 16, v31
	v_and_b32 v159, 0xffff0000, v31
	s_waitcnt vmcnt(2)
	v_lshlrev_b32 v160, 16, v32
	v_and_b32 v161, 0xffff0000, v32
	v_lshlrev_b32 v162, 16, v33
	v_and_b32 v163, 0xffff0000, v33
	v_lshlrev_b32 v164, 16, v34
	v_and_b32 v165, 0xffff0000, v34
	v_lshlrev_b32 v166, 16, v35
	v_and_b32 v167, 0xffff0000, v35
	s_waitcnt vmcnt(1)
	v_lshlrev_b32 v168, 16, v36
	v_and_b32 v169, 0xffff0000, v36
	v_lshlrev_b32 v170, 16, v37
	v_and_b32 v171, 0xffff0000, v37
	v_lshlrev_b32 v172, 16, v38
	v_and_b32 v173, 0xffff0000, v38
	v_lshlrev_b32 v174, 16, v39
	v_and_b32 v175, 0xffff0000, v39
	s_waitcnt vmcnt(0)
	v_lshlrev_b32 v176, 16, v40
	v_and_b32 v177, 0xffff0000, v40
	v_lshlrev_b32 v178, 16, v41
	v_and_b32 v179, 0xffff0000, v41
	v_lshlrev_b32 v180, 16, v42
	v_and_b32 v181, 0xffff0000, v42
	v_lshlrev_b32 v182, 16, v43
	v_and_b32 v183, 0xffff0000, v43
	v_add_f32 v44, v112, v116
	v_add_f32 v45, v113, v117
	v_add_f32 v46, v114, v118
	v_add_f32 v47, v115, v119
	v_add_f32 v44, v44, v120
	v_add_f32 v45, v45, v121
	v_add_f32 v46, v46, v122
	v_add_f32 v47, v47, v123
	v_add_f32 v44, v44, v124
	v_add_f32 v45, v45, v125
	v_add_f32 v46, v46, v126
	v_add_f32 v47, v47, v127
	v_add_f32 v44, v44, v128
	v_add_f32 v45, v45, v129
	v_add_f32 v46, v46, v130
	v_add_f32 v47, v47, v131
	v_add_f32 v44, v44, v132
	v_add_f32 v45, v45, v133
	v_add_f32 v46, v46, v134
	v_add_f32 v47, v47, v135
	v_add_f32 v44, v44, v136
	v_add_f32 v45, v45, v137
	v_add_f32 v46, v46, v138
	v_add_f32 v47, v47, v139
	v_add_f32 v44, v44, v140
	v_add_f32 v45, v45, v141
	v_add_f32 v46, v46, v142
	v_add_f32 v47, v47, v143
	v_add_f32 v44, v44, v144
	v_add_f32 v45, v45, v145
	v_add_f32 v46, v46, v146
	v_add_f32 v47, v47, v147
	v_add_f32 v44, v44, v148
	v_add_f32 v45, v45, v149
	v_add_f32 v46, v46, v150
	v_add_f32 v47, v47, v151
	v_add_f32 v44, v44, v152
	v_add_f32 v45, v45, v153
	v_add_f32 v46, v46, v154
	v_add_f32 v47, v47, v155
	v_add_f32 v44, v44, v156
	v_add_f32 v45, v45, v157
	v_add_f32 v46, v46, v158
	v_add_f32 v47, v47, v159
	v_add_f32 v44, v44, v160
	v_add_f32 v45, v45, v161
	v_add_f32 v46, v46, v162
	v_add_f32 v47, v47, v163
	v_add_f32 v44, v44, v164
	v_add_f32 v45, v45, v165
	v_add_f32 v46, v46, v166
	v_add_f32 v47, v47, v167
	v_add_f32 v44, v44, v168
	v_add_f32 v45, v45, v169
	v_add_f32 v46, v46, v170
	v_add_f32 v47, v47, v171
	v_add_f32 v44, v44, v172
	v_add_f32 v45, v45, v173
	v_add_f32 v46, v46, v174
	v_add_f32 v47, v47, v175
	v_add_f32 v44, v44, v176
	v_add_f32 v45, v45, v177
	v_add_f32 v46, v46, v178
	v_add_f32 v47, v47, v179
	v_add_f32 v44, v44, v180
	v_add_f32 v45, v45, v181
	v_add_f32 v46, v46, v182
	v_add_f32 v47, v47, v183
	v_add_f32 v44, v44, v45
	v_add_f32 v46, v46, v47
	v_add_f32 v44, v44, v46
	s_nop 1
	v_add_f32_dpp v45, v44, v44 quad_perm:[1,0,3,2] row_mask:0xf bank_mask:0xf
	s_nop 1
	v_add_f32_dpp v44, v45, v45 quad_perm:[2,3,0,1] row_mask:0xf bank_mask:0xf
	s_nop 1
	v_add_f32_dpp v45, v44, v44 row_half_mirror row_mask:0xf bank_mask:0xf
	v_mul_f32 v48, 0x3ae38e39, v45
	v_sub_f32 v184, v112, v48
	v_sub_f32 v185, v113, v48
	v_sub_f32 v186, v114, v48
	v_sub_f32 v187, v115, v48
	v_sub_f32 v188, v116, v48
	v_sub_f32 v189, v117, v48
	v_sub_f32 v190, v118, v48
	v_sub_f32 v191, v119, v48
	v_sub_f32 v192, v120, v48
	v_sub_f32 v193, v121, v48
	v_sub_f32 v194, v122, v48
	v_sub_f32 v195, v123, v48
	v_sub_f32 v196, v124, v48
	v_sub_f32 v197, v125, v48
	v_sub_f32 v198, v126, v48
	v_sub_f32 v199, v127, v48
	v_sub_f32 v200, v128, v48
	v_sub_f32 v201, v129, v48
	v_sub_f32 v202, v130, v48
	v_sub_f32 v203, v131, v48
	v_sub_f32 v204, v132, v48
	v_sub_f32 v205, v133, v48
	v_sub_f32 v206, v134, v48
	v_sub_f32 v207, v135, v48
	v_sub_f32 v208, v136, v48
	v_sub_f32 v209, v137, v48
	v_sub_f32 v210, v138, v48
	v_sub_f32 v211, v139, v48
	v_sub_f32 v212, v140, v48
	v_sub_f32 v213, v141, v48
	v_sub_f32 v214, v142, v48
	v_sub_f32 v215, v143, v48
	v_sub_f32 v216, v144, v48
	v_sub_f32 v217, v145, v48
	v_sub_f32 v218, v146, v48
	v_sub_f32 v219, v147, v48
	v_sub_f32 v220, v148, v48
	v_sub_f32 v221, v149, v48
	v_sub_f32 v222, v150, v48
	v_sub_f32 v223, v151, v48
	v_sub_f32 v224, v152, v48
	v_sub_f32 v225, v153, v48
	v_sub_f32 v226, v154, v48
	v_sub_f32 v227, v155, v48
	v_sub_f32 v228, v156, v48
	v_sub_f32 v229, v157, v48
	v_sub_f32 v230, v158, v48
	v_sub_f32 v231, v159, v48
	v_sub_f32 v232, v160, v48
	v_sub_f32 v233, v161, v48
	v_sub_f32 v234, v162, v48
	v_sub_f32 v235, v163, v48
	v_sub_f32 v236, v164, v48
	v_sub_f32 v237, v165, v48
	v_sub_f32 v238, v166, v48
	v_sub_f32 v239, v167, v48
	v_sub_f32 v240, v168, v48
	v_sub_f32 v241, v169, v48
	v_sub_f32 v242, v170, v48
	v_sub_f32 v243, v171, v48
	v_sub_f32 v244, v172, v48
	v_sub_f32 v245, v173, v48
	v_sub_f32 v246, v174, v48
	v_sub_f32 v247, v175, v48
	v_sub_f32 v248, v176, v48
	v_sub_f32 v249, v177, v48
	v_sub_f32 v250, v178, v48
	v_sub_f32 v251, v179, v48
	v_sub_f32 v252, v180, v48
	v_sub_f32 v253, v181, v48
	v_sub_f32 v254, v182, v48
	v_sub_f32 v255, v183, v48
	v_mul_f32 v44, v184, v184
	v_mul_f32 v45, v185, v185
	v_mul_f32 v46, v186, v186
	v_mul_f32 v47, v187, v187
	v_fmac_f32 v44, v188, v188
	v_fmac_f32 v45, v189, v189
	v_fmac_f32 v46, v190, v190
	v_fmac_f32 v47, v191, v191
	v_fmac_f32 v44, v192, v192
	v_fmac_f32 v45, v193, v193
	v_fmac_f32 v46, v194, v194
	v_fmac_f32 v47, v195, v195
	v_fmac_f32 v44, v196, v196
	v_fmac_f32 v45, v197, v197
	v_fmac_f32 v46, v198, v198
	v_fmac_f32 v47, v199, v199
	v_fmac_f32 v44, v200, v200
	v_fmac_f32 v45, v201, v201
	v_fmac_f32 v46, v202, v202
	v_fmac_f32 v47, v203, v203
	v_fmac_f32 v44, v204, v204
	v_fmac_f32 v45, v205, v205
	v_fmac_f32 v46, v206, v206
	v_fmac_f32 v47, v207, v207
	v_fmac_f32 v44, v208, v208
	v_fmac_f32 v45, v209, v209
	v_fmac_f32 v46, v210, v210
	v_fmac_f32 v47, v211, v211
	v_fmac_f32 v44, v212, v212
	v_fmac_f32 v45, v213, v213
	v_fmac_f32 v46, v214, v214
	v_fmac_f32 v47, v215, v215
	v_fmac_f32 v44, v216, v216
	v_fmac_f32 v45, v217, v217
	v_fmac_f32 v46, v218, v218
	v_fmac_f32 v47, v219, v219
	v_fmac_f32 v44, v220, v220
	v_fmac_f32 v45, v221, v221
	v_fmac_f32 v46, v222, v222
	v_fmac_f32 v47, v223, v223
	v_fmac_f32 v44, v224, v224
	v_fmac_f32 v45, v225, v225
	v_fmac_f32 v46, v226, v226
	v_fmac_f32 v47, v227, v227
	v_fmac_f32 v44, v228, v228
	v_fmac_f32 v45, v229, v229
	v_fmac_f32 v46, v230, v230
	v_fmac_f32 v47, v231, v231
	v_fmac_f32 v44, v232, v232
	v_fmac_f32 v45, v233, v233
	v_fmac_f32 v46, v234, v234
	v_fmac_f32 v47, v235, v235
	v_fmac_f32 v44, v236, v236
	v_fmac_f32 v45, v237, v237
	v_fmac_f32 v46, v238, v238
	v_fmac_f32 v47, v239, v239
	v_fmac_f32 v44, v240, v240
	v_fmac_f32 v45, v241, v241
	v_fmac_f32 v46, v242, v242
	v_fmac_f32 v47, v243, v243
	v_fmac_f32 v44, v244, v244
	v_fmac_f32 v45, v245, v245
	v_fmac_f32 v46, v246, v246
	v_fmac_f32 v47, v247, v247
	v_fmac_f32 v44, v248, v248
	v_fmac_f32 v45, v249, v249
	v_fmac_f32 v46, v250, v250
	v_fmac_f32 v47, v251, v251
	v_fmac_f32 v44, v252, v252
	v_fmac_f32 v45, v253, v253
	v_fmac_f32 v46, v254, v254
	v_fmac_f32 v47, v255, v255
	v_add_f32 v44, v44, v45
	v_add_f32 v46, v46, v47
	v_add_f32 v44, v44, v46
	s_nop 1
	v_add_f32_dpp v45, v44, v44 quad_perm:[1,0,3,2] row_mask:0xf bank_mask:0xf
	s_nop 1
	v_add_f32_dpp v44, v45, v45 quad_perm:[2,3,0,1] row_mask:0xf bank_mask:0xf
	s_nop 1
	v_add_f32_dpp v45, v44, v44 row_half_mirror row_mask:0xf bank_mask:0xf
	v_mul_f32 v49, 0x3ae38e39, v45
	v_cvt_pk_bf16_f32 v48, v48, v48
	v_lshlrev_b32 v48, 16, v48
	v_cvt_pk_bf16_f32 v49, v49, v49
	v_lshlrev_b32 v49, 16, v49
	v_add_f32 v49, 0x3727c5ac, v49
	v_cvt_pk_bf16_f32 v49, v49, v49
	v_lshlrev_b32 v49, 16, v49
	v_sqrt_f32 v49, v49
	s_nop 0
	v_cvt_pk_bf16_f32 v49, v49, v49
	v_lshlrev_b32 v49, 16, v49
	v_rcp_f32 v49, v49
	v_sub_f32 v112, v112, v48
	v_sub_f32 v113, v113, v48
	v_sub_f32 v114, v114, v48
	v_sub_f32 v115, v115, v48
	v_sub_f32 v116, v116, v48
	v_sub_f32 v117, v117, v48
	v_sub_f32 v118, v118, v48
	v_sub_f32 v119, v119, v48
	v_sub_f32 v120, v120, v48
	v_sub_f32 v121, v121, v48
	v_sub_f32 v122, v122, v48
	v_sub_f32 v123, v123, v48
	v_sub_f32 v124, v124, v48
	v_sub_f32 v125, v125, v48
	v_sub_f32 v126, v126, v48
	v_sub_f32 v127, v127, v48
	v_sub_f32 v128, v128, v48
	v_sub_f32 v129, v129, v48
	v_sub_f32 v130, v130, v48
	v_sub_f32 v131, v131, v48
	v_sub_f32 v132, v132, v48
	v_sub_f32 v133, v133, v48
	v_sub_f32 v134, v134, v48
	v_sub_f32 v135, v135, v48
	v_sub_f32 v136, v136, v48
	v_sub_f32 v137, v137, v48
	v_sub_f32 v138, v138, v48
	v_sub_f32 v139, v139, v48
	v_sub_f32 v140, v140, v48
	v_sub_f32 v141, v141, v48
	v_sub_f32 v142, v142, v48
	v_sub_f32 v143, v143, v48
	v_sub_f32 v144, v144, v48
	v_sub_f32 v145, v145, v48
	v_sub_f32 v146, v146, v48
	v_sub_f32 v147, v147, v48
	v_sub_f32 v148, v148, v48
	v_sub_f32 v149, v149, v48
	v_sub_f32 v150, v150, v48
	v_sub_f32 v151, v151, v48
	v_sub_f32 v152, v152, v48
	v_sub_f32 v153, v153, v48
	v_sub_f32 v154, v154, v48
	v_sub_f32 v155, v155, v48
	v_sub_f32 v156, v156, v48
	v_sub_f32 v157, v157, v48
	v_sub_f32 v158, v158, v48
	v_sub_f32 v159, v159, v48
	v_sub_f32 v160, v160, v48
	v_sub_f32 v161, v161, v48
	v_sub_f32 v162, v162, v48
	v_sub_f32 v163, v163, v48
	v_sub_f32 v164, v164, v48
	v_sub_f32 v165, v165, v48
	v_sub_f32 v166, v166, v48
	v_sub_f32 v167, v167, v48
	v_sub_f32 v168, v168, v48
	v_sub_f32 v169, v169, v48
	v_sub_f32 v170, v170, v48
	v_sub_f32 v171, v171, v48
	v_sub_f32 v172, v172, v48
	v_sub_f32 v173, v173, v48
	v_sub_f32 v174, v174, v48
	v_sub_f32 v175, v175, v48
	v_sub_f32 v176, v176, v48
	v_sub_f32 v177, v177, v48
	v_sub_f32 v178, v178, v48
	v_sub_f32 v179, v179, v48
	v_sub_f32 v180, v180, v48
	v_sub_f32 v181, v181, v48
	v_sub_f32 v182, v182, v48
	v_sub_f32 v183, v183, v48
	v_cvt_pk_bf16_f32 v8, v112, v113
	v_cvt_pk_bf16_f32 v9, v114, v115
	v_cvt_pk_bf16_f32 v10, v116, v117
	v_cvt_pk_bf16_f32 v11, v118, v119
	v_cvt_pk_bf16_f32 v12, v120, v121
	v_cvt_pk_bf16_f32 v13, v122, v123
	v_cvt_pk_bf16_f32 v14, v124, v125
	v_cvt_pk_bf16_f32 v15, v126, v127
	v_cvt_pk_bf16_f32 v16, v128, v129
	v_cvt_pk_bf16_f32 v17, v130, v131
	v_cvt_pk_bf16_f32 v18, v132, v133
	v_cvt_pk_bf16_f32 v19, v134, v135
	v_cvt_pk_bf16_f32 v20, v136, v137
	v_cvt_pk_bf16_f32 v21, v138, v139
	v_cvt_pk_bf16_f32 v22, v140, v141
	v_cvt_pk_bf16_f32 v23, v142, v143
	v_cvt_pk_bf16_f32 v24, v144, v145
	v_cvt_pk_bf16_f32 v25, v146, v147
	v_cvt_pk_bf16_f32 v26, v148, v149
	v_cvt_pk_bf16_f32 v27, v150, v151
	v_cvt_pk_bf16_f32 v28, v152, v153
	v_cvt_pk_bf16_f32 v29, v154, v155
	v_cvt_pk_bf16_f32 v30, v156, v157
	v_cvt_pk_bf16_f32 v31, v158, v159
	v_cvt_pk_bf16_f32 v32, v160, v161
	v_cvt_pk_bf16_f32 v33, v162, v163
	v_cvt_pk_bf16_f32 v34, v164, v165
	v_cvt_pk_bf16_f32 v35, v166, v167
	v_cvt_pk_bf16_f32 v36, v168, v169
	v_cvt_pk_bf16_f32 v37, v170, v171
	v_cvt_pk_bf16_f32 v38, v172, v173
	v_cvt_pk_bf16_f32 v39, v174, v175
	v_cvt_pk_bf16_f32 v40, v176, v177
	v_cvt_pk_bf16_f32 v41, v178, v179
	v_cvt_pk_bf16_f32 v42, v180, v181
	v_cvt_pk_bf16_f32 v43, v182, v183
	v_lshlrev_b32 v112, 16, v8
	v_and_b32 v113, 0xffff0000, v8
	v_lshlrev_b32 v114, 16, v9
	v_and_b32 v115, 0xffff0000, v9
	v_lshlrev_b32 v116, 16, v10
	v_and_b32 v117, 0xffff0000, v10
	v_lshlrev_b32 v118, 16, v11
	v_and_b32 v119, 0xffff0000, v11
	v_lshlrev_b32 v120, 16, v12
	v_and_b32 v121, 0xffff0000, v12
	v_lshlrev_b32 v122, 16, v13
	v_and_b32 v123, 0xffff0000, v13
	v_lshlrev_b32 v124, 16, v14
	v_and_b32 v125, 0xffff0000, v14
	v_lshlrev_b32 v126, 16, v15
	v_and_b32 v127, 0xffff0000, v15
	v_lshlrev_b32 v128, 16, v16
	v_and_b32 v129, 0xffff0000, v16
	v_lshlrev_b32 v130, 16, v17
	v_and_b32 v131, 0xffff0000, v17
	v_lshlrev_b32 v132, 16, v18
	v_and_b32 v133, 0xffff0000, v18
	v_lshlrev_b32 v134, 16, v19
	v_and_b32 v135, 0xffff0000, v19
	v_lshlrev_b32 v136, 16, v20
	v_and_b32 v137, 0xffff0000, v20
	v_lshlrev_b32 v138, 16, v21
	v_and_b32 v139, 0xffff0000, v21
	v_lshlrev_b32 v140, 16, v22
	v_and_b32 v141, 0xffff0000, v22
	v_lshlrev_b32 v142, 16, v23
	v_and_b32 v143, 0xffff0000, v23
	v_lshlrev_b32 v144, 16, v24
	v_and_b32 v145, 0xffff0000, v24
	v_lshlrev_b32 v146, 16, v25
	v_and_b32 v147, 0xffff0000, v25
	v_lshlrev_b32 v148, 16, v26
	v_and_b32 v149, 0xffff0000, v26
	v_lshlrev_b32 v150, 16, v27
	v_and_b32 v151, 0xffff0000, v27
	v_lshlrev_b32 v152, 16, v28
	v_and_b32 v153, 0xffff0000, v28
	v_lshlrev_b32 v154, 16, v29
	v_and_b32 v155, 0xffff0000, v29
	v_lshlrev_b32 v156, 16, v30
	v_and_b32 v157, 0xffff0000, v30
	v_lshlrev_b32 v158, 16, v31
	v_and_b32 v159, 0xffff0000, v31
	v_lshlrev_b32 v160, 16, v32
	v_and_b32 v161, 0xffff0000, v32
	v_lshlrev_b32 v162, 16, v33
	v_and_b32 v163, 0xffff0000, v33
	v_lshlrev_b32 v164, 16, v34
	v_and_b32 v165, 0xffff0000, v34
	v_lshlrev_b32 v166, 16, v35
	v_and_b32 v167, 0xffff0000, v35
	v_lshlrev_b32 v168, 16, v36
	v_and_b32 v169, 0xffff0000, v36
	v_lshlrev_b32 v170, 16, v37
	v_and_b32 v171, 0xffff0000, v37
	v_lshlrev_b32 v172, 16, v38
	v_and_b32 v173, 0xffff0000, v38
	v_lshlrev_b32 v174, 16, v39
	v_and_b32 v175, 0xffff0000, v39
	v_lshlrev_b32 v176, 16, v40
	v_and_b32 v177, 0xffff0000, v40
	v_lshlrev_b32 v178, 16, v41
	v_and_b32 v179, 0xffff0000, v41
	v_lshlrev_b32 v180, 16, v42
	v_and_b32 v181, 0xffff0000, v42
	v_lshlrev_b32 v182, 16, v43
	v_and_b32 v183, 0xffff0000, v43
	v_mul_f32 v112, v112, v49
	v_mul_f32 v113, v113, v49
	v_mul_f32 v114, v114, v49
	v_mul_f32 v115, v115, v49
	v_mul_f32 v116, v116, v49
	v_mul_f32 v117, v117, v49
	v_mul_f32 v118, v118, v49
	v_mul_f32 v119, v119, v49
	v_mul_f32 v120, v120, v49
	v_mul_f32 v121, v121, v49
	v_mul_f32 v122, v122, v49
	v_mul_f32 v123, v123, v49
	v_mul_f32 v124, v124, v49
	v_mul_f32 v125, v125, v49
	v_mul_f32 v126, v126, v49
	v_mul_f32 v127, v127, v49
	v_mul_f32 v128, v128, v49
	v_mul_f32 v129, v129, v49
	v_mul_f32 v130, v130, v49
	v_mul_f32 v131, v131, v49
	v_mul_f32 v132, v132, v49
	v_mul_f32 v133, v133, v49
	v_mul_f32 v134, v134, v49
	v_mul_f32 v135, v135, v49
	v_mul_f32 v136, v136, v49
	v_mul_f32 v137, v137, v49
	v_mul_f32 v138, v138, v49
	v_mul_f32 v139, v139, v49
	v_mul_f32 v140, v140, v49
	v_mul_f32 v141, v141, v49
	v_mul_f32 v142, v142, v49
	v_mul_f32 v143, v143, v49
	v_mul_f32 v144, v144, v49
	v_mul_f32 v145, v145, v49
	v_mul_f32 v146, v146, v49
	v_mul_f32 v147, v147, v49
	v_mul_f32 v148, v148, v49
	v_mul_f32 v149, v149, v49
	v_mul_f32 v150, v150, v49
	v_mul_f32 v151, v151, v49
	v_mul_f32 v152, v152, v49
	v_mul_f32 v153, v153, v49
	v_mul_f32 v154, v154, v49
	v_mul_f32 v155, v155, v49
	v_mul_f32 v156, v156, v49
	v_mul_f32 v157, v157, v49
	v_mul_f32 v158, v158, v49
	v_mul_f32 v159, v159, v49
	v_mul_f32 v160, v160, v49
	v_mul_f32 v161, v161, v49
	v_mul_f32 v162, v162, v49
	v_mul_f32 v163, v163, v49
	v_mul_f32 v164, v164, v49
	v_mul_f32 v165, v165, v49
	v_mul_f32 v166, v166, v49
	v_mul_f32 v167, v167, v49
	v_mul_f32 v168, v168, v49
	v_mul_f32 v169, v169, v49
	v_mul_f32 v170, v170, v49
	v_mul_f32 v171, v171, v49
	v_mul_f32 v172, v172, v49
	v_mul_f32 v173, v173, v49
	v_mul_f32 v174, v174, v49
	v_mul_f32 v175, v175, v49
	v_mul_f32 v176, v176, v49
	v_mul_f32 v177, v177, v49
	v_mul_f32 v178, v178, v49
	v_mul_f32 v179, v179, v49
	v_mul_f32 v180, v180, v49
	v_mul_f32 v181, v181, v49
	v_mul_f32 v182, v182, v49
	v_mul_f32 v183, v183, v49
	v_cvt_pk_bf16_f32 v8, v112, v113
	v_cvt_pk_bf16_f32 v9, v114, v115
	v_cvt_pk_bf16_f32 v10, v116, v117
	v_cvt_pk_bf16_f32 v11, v118, v119
	v_cvt_pk_bf16_f32 v12, v120, v121
	v_cvt_pk_bf16_f32 v13, v122, v123
	v_cvt_pk_bf16_f32 v14, v124, v125
	v_cvt_pk_bf16_f32 v15, v126, v127
	v_cvt_pk_bf16_f32 v16, v128, v129
	v_cvt_pk_bf16_f32 v17, v130, v131
	v_cvt_pk_bf16_f32 v18, v132, v133
	v_cvt_pk_bf16_f32 v19, v134, v135
	v_cvt_pk_bf16_f32 v20, v136, v137
	v_cvt_pk_bf16_f32 v21, v138, v139
	v_cvt_pk_bf16_f32 v22, v140, v141
	v_cvt_pk_bf16_f32 v23, v142, v143
	v_cvt_pk_bf16_f32 v24, v144, v145
	v_cvt_pk_bf16_f32 v25, v146, v147
	v_cvt_pk_bf16_f32 v26, v148, v149
	v_cvt_pk_bf16_f32 v27, v150, v151
	v_cvt_pk_bf16_f32 v28, v152, v153
	v_cvt_pk_bf16_f32 v29, v154, v155
	v_cvt_pk_bf16_f32 v30, v156, v157
	v_cvt_pk_bf16_f32 v31, v158, v159
	v_cvt_pk_bf16_f32 v32, v160, v161
	v_cvt_pk_bf16_f32 v33, v162, v163
	v_cvt_pk_bf16_f32 v34, v164, v165
	v_cvt_pk_bf16_f32 v35, v166, v167
	v_cvt_pk_bf16_f32 v36, v168, v169
	v_cvt_pk_bf16_f32 v37, v170, v171
	v_cvt_pk_bf16_f32 v38, v172, v173
	v_cvt_pk_bf16_f32 v39, v174, v175
	v_cvt_pk_bf16_f32 v40, v176, v177
	v_cvt_pk_bf16_f32 v41, v178, v179
	v_cvt_pk_bf16_f32 v42, v180, v181
	v_cvt_pk_bf16_f32 v43, v182, v183
	s_mul_i32 s36, s41, 36864
	s_lshl_b32 s37, s26, 7
	s_add_u32 s36, s36, s37
	s_add_u32 s36, s36, 0x3400000
	buffer_store_dwordx4 v[8:11], v100, s[4:7], s36 offen offset:0 sc1
	s_add_u32 s36, s36, 4096
	buffer_store_dwordx4 v[12:15], v100, s[4:7], s36 offen offset:0 sc1
	s_add_u32 s36, s36, 4096
	buffer_store_dwordx4 v[16:19], v100, s[4:7], s36 offen offset:0 sc1
	s_add_u32 s36, s36, 4096
	buffer_store_dwordx4 v[20:23], v100, s[4:7], s36 offen offset:0 sc1
	s_add_u32 s36, s36, 4096
	buffer_store_dwordx4 v[24:27], v100, s[4:7], s36 offen offset:0 sc1
	s_add_u32 s36, s36, 4096
	buffer_store_dwordx4 v[28:31], v100, s[4:7], s36 offen offset:0 sc1
	s_add_u32 s36, s36, 4096
	buffer_store_dwordx4 v[32:35], v100, s[4:7], s36 offen offset:0 sc1
	s_add_u32 s36, s36, 4096
	buffer_store_dwordx4 v[36:39], v100, s[4:7], s36 offen offset:0 sc1
	s_add_u32 s36, s36, 4096
	buffer_store_dwordx4 v[40:43], v100, s[4:7], s36 offen offset:0 sc1
	s_add_u32 s36, s36, 4096
	s_waitcnt vmcnt(0)
	v_mov_b32 v8, 0
ln_init:
	global_load_dword v9, v8, s[24:25] offset:8 sc1
	s_sub_u32 s34, s34, 1
	s_cbranch_scc1 all_exit
	s_waitcnt vmcnt(0)
	v_readfirstlane_b32 s36, v9
	s_cmp_eq_u32 s36, 0
	s_cbranch_scc1 ln_init
	s_lshl_b32 s32, s41, 7
	s_lshl_b32 s36, s26, 2
	s_add_u32 s32, s32, s36
	s_add_u32 s32, s32, 0x3300000
	s_add_u32 s36, s41, 1
	v_mov_b32 v98, s36
	s_mov_b64 exec, 1
	buffer_store_dword v98, off, s[4:7], s32 sc1
	s_mov_b64 exec, -1
	s_add_u32 s41, s41, 60
	s_cmp_lt_u32 s41, 64
	s_cbranch_scc1 ln_loop
	s_cmp_eq_u32 s42, 3
	s_cbranch_scc1 at_entry
	s_cmp_eq_u32 s42, 5
	s_cbranch_scc1 r1_entry
	s_cmp_eq_u32 s42, 8
	s_cbranch_scc1 r2_entry
	s_branch all_exit
r1_entry:
	s_cmp_eq_u32 s26, 3
	s_cbranch_scc1 all_exit
	s_mov_b32 s46, 0x3f80
	s_mov_b32 s47, 0x3f800000
	s_mov_b32 s43, 0x3f803f80
	s_mul_i32 s36, s27, 3
	s_add_u32 s36, s36, s26
	s_mul_i32 s48, s36, 57
	s_lshr_b32 s48, s48, 9
	s_mul_i32 s37, s48, 9
	s_sub_u32 s49, s36, s37
	s_lshl_b32 s36, s49, 12
	s_lshl_b32 s37, s48, 7
	s_add_u32 s36, s36, s37
	v_add_u32 v3, s36, v100
	v_add_u32 v105, s36, v105
	s_lshl_b32 s36, s49, 7
	s_mul_i32 s37, s48, 9216
	s_add_u32 s36, s36, s37
	v_add_u32 v6, s36, v101
	s_lshl_b32 s32, s27, 7
	s_lshl_b32 s36, s26, 2
	s_add_u32 s32, s32, s36
	s_add_u32 s32, s32, 0x3305400
	v_mov_b64 v[108:109], -1
	v_mov_b64 v[110:111], -1
	s_lshl_b32 s36, s49, 9
	s_lshl_b32 s37, s48, 7
	s_add_u32 s36, s36, s37
	v_add_u32 v7, s36, v104
	s_mov_b32 s35, 0x3d00000
	s_mov_b32 s76, 0x03030303
	s_mov_b32 s77, 0x03030303
	s_mov_b32 s36, 0x3a00000
	buffer_store_dwordx4 v[108:111], v3, s[4:7], s36 offen offset:0 sc1
	s_mov_b32 s36, 0x3d00000
	buffer_store_dwordx2 v[108:109], v7, s[4:7], s36 offen sc1
	s_mov_b32 s36, 0x3a09000
	buffer_store_dwordx4 v[108:111], v3, s[4:7], s36 offen offset:0 sc1
	s_mov_b32 s36, 0x3d02000
	buffer_store_dwordx2 v[108:109], v7, s[4:7], s36 offen sc1
	s_mov_b32 s36, 0x3a12000
	buffer_store_dwordx4 v[108:111], v3, s[4:7], s36 offen offset:0 sc1
	s_mov_b32 s36, 0x3d04000
	buffer_store_dwordx2 v[108:109], v7, s[4:7], s36 offen sc1
	s_mov_b32 s36, 0x3a1b000
	buffer_store_dwordx4 v[108:111], v3, s[4:7], s36 offen offset:0 sc1
	s_mov_b32 s36, 0x3d06000
	buffer_store_dwordx2 v[108:109], v7, s[4:7], s36 offen sc1
	s_mov_b32 s36, 0x3c13000
	buffer_store_dwordx4 v[108:111], v3, s[4:7], s36 offen offset:0 sc1
	s_mov_b32 s36, 0x3d76000
	buffer_store_dwordx2 v[108:109], v7, s[4:7], s36 offen sc1
	s_waitcnt vmcnt(0)
	v_mov_b32 v98, 1
	s_mov_b64 exec, 1
	buffer_store_dword v98, off, s[4:7], s32 sc1
	s_mov_b64 exec, -1
	s_mov_b32 s33, 0x3304000
	s_waitcnt lgkmcnt(0)
r1_sp:
	buffer_load_dwordx4 v[92:95], v103, s[4:7], s33 offen sc1
	s_sub_u32 s34, s34, 1
	s_cbranch_scc1 all_exit
	s_waitcnt vmcnt(0)
	v_min_u32 v92, v92, v93
	v_min3_u32 v96, v92, v94, v95
	v_cmp_gt_u32 vcc, 1, v96
	s_cbranch_vccnz r1_sp
	s_mov_b32 s28, 0
	s_mov_b32 s30, 0
	s_mov_b32 s45, 0x3a00000
	s_mov_b32 s31, 0x6600000
r1_loop:
	buffer_load_dwordx2 v[8:9], v6, s[16:19], s30 offen offset:0
	buffer_load_dwordx2 v[10:11], v6, s[16:19], s30 offen offset:16
r1_again:
	buffer_load_dwordx4 v[112:115], v3, s[4:7], s31 offen sc1
	s_add_u32 s36, s31, 36864
	buffer_load_dwordx4 v[116:119], v3, s[4:7], s36 offen sc1
	s_add_u32 s36, s31, 73728
	buffer_load_dwordx4 v[120:123], v3, s[4:7], s36 offen sc1
	s_add_u32 s36, s31, 110592
	buffer_load_dwordx4 v[124:127], v3, s[4:7], s36 offen sc1
	s_add_u32 s36, s31, 147456
	buffer_load_dwordx4 v[128:131], v3, s[4:7], s36 offen sc1
	s_add_u32 s36, s31, 184320
	buffer_load_dwordx4 v[132:135], v3, s[4:7], s36 offen sc1
	s_add_u32 s36, s31, 221184
	buffer_load_dwordx4 v[136:139], v3, s[4:7], s36 offen sc1
	s_add_u32 s36, s31, 258048
	buffer_load_dwordx4 v[140:143], v3, s[4:7], s36 offen sc1
	s_sub_u32 s34, s34, 1
	s_cbranch_scc1 all_exit
	s_waitcnt vmcnt(9)
	v_lshlrev_b32 v60, 16, v8
	v_and_b32 v61, 0xffff0000, v8
	v_lshlrev_b32 v62, 16, v9
	v_and_b32 v63, 0xffff0000, v9
	s_waitcnt vmcnt(8)
	v_lshlrev_b32 v64, 16, v10
	v_and_b32 v65, 0xffff0000, v10
	v_lshlrev_b32 v66, 16, v11
	v_and_b32 v67, 0xffff0000, v11
	s_waitcnt vmcnt(6)
	v_max3_u32 v20, v112, v116, v112
	s_waitcnt vmcnt(4)
	v_max3_u32 v20, v20, v120, v124
	s_waitcnt vmcnt(2)
	v_max3_u32 v20, v20, v128, v132
	s_waitcnt vmcnt(0)
	v_max3_u32 v20, v20, v136, v140
	v_cmp_eq_u32 vcc, -1, v20
	s_cbranch_vccnz r1_again
	v_lshlrev_b32 v24, 16, v112
	v_and_b32 v25, 0xffff0000, v112
	v_lshlrev_b32 v26, 16, v113
	v_and_b32 v27, 0xffff0000, v113
	v_lshlrev_b32 v28, 16, v114
	v_and_b32 v29, 0xffff0000, v114
	v_lshlrev_b32 v30, 16, v115
	v_and_b32 v31, 0xffff0000, v115
	v_dot2c_f32_bf16 v24, s46, v116
	v_dot2c_f32_bf16 v25, s47, v116
	v_dot2c_f32_bf16 v26, s46, v117
	v_dot2c_f32_bf16 v27, s47, v117
	v_dot2c_f32_bf16 v28, s46, v118
	v_dot2c_f32_bf16 v29, s47, v118
	v_dot2c_f32_bf16 v30, s46, v119
	v_dot2c_f32_bf16 v31, s47, v119
	v_dot2c_f32_bf16 v24, s46, v120
	v_dot2c_f32_bf16 v25, s47, v120
	v_dot2c_f32_bf16 v26, s46, v121
	v_dot2c_f32_bf16 v27, s47, v121
	v_dot2c_f32_bf16 v28, s46, v122
	v_dot2c_f32_bf16 v29, s47, v122
	v_dot2c_f32_bf16 v30, s46, v123
	v_dot2c_f32_bf16 v31, s47, v123
	v_dot2c_f32_bf16 v24, s46, v124
	v_dot2c_f32_bf16 v25, s47, v124
	v_dot2c_f32_bf16 v26, s46, v125
	v_dot2c_f32_bf16 v27, s47, v125
	v_dot2c_f32_bf16 v28, s46, v126
	v_dot2c_f32_bf16 v29, s47, v126
	v_dot2c_f32_bf16 v30, s46, v127
	v_dot2c_f32_bf16 v31, s47, v127
	v_dot2c_f32_bf16 v24, s46, v128
	v_dot2c_f32_bf16 v25, s47, v128
	v_dot2c_f32_bf16 v26, s46, v129
	v_dot2c_f32_bf16 v27, s47, v129
	v_dot2c_f32_bf16 v28, s46, v130
	v_dot2c_f32_bf16 v29, s47, v130
	v_dot2c_f32_bf16 v30, s46, v131
	v_dot2c_f32_bf16 v31, s47, v131
	v_dot2c_f32_bf16 v24, s46, v132
	v_dot2c_f32_bf16 v25, s47, v132
	v_dot2c_f32_bf16 v26, s46, v133
	v_dot2c_f32_bf16 v27, s47, v133
	v_dot2c_f32_bf16 v28, s46, v134
	v_dot2c_f32_bf16 v29, s47, v134
	v_dot2c_f32_bf16 v30, s46, v135
	v_dot2c_f32_bf16 v31, s47, v135
	v_dot2c_f32_bf16 v24, s46, v136
	v_dot2c_f32_bf16 v25, s47, v136
	v_dot2c_f32_bf16 v26, s46, v137
	v_dot2c_f32_bf16 v27, s47, v137
	v_dot2c_f32_bf16 v28, s46, v138
	v_dot2c_f32_bf16 v29, s47, v138
	v_dot2c_f32_bf16 v30, s46, v139
	v_dot2c_f32_bf16 v31, s47, v139
	v_dot2c_f32_bf16 v24, s46, v140
	v_dot2c_f32_bf16 v25, s47, v140
	v_dot2c_f32_bf16 v26, s46, v141
	v_dot2c_f32_bf16 v27, s47, v141
	v_dot2c_f32_bf16 v28, s46, v142
	v_dot2c_f32_bf16 v29, s47, v142
	v_dot2c_f32_bf16 v30, s46, v143
	v_dot2c_f32_bf16 v31, s47, v143
	v_cvt_pk_bf16_f32 v48, v24, v25
	v_cvt_pk_bf16_f32 v49, v26, v27
	v_cvt_pk_bf16_f32 v50, v28, v29
	v_cvt_pk_bf16_f32 v51, v30, v31
	v_lshlrev_b32 v24, 16, v48
	v_and_b32 v25, 0xffff0000, v48
	v_lshlrev_b32 v26, 16, v49
	v_and_b32 v27, 0xffff0000, v49
	v_lshlrev_b32 v28, 16, v50
	v_and_b32 v29, 0xffff0000, v50
	v_lshlrev_b32 v30, 16, v51
	v_and_b32 v31, 0xffff0000, v51
	v_add_f32 v24, v24, v60
	v_add_f32 v25, v25, v61
	v_add_f32 v26, v26, v62
	v_add_f32 v27, v27, v63
	v_add_f32 v28, v28, v64
	v_add_f32 v29, v29, v65
	v_add_f32 v30, v30, v66
	v_add_f32 v31, v31, v67
	v_cvt_pk_bf16_f32 v48, v24, v25
	v_cvt_pk_bf16_f32 v49, v26, v27
	v_cvt_pk_bf16_f32 v50, v28, v29
	v_cvt_pk_bf16_f32 v51, v30, v31
	buffer_store_dwordx4 v[48:51], v3, s[4:7], s45 offen offset:0 sc1
	v_mov_b64 v[52:53], 0
	v_dot2c_f32_bf16 v52, s43, v48
	v_dot2c_f32_bf16 v53, v48, v48
	v_dot2c_f32_bf16 v52, s43, v49
	v_dot2c_f32_bf16 v53, v49, v49
	v_dot2c_f32_bf16 v52, s43, v50
	v_dot2c_f32_bf16 v53, v50, v50
	v_dot2c_f32_bf16 v52, s43, v51
	v_dot2c_f32_bf16 v53, v51, v51
	s_nop 1
	v_add_f32_dpp v54, v52, v52 quad_perm:[1,0,3,2] row_mask:0xf bank_mask:0xf
	v_add_f32_dpp v55, v53, v53 quad_perm:[1,0,3,2] row_mask:0xf bank_mask:0xf
	s_nop 0
	v_add_f32_dpp v52, v54, v54 quad_perm:[2,3,0,1] row_mask:0xf bank_mask:0xf
	v_add_f32_dpp v53, v55, v55 quad_perm:[2,3,0,1] row_mask:0xf bank_mask:0xf
	s_nop 0
	v_add_f32_dpp v54, v52, v52 row_half_mirror row_mask:0xf bank_mask:0xf
	v_add_f32_dpp v55, v53, v53 row_half_mirror row_mask:0xf bank_mask:0xf
	s_add_u32 s36, s45, 147456
	s_add_u32 s37, s35, 32768
	s_mov_b64 exec, s[76:77]
	buffer_store_dwordx2 v[54:55], v7, s[4:7], s35 offen sc1
	buffer_store_dwordx2 v[108:109], v7, s[4:7], s37 offen sc1
	s_mov_b64 exec, -1
	buffer_store_dwordx4 v[108:111], v3, s[4:7], s36 offen offset:0 sc1
	s_add_u32 s35, s35, 8192
	s_add_u32 s28, s28, 1
	s_add_u32 s30, s30, 36864
	s_add_u32 s45, s45, 36864
	s_add_u32 s31, s31, 294912
	s_cmp_lt_u32 s28, 64
	s_cbranch_scc1 r1_loop
	s_branch all_exit
r2_entry:
	s_cmp_eq_u32 s26, 3
	s_cbranch_scc1 all_exit
	s_load_dwordx2 s[8:9], s[0:1], 88
	s_mov_b32 s10, 2359296
	s_mov_b32 s11, 0x00020000
	s_mov_b32 s46, 0x3f80
	s_mov_b32 s47, 0x3f800000
	s_mov_b32 s43, 0x3f803f80
	s_mul_i32 s36, s27, 3
	s_add_u32 s36, s36, s26
	s_mul_i32 s48, s36, 57
	s_lshr_b32 s48, s48, 9
	s_mul_i32 s37, s48, 9
	s_sub_u32 s49, s36, s37
	s_lshl_b32 s36, s49, 12
	s_lshl_b32 s37, s48, 7
	s_add_u32 s36, s36, s37
	v_add_u32 v3, s36, v100
	v_add_u32 v105, s36, v105
	s_lshl_b32 s36, s49, 7
	s_mul_i32 s37, s48, 9216
	s_add_u32 s36, s36, s37
	v_add_u32 v6, s36, v101
	s_mov_b32 s33, 0x3306c00
	s_waitcnt lgkmcnt(0)
r2_sp:
	buffer_load_dwordx4 v[92:95], v103, s[4:7], s33 offen sc1
	s_sub_u32 s34, s34, 1
	s_cbranch_scc1 all_exit
	s_waitcnt vmcnt(0)
	v_min_u32 v92, v92, v93
	v_min3_u32 v96, v92, v94, v95
	v_cmp_gt_u32 vcc, 1, v96
	s_cbranch_vccnz r2_sp
	s_mov_b32 s28, 0
	s_mov_b32 s30, 0
	s_mov_b32 s45, 0x3a00000
	s_mov_b32 s31, 0x7a00000
r2_loop:
r2_again:
	buffer_load_dwordx4 v[8:11], v3, s[4:7], s45 offen sc1
	buffer_load_dwordx4 v[112:115], v3, s[4:7], s31 offen sc1
	s_add_u32 s36, s31, 36864
	buffer_load_dwordx4 v[116:119], v3, s[4:7], s36 offen sc1
	s_add_u32 s36, s31, 73728
	buffer_load_dwordx4 v[120:123], v3, s[4:7], s36 offen sc1
	s_add_u32 s36, s31, 110592
	buffer_load_dwordx4 v[124:127], v3, s[4:7], s36 offen sc1
	s_add_u32 s36, s31, 147456
	buffer_load_dwordx4 v[128:131], v3, s[4:7], s36 offen sc1
	s_add_u32 s36, s31, 184320
	buffer_load_dwordx4 v[132:135], v3, s[4:7], s36 offen sc1
	s_add_u32 s36, s31, 221184
	buffer_load_dwordx4 v[136:139], v3, s[4:7], s36 offen sc1
	s_add_u32 s36, s31, 258048
	buffer_load_dwordx4 v[140:143], v3, s[4:7], s36 offen sc1
	s_sub_u32 s34, s34, 1
	s_cbranch_scc1 all_exit
	s_waitcnt vmcnt(8)
	v_lshlrev_b32 v60, 16, v8
	v_and_b32 v61, 0xffff0000, v8
	v_lshlrev_b32 v62, 16, v9
	v_and_b32 v63, 0xffff0000, v9
	v_lshlrev_b32 v64, 16, v10
	v_and_b32 v65, 0xffff0000, v10
	v_lshlrev_b32 v66, 16, v11
	v_and_b32 v67, 0xffff0000, v11
	s_waitcnt vmcnt(6)
	v_max3_u32 v20, v112, v116, v8
	s_waitcnt vmcnt(4)
	v_max3_u32 v20, v20, v120, v124
	s_waitcnt vmcnt(2)
	v_max3_u32 v20, v20, v128, v132
	s_waitcnt vmcnt(0)
	v_max3_u32 v20, v20, v136, v140
	v_cmp_eq_u32 vcc, -1, v20
	s_cbranch_vccnz r2_again
	v_lshlrev_b32 v24, 16, v112
	v_and_b32 v25, 0xffff0000, v112
	v_lshlrev_b32 v26, 16, v113
	v_and_b32 v27, 0xffff0000, v113
	v_lshlrev_b32 v28, 16, v114
	v_and_b32 v29, 0xffff0000, v114
	v_lshlrev_b32 v30, 16, v115
	v_and_b32 v31, 0xffff0000, v115
	v_dot2c_f32_bf16 v24, s46, v116
	v_dot2c_f32_bf16 v25, s47, v116
	v_dot2c_f32_bf16 v26, s46, v117
	v_dot2c_f32_bf16 v27, s47, v117
	v_dot2c_f32_bf16 v28, s46, v118
	v_dot2c_f32_bf16 v29, s47, v118
	v_dot2c_f32_bf16 v30, s46, v119
	v_dot2c_f32_bf16 v31, s47, v119
	v_dot2c_f32_bf16 v24, s46, v120
	v_dot2c_f32_bf16 v25, s47, v120
	v_dot2c_f32_bf16 v26, s46, v121
	v_dot2c_f32_bf16 v27, s47, v121
	v_dot2c_f32_bf16 v28, s46, v122
	v_dot2c_f32_bf16 v29, s47, v122
	v_dot2c_f32_bf16 v30, s46, v123
	v_dot2c_f32_bf16 v31, s47, v123
	v_dot2c_f32_bf16 v24, s46, v124
	v_dot2c_f32_bf16 v25, s47, v124
	v_dot2c_f32_bf16 v26, s46, v125
	v_dot2c_f32_bf16 v27, s47, v125
	v_dot2c_f32_bf16 v28, s46, v126
	v_dot2c_f32_bf16 v29, s47, v126
	v_dot2c_f32_bf16 v30, s46, v127
	v_dot2c_f32_bf16 v31, s47, v127
	v_dot2c_f32_bf16 v24, s46, v128
	v_dot2c_f32_bf16 v25, s47, v128
	v_dot2c_f32_bf16 v26, s46, v129
	v_dot2c_f32_bf16 v27, s47, v129
	v_dot2c_f32_bf16 v28, s46, v130
	v_dot2c_f32_bf16 v29, s47, v130
	v_dot2c_f32_bf16 v30, s46, v131
	v_dot2c_f32_bf16 v31, s47, v131
	v_dot2c_f32_bf16 v24, s46, v132
	v_dot2c_f32_bf16 v25, s47, v132
	v_dot2c_f32_bf16 v26, s46, v133
	v_dot2c_f32_bf16 v27, s47, v133
	v_dot2c_f32_bf16 v28, s46, v134
	v_dot2c_f32_bf16 v29, s47, v134
	v_dot2c_f32_bf16 v30, s46, v135
	v_dot2c_f32_bf16 v31, s47, v135
	v_dot2c_f32_bf16 v24, s46, v136
	v_dot2c_f32_bf16 v25, s47, v136
	v_dot2c_f32_bf16 v26, s46, v137
	v_dot2c_f32_bf16 v27, s47, v137
	v_dot2c_f32_bf16 v28, s46, v138
	v_dot2c_f32_bf16 v29, s47, v138
	v_dot2c_f32_bf16 v30, s46, v139
	v_dot2c_f32_bf16 v31, s47, v139
	v_dot2c_f32_bf16 v24, s46, v140
	v_dot2c_f32_bf16 v25, s47, v140
	v_dot2c_f32_bf16 v26, s46, v141
	v_dot2c_f32_bf16 v27, s47, v141
	v_dot2c_f32_bf16 v28, s46, v142
	v_dot2c_f32_bf16 v29, s47, v142
	v_dot2c_f32_bf16 v30, s46, v143
	v_dot2c_f32_bf16 v31, s47, v143
	v_cvt_pk_bf16_f32 v48, v24, v25
	v_cvt_pk_bf16_f32 v49, v26, v27
	v_cvt_pk_bf16_f32 v50, v28, v29
	v_cvt_pk_bf16_f32 v51, v30, v31
	v_lshlrev_b32 v24, 16, v48
	v_and_b32 v25, 0xffff0000, v48
	v_lshlrev_b32 v26, 16, v49
	v_and_b32 v27, 0xffff0000, v49
	v_lshlrev_b32 v28, 16, v50
	v_and_b32 v29, 0xffff0000, v50
	v_lshlrev_b32 v30, 16, v51
	v_and_b32 v31, 0xffff0000, v51
	v_add_f32 v24, v24, v60
	v_add_f32 v25, v25, v61
	v_add_f32 v26, v26, v62
	v_add_f32 v27, v27, v63
	v_add_f32 v28, v28, v64
	v_add_f32 v29, v29, v65
	v_add_f32 v30, v30, v66
	v_add_f32 v31, v31, v67
	v_cvt_pk_bf16_f32 v48, v24, v25
	v_cvt_pk_bf16_f32 v49, v26, v27
	v_cvt_pk_bf16_f32 v50, v28, v29
	v_cvt_pk_bf16_f32 v51, v30, v31
	buffer_store_dwordx2 v[48:49], v6, s[8:11], s30 offen
	buffer_store_dwordx2 v[50:51], v6, s[8:11], s30 offen offset:16
	s_add_u32 s28, s28, 1
	s_add_u32 s30, s30, 36864
	s_add_u32 s45, s45, 36864
	s_add_u32 s31, s31, 294912
	s_cmp_lt_u32 s28, 64
	s_cbranch_scc1 r2_loop
	s_branch all_exit
at_entry:
	v_add_u32 v8, 11264, v0
	global_load_dwordx4 v[100:103], v8, s[64:65]
	global_load_dwordx4 v[104:107], v8, s[64:65] offset:1024
	s_lshl_b32 s32, s27, 7
	s_lshl_b32 s36, s26, 2
	s_add_u32 s32, s32, s36
	s_add_u32 s32, s32, 0x3303000
	v_mov_b64 v[108:109], -1
	v_mov_b64 v[110:111], -1
	s_and_b32 s47, s26, 1
	s_lshr_b32 s28, s26, 1
	s_lshl_b32 s37, s27, 13
	s_waitcnt vmcnt(0)
	s_lshl_b32 s36, s28, 18
	s_add_u32 s37, s37, s36
	s_add_u32 s49, s37, 0x2000000
	s_lshl_b32 s35, s37, 1
	s_lshl_b32 s36, s47, 12
	s_add_u32 s30, s37, s36
	s_add_u32 s30, s30, 0x9000000
	s_lshl_b32 s36, s47, 8
	s_add_u32 s31, s37, s36
	s_add_u32 s31, s31, 0x4000000
	s_mov_b32 s46, 0x3e0293ee
	v_add_u32 v3, 4096, v0
	v_add_u32 v4, 8192, v0
	v_add_u32 v5, 12288, v0
	v_add_u32 v106, 4096, v100
	v_lshlrev_b32 v107, 9, v102
	s_add_u32 s36, s31, 0
	buffer_store_dwordx4 v[108:111], v100, s[4:7], s36 offen offset:0 sc1
	buffer_store_dwordx4 v[108:111], v100, s[4:7], s36 offen offset:2048 sc1
	buffer_store_dwordx4 v[108:111], v106, s[4:7], s36 offen offset:0 sc1
	buffer_store_dwordx4 v[108:111], v106, s[4:7], s36 offen offset:2048 sc1
	s_add_u32 s36, s31, 524288
	buffer_store_dwordx4 v[108:111], v100, s[4:7], s36 offen offset:0 sc1
	buffer_store_dwordx4 v[108:111], v100, s[4:7], s36 offen offset:2048 sc1
	buffer_store_dwordx4 v[108:111], v106, s[4:7], s36 offen offset:0 sc1
	buffer_store_dwordx4 v[108:111], v106, s[4:7], s36 offen offset:2048 sc1
	s_lshl_b32 s36, s47, 4
	v_add_u32 v101, s36, v101
	v_cmp_le_i32 s[60:61], 0, v101
	v_cmp_le_i32 s[62:63], 1, v101
	v_cmp_le_i32 s[64:65], 2, v101
	v_cmp_le_i32 s[66:67], 3, v101
	v_cmp_le_i32 s[68:69], 8, v101
	v_cmp_le_i32 s[70:71], 9, v101
	v_cmp_le_i32 s[72:73], 10, v101
	v_cmp_le_i32 s[74:75], 11, v101
	s_sub_u32 s36, 192, s27
	s_lshr_b32 s37, s27, 1
	s_add_u32 s36, s36, s37
	s_lshl_b32 s36, s36, 7
	v_mul_lo_u32 v103, v103, s36
	v_add_u32 v103, v103, v102
	s_lshl_b32 s36, s27, 7
	s_add_u32 s33, s36, 0x3302000
	v_mov_b32 v6, 0xf149f2ca
	s_mov_b32 s43, 0
	s_mov_b32 s76, 0xff00ff00
	s_mov_b32 s77, 0xff00ff00
	v_mov_b64 v[112:113], 0
	v_mov_b64 v[114:115], 0
	v_mov_b64 v[116:117], 0
	v_mov_b64 v[118:119], 0
	v_mov_b64 v[120:121], 0
	v_mov_b64 v[122:123], 0
	v_mov_b64 v[124:125], 0
	v_mov_b64 v[126:127], 0
	s_waitcnt vmcnt(0)
	v_mov_b32 v98, 1
	s_mov_b64 exec, 1
	buffer_store_dword v98, off, s[4:7], s32 sc1
	s_mov_b64 exec, -1
	s_add_u32 s29, s28, 1
	s_cmp_ge_u32 s43, s29
	s_cbranch_scc1 at_k0_ok
at_k0:
	buffer_load_dword v96, v103, s[4:7], s33 offen sc1
	s_sub_u32 s34, s34, 1
	s_cbranch_scc1 all_exit
	s_waitcnt vmcnt(0)
	v_cmp_gt_u32 vcc, s29, v96
	s_cbranch_vccnz at_k0
	v_min_u32_dpp v97, v96, v96 quad_perm:[1,0,3,2] row_mask:0xf bank_mask:0xf
	s_nop 1
	v_min_u32_dpp v96, v97, v97 quad_perm:[2,3,0,1] row_mask:0xf bank_mask:0xf
	s_nop 1
	v_min_u32_dpp v97, v96, v96 row_half_mirror row_mask:0xf bank_mask:0xf
	s_nop 0
	v_readfirstlane_b32 s43, v97
at_k0_ok:
	buffer_load_dwordx4 v[8:11], v0, s[4:7], s30 offen offset:0 sc1
	buffer_load_dwordx4 v[24:27], v0, s[4:7], s35 offen offset:0 sc1
	buffer_load_dwordx4 v[28:31], v0, s[4:7], s35 offen offset:1024 sc1
	buffer_load_dwordx4 v[12:15], v0, s[4:7], s30 offen offset:1024 sc1
	buffer_load_dwordx4 v[32:35], v3, s[4:7], s35 offen offset:0 sc1
	buffer_load_dwordx4 v[36:39], v3, s[4:7], s35 offen offset:1024 sc1
	buffer_load_dwordx4 v[16:19], v0, s[4:7], s30 offen offset:2048 sc1
	buffer_load_dwordx4 v[40:43], v4, s[4:7], s35 offen offset:0 sc1
	buffer_load_dwordx4 v[44:47], v4, s[4:7], s35 offen offset:1024 sc1
	buffer_load_dwordx4 v[20:23], v0, s[4:7], s30 offen offset:3072 sc1
	buffer_load_dwordx4 v[48:51], v5, s[4:7], s35 offen offset:0 sc1
	buffer_load_dwordx4 v[52:55], v5, s[4:7], s35 offen offset:1024 sc1
	buffer_load_dwordx4 v[56:59], v0, s[4:7], s35 offen offset:2048 sc1
	buffer_load_dwordx4 v[60:63], v0, s[4:7], s35 offen offset:3072 sc1
	buffer_load_dwordx4 v[64:67], v3, s[4:7], s35 offen offset:2048 sc1
	buffer_load_dwordx4 v[68:71], v3, s[4:7], s35 offen offset:3072 sc1
	buffer_load_dwordx4 v[72:75], v4, s[4:7], s35 offen offset:2048 sc1
	buffer_load_dwordx4 v[76:79], v4, s[4:7], s35 offen offset:3072 sc1
	buffer_load_dwordx4 v[80:83], v5, s[4:7], s35 offen offset:2048 sc1
	buffer_load_dwordx4 v[84:87], v5, s[4:7], s35 offen offset:3072 sc1
	s_waitcnt vmcnt(0)
at_loop:
	s_waitcnt vmcnt(21)
	v_mfma_f32_16x16x32_bf16 v[136:139], v[24:27], v[8:11], 0
	v_mfma_f32_16x16x32_bf16 v[140:143], v[28:31], v[8:11], 0
	s_waitcnt vmcnt(18)
	v_mfma_f32_16x16x32_bf16 v[136:139], v[32:35], v[12:15], v[136:139]
	v_mfma_f32_16x16x32_bf16 v[140:143], v[36:39], v[12:15], v[140:143]
	s_waitcnt vmcnt(15)
	v_mfma_f32_16x16x32_bf16 v[136:139], v[40:43], v[16:19], v[136:139]
	v_mfma_f32_16x16x32_bf16 v[140:143], v[44:47], v[16:19], v[140:143]
	s_waitcnt vmcnt(12)
	v_mfma_f32_16x16x32_bf16 v[136:139], v[48:51], v[20:23], v[136:139]
	v_mfma_f32_16x16x32_bf16 v[140:143], v[52:55], v[20:23], v[140:143]
	s_add_u32 s30, s30, 524288
	s_add_u32 s35, s35, 1048576
	s_nop 1
	v_cndmask_b32_e64 v136, v6, v136, s[60:61]
	v_cndmask_b32_e64 v137, v6, v137, s[62:63]
	v_cndmask_b32_e64 v138, v6, v138, s[64:65]
	v_cndmask_b32_e64 v139, v6, v139, s[66:67]
	v_cndmask_b32_e64 v140, v6, v140, s[68:69]
	v_cndmask_b32_e64 v141, v6, v141, s[70:71]
	v_cndmask_b32_e64 v142, v6, v142, s[72:73]
	v_cndmask_b32_e64 v143, v6, v143, s[74:75]
	v_max3_f32 v2, v136, v137, v138
	v_max3_f32 v2, v2, v139, v140
	v_max3_f32 v2, v2, v141, v142
	v_max_f32 v2, v2, v143
	s_add_u32 s29, s28, 3
	s_min_u32 s29, s29, 64
	s_cmp_ge_u32 s43, s29
	s_cbranch_scc1 at_k1_ok
at_k1:
	buffer_load_dword v96, v103, s[4:7], s33 offen sc1
	s_sub_u32 s34, s34, 1
	s_cbranch_scc1 all_exit
	s_waitcnt vmcnt(0)
	v_cmp_gt_u32 vcc, s29, v96
	s_cbranch_vccnz at_k1
	v_min_u32_dpp v97, v96, v96 quad_perm:[1,0,3,2] row_mask:0xf bank_mask:0xf
	s_nop 1
	v_min_u32_dpp v96, v97, v97 quad_perm:[2,3,0,1] row_mask:0xf bank_mask:0xf
	s_nop 1
	v_min_u32_dpp v97, v96, v96 row_half_mirror row_mask:0xf bank_mask:0xf
	s_nop 0
	v_readfirstlane_b32 s43, v97
at_k1_ok:
at_look:
	buffer_load_dword v92, v107, s[4:7], s49 offen offset:240 sc1
	s_sub_u32 s34, s34, 1
	s_cbranch_scc1 all_exit
	s_waitcnt vmcnt(0)
	v_cmp_eq_u32 vcc, -1, v92
	s_cbranch_vccnz at_look
at_again:
	s_mov_b64 exec, s[76:77]
	buffer_load_dwordx4 v[112:115], v0, s[4:7], s49 offen offset:0 sc1
	buffer_load_dwordx4 v[116:119], v0, s[4:7], s49 offen offset:2048 sc1
	buffer_load_dwordx4 v[120:123], v3, s[4:7], s49 offen offset:0 sc1
	buffer_load_dwordx4 v[124:127], v3, s[4:7], s49 offen offset:2048 sc1
	s_mov_b64 exec, -1
	buffer_load_dwordx4 v[200:203], v0, s[4:7], s49 offen offset:1024 sc1
	buffer_load_dwordx4 v[204:207], v0, s[4:7], s49 offen offset:3072 sc1
	buffer_load_dwordx4 v[208:211], v3, s[4:7], s49 offen offset:1024 sc1
	buffer_load_dwordx4 v[212:215], v3, s[4:7], s49 offen offset:3072 sc1
	s_sub_u32 s34, s34, 1
	s_cbranch_scc1 all_exit
	s_waitcnt vmcnt(7)
	v_mfma_f32_16x16x32_bf16 v[144:147], v[112:115], v[8:11], 0
	s_waitcnt vmcnt(6)
	v_mfma_f32_16x16x32_bf16 v[144:147], v[116:119], v[12:15], v[144:147]
	s_waitcnt vmcnt(5)
	v_mfma_f32_16x16x32_bf16 v[144:147], v[120:123], v[16:19], v[144:147]
	s_waitcnt vmcnt(4)
	v_mfma_f32_16x16x32_bf16 v[144:147], v[124:127], v[20:23], v[144:147]
	v_max3_u32 v92, v112, v116, v120
	s_waitcnt vmcnt(3)
	v_max3_u32 v92, v92, v124, v200
	s_waitcnt vmcnt(1)
	v_max3_u32 v92, v92, v204, v208
	s_waitcnt vmcnt(0)
	v_max_u32 v92, v92, v212
	v_cmp_eq_u32 vcc, -1, v92
	s_cbranch_vccnz at_again
	s_add_u32 s49, s49, 524288
	s_mov_b32 exec_hi, 0
	v_mov_b32 v144, v6
	v_mov_b32 v145, v6
	v_mov_b32 v146, v6
	v_mov_b32 v147, v6
	s_mov_b32 exec_hi, -1
	v_max3_f32 v2, v2, v144, v145
	v_max3_f32 v92, v2, v146, v147
	v_max3_f32 v93, v2, v146, v147
	s_nop 1
	v_permlane16_swap_b32 v92, v93
	v_max_f32 v2, v92, v93
	v_max_f32 v92, v92, v93
	s_nop 1
	v_permlane32_swap_b32 v2, v92
	v_max_f32 v2, v2, v92
	v_mul_f32 v2, s46, v2
	v_fma_f32 v136, v136, s46, -v2
	v_fma_f32 v137, v137, s46, -v2
	v_fma_f32 v138, v138, s46, -v2
	v_fma_f32 v139, v139, s46, -v2
	v_fma_f32 v140, v140, s46, -v2
	v_fma_f32 v141, v141, s46, -v2
	v_fma_f32 v142, v142, s46, -v2
	v_fma_f32 v143, v143, s46, -v2
	v_fma_f32 v144, v144, s46, -v2
	v_fma_f32 v145, v145, s46, -v2
	v_fma_f32 v146, v146, s46, -v2
	v_fma_f32 v147, v147, s46, -v2
	v_exp_f32 v136, v136
	v_exp_f32 v137, v137
	v_exp_f32 v138, v138
	v_exp_f32 v139, v139
	v_exp_f32 v140, v140
	v_exp_f32 v141, v141
	v_exp_f32 v142, v142
	v_exp_f32 v143, v143
	v_exp_f32 v144, v144
	v_exp_f32 v145, v145
	v_exp_f32 v146, v146
	v_exp_f32 v147, v147
	v_cvt_pk_bf16_f32 v148, v136, v137
	v_cvt_pk_bf16_f32 v149, v138, v139
	v_cvt_pk_bf16_f32 v150, v140, v141
	v_cvt_pk_bf16_f32 v151, v142, v143
	v_cvt_pk_bf16_f32 v92, v144, v146
	v_cvt_pk_bf16_f32 v93, v145, v147
	v_cvt_pk_bf16_f32 v94, v144, v146
	v_cvt_pk_bf16_f32 v95, v145, v147
	v_mfma_f32_16x16x32_bf16 v[152:155], v[56:59], v[148:151], 0
	v_permlane32_swap_b32 v92, v94
	v_permlane32_swap_b32 v93, v95
	v_mfma_f32_16x16x32_bf16 v[156:159], v[60:63], v[148:151], 0
	v_add_f32 v88, v136, v140
	v_add_f32 v89, v137, v141
	v_mfma_f32_16x16x32_bf16 v[160:163], v[64:67], v[148:151], 0
	v_add_f32 v90, v138, v142
	v_add_f32 v91, v139, v143
	v_mfma_f32_16x16x32_bf16 v[164:167], v[68:71], v[148:151], 0
	v_add_f32 v88, v88, v144
	v_add_f32 v89, v89, v145
	v_mfma_f32_16x16x32_bf16 v[168:171], v[72:75], v[148:151], 0
	v_add_f32 v90, v90, v146
	v_add_f32 v91, v91, v147
	v_mfma_f32_16x16x32_bf16 v[172:175], v[76:79], v[148:151], 0
	v_add_f32 v88, v88, v89
	v_add_f32 v90, v90, v91
	v_mfma_f32_16x16x32_bf16 v[176:179], v[80:83], v[148:151], 0
	v_add_f32 v89, v88, v90
	v_add_f32 v88, v88, v90
	v_mfma_f32_16x16x32_bf16 v[180:183], v[84:87], v[148:151], 0
	v_permlane16_swap_b32 v88, v89
	v_add_f32 v90, v88, v89
	v_mfma_f32_16x16x16_bf16 v[152:155], v[200:201], v[94:95], v[152:155]
	v_add_f32 v88, v88, v89
	v_mfma_f32_16x16x16_bf16 v[156:159], v[202:203], v[94:95], v[156:159]
	v_permlane32_swap_b32 v88, v90
	v_mfma_f32_16x16x16_bf16 v[160:163], v[204:205], v[94:95], v[160:163]
	v_add_f32 v88, v88, v90
	v_mfma_f32_16x16x16_bf16 v[164:167], v[206:207], v[94:95], v[164:167]
	v_rcp_f32 v88, v88
	v_mfma_f32_16x16x16_bf16 v[168:171], v[208:209], v[94:95], v[168:171]
	v_mfma_f32_16x16x16_bf16 v[172:175], v[210:211], v[94:95], v[172:175]
	v_mfma_f32_16x16x16_bf16 v[176:179], v[212:213], v[94:95], v[176:179]
	v_mfma_f32_16x16x16_bf16 v[180:183], v[214:215], v[94:95], v[180:183]
	v_pk_mul_f32 v[152:153], v[152:153], v[88:89] op_sel_hi:[1,0]
	v_pk_mul_f32 v[154:155], v[154:155], v[88:89] op_sel_hi:[1,0]
	v_pk_mul_f32 v[156:157], v[156:157], v[88:89] op_sel_hi:[1,0]
	v_pk_mul_f32 v[158:159], v[158:159], v[88:89] op_sel_hi:[1,0]
	v_cvt_pk_bf16_f32 v184, v152, v153
	v_cvt_pk_bf16_f32 v185, v154, v155
	v_cvt_pk_bf16_f32 v186, v156, v157
	v_cvt_pk_bf16_f32 v187, v158, v159
	buffer_store_dwordx4 v[184:187], v100, s[4:7], s31 offen offset:0 sc1
	v_pk_mul_f32 v[160:161], v[160:161], v[88:89] op_sel_hi:[1,0]
	v_pk_mul_f32 v[162:163], v[162:163], v[88:89] op_sel_hi:[1,0]
	v_pk_mul_f32 v[164:165], v[164:165], v[88:89] op_sel_hi:[1,0]
	v_pk_mul_f32 v[166:167], v[166:167], v[88:89] op_sel_hi:[1,0]
	v_cvt_pk_bf16_f32 v188, v160, v161
	v_cvt_pk_bf16_f32 v189, v162, v163
	v_cvt_pk_bf16_f32 v190, v164, v165
	v_cvt_pk_bf16_f32 v191, v166, v167
	buffer_store_dwordx4 v[188:191], v100, s[4:7], s31 offen offset:2048 sc1
	v_pk_mul_f32 v[168:169], v[168:169], v[88:89] op_sel_hi:[1,0]
	v_pk_mul_f32 v[170:171], v[170:171], v[88:89] op_sel_hi:[1,0]
	v_pk_mul_f32 v[172:173], v[172:173], v[88:89] op_sel_hi:[1,0]
	v_pk_mul_f32 v[174:175], v[174:175], v[88:89] op_sel_hi:[1,0]
	v_cvt_pk_bf16_f32 v192, v168, v169
	v_cvt_pk_bf16_f32 v193, v170, v171
	v_cvt_pk_bf16_f32 v194, v172, v173
	v_cvt_pk_bf16_f32 v195, v174, v175
	buffer_store_dwordx4 v[192:195], v106, s[4:7], s31 offen offset:0 sc1
	v_pk_mul_f32 v[176:177], v[176:177], v[88:89] op_sel_hi:[1,0]
	v_pk_mul_f32 v[178:179], v[178:179], v[88:89] op_sel_hi:[1,0]
	v_pk_mul_f32 v[180:181], v[180:181], v[88:89] op_sel_hi:[1,0]
	v_pk_mul_f32 v[182:183], v[182:183], v[88:89] op_sel_hi:[1,0]
	v_cvt_pk_bf16_f32 v196, v176, v177
	v_cvt_pk_bf16_f32 v197, v178, v179
	v_cvt_pk_bf16_f32 v198, v180, v181
	v_cvt_pk_bf16_f32 v199, v182, v183
	buffer_store_dwordx4 v[196:199], v106, s[4:7], s31 offen offset:2048 sc1
	s_add_u32 s28, s28, 2
	s_sub_u32 s37, s28, 1
	s_cmp_ge_u32 s28, 64
	s_cbranch_scc1 all_exit
	buffer_load_dwordx4 v[8:11], v0, s[4:7], s30 offen offset:0 sc1
	buffer_load_dwordx4 v[24:27], v0, s[4:7], s35 offen offset:0 sc1
	buffer_load_dwordx4 v[28:31], v0, s[4:7], s35 offen offset:1024 sc1
	buffer_load_dwordx4 v[12:15], v0, s[4:7], s30 offen offset:1024 sc1
	buffer_load_dwordx4 v[32:35], v3, s[4:7], s35 offen offset:0 sc1
	buffer_load_dwordx4 v[36:39], v3, s[4:7], s35 offen offset:1024 sc1
	buffer_load_dwordx4 v[16:19], v0, s[4:7], s30 offen offset:2048 sc1
	buffer_load_dwordx4 v[40:43], v4, s[4:7], s35 offen offset:0 sc1
	buffer_load_dwordx4 v[44:47], v4, s[4:7], s35 offen offset:1024 sc1
	buffer_load_dwordx4 v[20:23], v0, s[4:7], s30 offen offset:3072 sc1
	buffer_load_dwordx4 v[48:51], v5, s[4:7], s35 offen offset:0 sc1
	buffer_load_dwordx4 v[52:55], v5, s[4:7], s35 offen offset:1024 sc1
	buffer_load_dwordx4 v[56:59], v0, s[4:7], s35 offen offset:2048 sc1
	buffer_load_dwordx4 v[60:63], v0, s[4:7], s35 offen offset:3072 sc1
	buffer_load_dwordx4 v[64:67], v3, s[4:7], s35 offen offset:2048 sc1
	buffer_load_dwordx4 v[68:71], v3, s[4:7], s35 offen offset:3072 sc1
	buffer_load_dwordx4 v[72:75], v4, s[4:7], s35 offen offset:2048 sc1
	buffer_load_dwordx4 v[76:79], v4, s[4:7], s35 offen offset:3072 sc1
	buffer_load_dwordx4 v[80:83], v5, s[4:7], s35 offen offset:2048 sc1
	buffer_load_dwordx4 v[84:87], v5, s[4:7], s35 offen offset:3072 sc1
	s_add_u32 s36, s31, 1048576
	buffer_store_dwordx4 v[108:111], v100, s[4:7], s36 offen offset:0 sc1
	buffer_store_dwordx4 v[108:111], v100, s[4:7], s36 offen offset:2048 sc1
	buffer_store_dwordx4 v[108:111], v106, s[4:7], s36 offen offset:0 sc1
	buffer_store_dwordx4 v[108:111], v106, s[4:7], s36 offen offset:2048 sc1
	s_add_u32 s31, s31, 524288
	s_branch at_loop
all_exit:
	s_waitcnt vmcnt(0)
	s_endpgm
.p2align 8
.type chain_tbl,@object
chain_tbl:
.long 0x4444,0x1800,0xb200,0x14c00,0x4444,0x1810,0xb210,0x14c10
.long 0x4444,0x1820,0xb220,0x14c20,0x4444,0x1830,0xb230,0x14c30
.long 0x4444,0x1840,0xb240,0x14c40,0x4444,0x1850,0xb250,0x14c50
.long 0x4444,0x1860,0xb260,0x14c60,0x4444,0x1870,0xb270,0x14c70
.long 0xeeee,0x1880,0xb280,0x14c80,0xeeee,0x1890,0xb290,0x14c90
.long 0xeeee,0x18a0,0xb2a0,0x14ca0,0xeeee,0x18b0,0xb2b0,0x14cb0
.long 0xeeee,0x18c0,0xb2c0,0x14cc0,0xeeee,0x18d0,0xb2d0,0x14cd0
.long 0xeeee,0x18e0,0xb2e0,0x14ce0,0xeeee,0x18f0,0xb2f0,0x14cf0
.long 0x4444,0x1900,0xb300,0x14d00,0x4444,0x1910,0xb310,0x14d10
.long 0x4444,0x1920,0xb320,0x14d20,0x4444,0x1930,0xb330,0x14d30
.long 0x4444,0x1940,0xb340,0x14d40,0x4444,0x1950,0xb350,0x14d50
.long 0x4444,0x1960,0xb360,0x14d60,0x4444,0x1970,0xb370,0x14d70
.long 0xeeee,0x1980,0xb380,0x14d80,0xeeee,0x1990,0xb390,0x14d90
.long 0xeeee,0x19a0,0xb3a0,0x14da0,0xeeee,0x19b0,0xb3b0,0x14db0
.long 0xeeee,0x19c0,0xb3c0,0x14dc0,0xeeee,0x19d0,0xb3d0,0x14dd0
.long 0xeeee,0x19e0,0xb3e0,0x14de0,0xeeee,0x19f0,0xb3f0,0x14df0
.long 0x4444,0x1a00,0xb400,0x14e00,0x4444,0x1a10,0xb410,0x14e10
.long 0x4444,0x1a20,0xb420,0x14e20,0x4444,0x1a30,0xb430,0x14e30
.long 0x4444,0x1a40,0xb440,0x14e40,0x4444,0x1a50,0xb450,0x14e50
.long 0x4444,0x1a60,0xb460,0x14e60,0x4444,0x1a70,0xb470,0x14e70
.long 0xeeee,0x1a80,0xb480,0x14e80,0xeeee,0x1a90,0xb490,0x14e90
.long 0xeeee,0x1aa0,0xb4a0,0x14ea0,0xeeee,0x1ab0,0xb4b0,0x14eb0
.long 0xeeee,0x1ac0,0xb4c0,0x14ec0,0xeeee,0x1ad0,0xb4d0,0x14ed0
.long 0xeeee,0x1ae0,0xb4e0,0x14ee0,0xeeee,0x1af0,0xb4f0,0x14ef0
.long 0x4444,0x1b00,0xb500,0x14f00,0x4444,0x1b10,0xb510,0x14f10
.long 0x4444,0x1b20,0xb520,0x14f20,0x4444,0x1b30,0xb530,0x14f30
.long 0x4444,0x1b40,0xb540,0x14f40,0x4444,0x1b50,0xb550,0x14f50
.long 0x4444,0x1b60,0xb560,0x14f60,0x4444,0x1b70,0xb570,0x14f70
.long 0xeeee,0x1b80,0xb580,0x14f80,0xeeee,0x1b90,0xb590,0x14f90
.long 0xeeee,0x1ba0,0xb5a0,0x14fa0,0xeeee,0x1bb0,0xb5b0,0x14fb0
.long 0xeeee,0x1bc0,0xb5c0,0x14fc0,0xeeee,0x1bd0,0xb5d0,0x14fd0
.long 0xeeee,0x1be0,0xb5e0,0x14fe0,0xeeee,0x1bf0,0xb5f0,0x14ff0
.long 0x1e600,0x0,0x0,0x0,0x1e610,0x4,0x4,0x2
.long 0x1e620,0x8,0x8,0x4,0x1e630,0xc,0xc,0x6
.long 0x1e640,0x10,0x80,0x8,0x1e650,0x14,0x84,0xa
.long 0x1e660,0x18,0x88,0xc,0x1e670,0x1c,0x8c,0xe
.long 0x1e680,0x20,0x80000000,0x80000000,0x1e690,0x24,0x80000000,0x80000000
.long 0x1e6a0,0x28,0x80000000,0x80000000,0x1e6b0,0x2c,0x80000000,0x80000000
.long 0x1e6c0,0x30,0x80000000,0x80000000,0x1e6d0,0x34,0x80000000,0x80000000
.long 0x1e6e0,0x38,0x80000000,0x80000000,0x1e6f0,0x3c,0x80000000,0x80000000
.long 0x1e700,0x40,0x10,0x480,0x1e710,0x44,0x14,0x482
.long 0x1e720,0x48,0x18,0x484,0x1e730,0x4c,0x1c,0x486
.long 0x1e740,0x50,0x90,0x488,0x1e750,0x54,0x94,0x48a
.long 0x1e760,0x58,0x98,0x48c,0x1e770,0x5c,0x9c,0x48e
.long 0x1e780,0x60,0x80000000,0x80000000,0x1e790,0x64,0x80000000,0x80000000
.long 0x1e7a0,0x68,0x80000000,0x80000000,0x1e7b0,0x6c,0x80000000,0x80000000
.long 0x1e7c0,0x70,0x80000000,0x80000000,0x1e7d0,0x74,0x80000000,0x80000000
.long 0x1e7e0,0x78,0x80000000,0x80000000,0x1e7f0,0x7c,0x80000000,0x80000000
.long 0x1e800,0x80,0x20,0x900,0x1e810,0x84,0x24,0x902
.long 0x1e820,0x88,0x28,0x904,0x1e830,0x8c,0x2c,0x906
.long 0x1e840,0x90,0xa0,0x908,0x1e850,0x94,0xa4,0x90a
.long 0x1e860,0x98,0xa8,0x90c,0x1e870,0x9c,0xac,0x90e
.long 0x1e880,0xa0,0x80000000,0x80000000,0x1e890,0xa4,0x80000000,0x80000000
.long 0x1e8a0,0xa8,0x80000000,0x80000000,0x1e8b0,0xac,0x80000000,0x80000000
.long 0x1e8c0,0xb0,0x80000000,0x80000000,0x1e8d0,0xb4,0x80000000,0x80000000
.long 0x1e8e0,0xb8,0x80000000,0x80000000,0x1e8f0,0xbc,0x80000000,0x80000000
.long 0x1e900,0xc0,0x30,0xd80,0x1e910,0xc4,0x34,0xd82
.long 0x1e920,0xc8,0x38,0xd84,0x1e930,0xcc,0x3c,0xd86
.long 0x1e940,0xd0,0xb0,0xd88,0x1e950,0xd4,0xb4,0xd8a
.long 0x1e960,0xd8,0xb8,0xd8c,0x1e970,0xdc,0xbc,0xd8e
.long 0x1e980,0xe0,0x80000000,0x80000000,0x1e990,0xe4,0x80000000,0x80000000
.long 0x1e9a0,0xe8,0x80000000,0x80000000,0x1e9b0,0xec,0x80000000,0x80000000
.long 0x1e9c0,0xf0,0x80000000,0x80000000,0x1e9d0,0xf4,0x80000000,0x80000000
.long 0x1e9e0,0xf8,0x80000000,0x80000000,0x1e9f0,0xfc,0x80000000,0x80000000
.long 0x0,0x40,0x0,0x40,0x10,0x50,0x10,0x50
.long 0x20,0x60,0x20,0x60,0x30,0x70,0x30,0x70
.long 0x40,0x0,0x40,0x0,0x50,0x10,0x50,0x10
.long 0x60,0x20,0x60,0x20,0x70,0x30,0x70,0x30
.long 0x2000,0x2040,0x480,0x4c0,0x2010,0x2050,0x490,0x4d0
.long 0x2020,0x2060,0x4a0,0x4e0,0x2030,0x2070,0x4b0,0x4f0
.long 0x2040,0x2000,0x4c0,0x480,0x2050,0x2010,0x4d0,0x490
.long 0x2060,0x2020,0x4e0,0x4a0,0x2070,0x2030,0x4f0,0x4b0
.long 0x4000,0x4040,0x900,0x940,0x4010,0x4050,0x910,0x950
.long 0x4020,0x4060,0x920,0x960,0x4030,0x4070,0x930,0x970
.long 0x4040,0x4000,0x940,0x900,0x4050,0x4010,0x950,0x910
.long 0x4060,0x4020,0x960,0x920,0x4070,0x4030,0x970,0x930
.long 0x6000,0x6040,0xd80,0xdc0,0x6010,0x6050,0xd90,0xdd0
.long 0x6020,0x6060,0xda0,0xde0,0x6030,0x6070,0xdb0,0xdf0
.long 0x6040,0x6000,0xdc0,0xd80,0x6050,0x6010,0xdd0,0xd90
.long 0x6060,0x6020,0xde0,0xda0,0x6070,0x6030,0xdf0,0xdb0
.long 0x8020,0x8060,0x1200,0x1240,0x8030,0x8070,0x1210,0x1250
.long 0x8000,0x8040,0x1220,0x1260,0x8010,0x8050,0x1230,0x1270
.long 0x8060,0x8020,0x1240,0x1200,0x8070,0x8030,0x1250,0x1210
.long 0x8040,0x8000,0x1260,0x1220,0x8050,0x8010,0x1270,0x1230
.long 0xa020,0xa060,0x1680,0x16c0,0xa030,0xa070,0x1690,0x16d0
.long 0xa000,0xa040,0x16a0,0x16e0,0xa010,0xa050,0x16b0,0x16f0
.long 0xa060,0xa020,0x16c0,0x1680,0xa070,0xa030,0x16d0,0x1690
.long 0xa040,0xa000,0x16e0,0x16a0,0xa050,0xa010,0x16f0,0x16b0
.long 0xc020,0xc060,0x1b00,0x1b40,0xc030,0xc070,0x1b10,0x1b50
.long 0xc000,0xc040,0x1b20,0x1b60,0xc010,0xc050,0x1b30,0x1b70
.long 0xc060,0xc020,0x1b40,0x1b00,0xc070,0xc030,0x1b50,0x1b10
.long 0xc040,0xc000,0x1b60,0x1b20,0xc050,0xc010,0x1b70,0x1b30
.long 0xe020,0xe060,0x1f80,0x1fc0,0xe030,0xe070,0x1f90,0x1fd0
.long 0xe000,0xe040,0x1fa0,0x1fe0,0xe010,0xe050,0x1fb0,0x1ff0
.long 0xe060,0xe020,0x1fc0,0x1f80,0xe070,0xe030,0x1fd0,0x1f90
.long 0xe040,0xe000,0x1fe0,0x1fa0,0xe050,0xe010,0x1ff0,0x1fb0
.long 0x0,0x20,0x0,0x0,0x10,0x30,0x8,0x8
.long 0x20,0x0,0x20,0x10,0x30,0x10,0x28,0x18
.long 0x40,0x60,0x840,0x840,0x50,0x70,0x848,0x848
.long 0x60,0x40,0x860,0x850,0x70,0x50,0x868,0x858
.long 0x480,0x4a0,0x220,0x220,0x490,0x4b0,0x228,0x228
.long 0x4a0,0x480,0x200,0x230,0x4b0,0x490,0x208,0x238
.long 0x4c0,0x4e0,0xa60,0xa60,0x4d0,0x4f0,0xa68,0xa68
.long 0x4e0,0x4c0,0xa40,0xa70,0x4f0,0x4d0,0xa48,0xa78
.long 0x900,0x920,0x100,0x100,0x910,0x930,0x108,0x108
.long 0x920,0x900,0x120,0x110,0x930,0x910,0x128,0x118
.long 0x940,0x960,0x940,0x940,0x950,0x970,0x948,0x948
.long 0x960,0x940,0x960,0x950,0x970,0x950,0x968,0x958
.long 0xd80,0xda0,0x320,0x320,0xd90,0xdb0,0x328,0x328
.long 0xda0,0xd80,0x300,0x330,0xdb0,0xd90,0x308,0x338
.long 0xdc0,0xde0,0xb60,0xb60,0xdd0,0xdf0,0xb68,0xb68
.long 0xde0,0xdc0,0xb40,0xb70,0xdf0,0xdd0,0xb48,0xb78
.long 0x1200,0x1220,0x400,0x400,0x1210,0x1230,0x408,0x408
.long 0x1220,0x1200,0x420,0x410,0x1230,0x1210,0x428,0x418
.long 0x1240,0x1260,0xc40,0xc40,0x1250,0x1270,0xc48,0xc48
.long 0x1260,0x1240,0xc60,0xc50,0x1270,0x1250,0xc68,0xc58
.long 0x1680,0x16a0,0x620,0x620,0x1690,0x16b0,0x628,0x628
.long 0x16a0,0x1680,0x600,0x630,0x16b0,0x1690,0x608,0x638
.long 0x16c0,0x16e0,0xe60,0xe60,0x16d0,0x16f0,0xe68,0xe68
.long 0x16e0,0x16c0,0xe40,0xe70,0x16f0,0x16d0,0xe48,0xe78
.long 0x1b00,0x1b20,0x500,0x500,0x1b10,0x1b30,0x508,0x508
.long 0x1b20,0x1b00,0x520,0x510,0x1b30,0x1b10,0x528,0x518
.long 0x1b40,0x1b60,0xd40,0xd40,0x1b50,0x1b70,0xd48,0xd48
.long 0x1b60,0x1b40,0xd60,0xd50,0x1b70,0x1b50,0xd68,0xd58
.long 0x1f80,0x1fa0,0x720,0x720,0x1f90,0x1fb0,0x728,0x728
.long 0x1fa0,0x1f80,0x700,0x730,0x1fb0,0x1f90,0x708,0x738
.long 0x1fc0,0x1fe0,0xf60,0xf60,0x1fd0,0x1ff0,0xf68,0xf68
.long 0x1fe0,0x1fc0,0xf40,0xf70,0x1ff0,0x1fd0,0xf48,0xf78
.long 0x0,0x1800,0x0,0x0,0x8,0x1808,0x8,0x8
.long 0x10,0x1810,0x20,0x10,0x18,0x1818,0x28,0x18
.long 0x80,0x1880,0x80,0x80,0x88,0x1888,0x88,0x88
.long 0x90,0x1890,0xa0,0x90,0x98,0x1898,0xa8,0x98
.long 0x40,0xb240,0x440,0x440,0x48,0xb248,0x448,0x448
.long 0x50,0xb250,0x460,0x450,0x58,0xb258,0x468,0x458
.long 0xc0,0xb2c0,0x4c0,0x4c0,0xc8,0xb2c8,0x4c8,0x4c8
.long 0xd0,0xb2d0,0x4e0,0x4d0,0xd8,0xb2d8,0x4e8,0x4d8
.long 0x840,0x2020,0x220,0x220,0x848,0x2028,0x228,0x228
.long 0x850,0x2030,0x200,0x230,0x858,0x2038,0x208,0x238
.long 0x8c0,0x20a0,0x2a0,0x2a0,0x8c8,0x20a8,0x2a8,0x2a8
.long 0x8d0,0x20b0,0x280,0x2b0,0x8d8,0x20b8,0x288,0x2b8
.long 0x800,0xba60,0x660,0x660,0x808,0xba68,0x668,0x668
.long 0x810,0xba70,0x640,0x670,0x818,0xba78,0x648,0x678
.long 0x880,0xbae0,0x6e0,0x6e0,0x888,0xbae8,0x6e8,0x6e8
.long 0x890,0xbaf0,0x6c0,0x6f0,0x898,0xbaf8,0x6c8,0x6f8
.long 0x200,0x1a00,0x800,0x800,0x208,0x1a08,0x808,0x808
.long 0x210,0x1a10,0x820,0x810,0x218,0x1a18,0x828,0x818
.long 0x280,0x1a80,0x880,0x880,0x288,0x1a88,0x888,0x888
.long 0x290,0x1a90,0x8a0,0x890,0x298,0x1a98,0x8a8,0x898
.long 0x240,0xb440,0xc40,0xc40,0x248,0xb448,0xc48,0xc48
.long 0x250,0xb450,0xc60,0xc50,0x258,0xb458,0xc68,0xc58
.long 0x2c0,0xb4c0,0xcc0,0xcc0,0x2c8,0xb4c8,0xcc8,0xcc8
.long 0x2d0,0xb4d0,0xce0,0xcd0,0x2d8,0xb4d8,0xce8,0xcd8
.long 0xa40,0x2220,0xa20,0xa20,0xa48,0x2228,0xa28,0xa28
.long 0xa50,0x2230,0xa00,0xa30,0xa58,0x2238,0xa08,0xa38
.long 0xac0,0x22a0,0xaa0,0xaa0,0xac8,0x22a8,0xaa8,0xaa8
.long 0xad0,0x22b0,0xa80,0xab0,0xad8,0x22b8,0xa88,0xab8
.long 0xa00,0xbc60,0xe60,0xe60,0xa08,0xbc68,0xe68,0xe68
.long 0xa10,0xbc70,0xe40,0xe70,0xa18,0xbc78,0xe48,0xe78
.long 0xa80,0xbce0,0xee0,0xee0,0xa88,0xbce8,0xee8,0xee8
.long 0xa90,0xbcf0,0xec0,0xef0,0xa98,0xbcf8,0xec8,0xef8
.long 0x3f80,0x0,0x0,0x0,0x3f800000,0x0,0x0,0x0
.long 0x0,0x3f80,0x0,0x0,0x0,0x3f800000,0x0,0x0
.long 0x0,0x0,0x0,0x0,0x0,0x0,0x0,0x0
.long 0x0,0x0,0x0,0x0,0x0,0x0,0x0,0x0
.long 0x0,0x0,0x3f80,0x0,0x0,0x0,0x3f800000,0x0
.long 0x0,0x0,0x0,0x3f80,0x0,0x0,0x0,0x3f800000
.long 0x0,0x0,0x0,0x0,0x0,0x0,0x0,0x0
.long 0x0,0x0,0x0,0x0,0x0,0x0,0x0,0x0
.long 0x0,0x0,0x0,0x0,0x0,0x0,0x0,0x0
.long 0x0,0x0,0x0,0x0,0x0,0x0,0x0,0x0
.long 0x3f80,0x0,0x0,0x0,0x3f800000,0x0,0x0,0x0
.long 0x0,0x3f80,0x0,0x0,0x0,0x3f800000,0x0,0x0
.long 0x0,0x0,0x0,0x0,0x0,0x0,0x0,0x0
.long 0x0,0x0,0x0,0x0,0x0,0x0,0x0,0x0
.long 0x0,0x0,0x3f80,0x0,0x0,0x0,0x3f800000,0x0
.long 0x0,0x0,0x0,0x3f80,0x0,0x0,0x0,0x3f800000
.long 0x3f80,0x0,0x0,0x0,0x3f800000,0x0,0x0,0x0
.long 0x0,0x3f80,0x0,0x0,0x0,0x3f800000,0x0,0x0
.long 0x0,0x0,0x0,0x0,0x0,0x0,0x0,0x0
.long 0x0,0x0,0x0,0x0,0x0,0x0,0x0,0x0
.long 0x0,0x0,0x3f80,0x0,0x0,0x0,0x3f800000,0x0
.long 0x0,0x0,0x0,0x3f80,0x0,0x0,0x0,0x3f800000
.long 0x0,0x0,0x0,0x0,0x0,0x0,0x0,0x0
.long 0x0,0x0,0x0,0x0,0x0,0x0,0x0,0x0
.long 0x0,0x0,0x0,0x0,0x0,0x0,0x0,0x0
.long 0x0,0x0,0x0,0x0,0x0,0x0,0x0,0x0
.long 0x3f80,0x0,0x0,0x0,0x3f800000,0x0,0x0,0x0
.long 0x0,0x3f80,0x0,0x0,0x0,0x3f800000,0x0,0x0
.long 0x0,0x0,0x0,0x0,0x0,0x0,0x0,0x0
.long 0x0,0x0,0x0,0x0,0x0,0x0,0x0,0x0
.long 0x0,0x0,0x3f80,0x0,0x0,0x0,0x3f800000,0x0
.long 0x0,0x0,0x0,0x3f80,0x0,0x0,0x0,0x3f800000
.long 0xaa00,0x0,0x1de00,0x0,0xaa10,0x10,0x1de10,0x8
.long 0xaa20,0x20,0x1de20,0x10,0xaa30,0x30,0x1de30,0x18
.long 0xaa40,0x40,0x1de40,0x80,0xaa50,0x50,0x1de50,0x88
.long 0xaa60,0x60,0x1de60,0x90,0xaa70,0x70,0x1de70,0x98
.long 0x14400,0x2880,0x27800,0x100,0x14410,0x2890,0x27810,0x108
.long 0x14420,0x28a0,0x27820,0x110,0x14430,0x28b0,0x27830,0x118
.long 0x14440,0x28c0,0x27840,0x180,0x14450,0x28d0,0x27850,0x188
.long 0x14460,0x28e0,0x27860,0x190,0x14470,0x28f0,0x27870,0x198
.long 0xab00,0x5100,0x1df00,0x20,0xab10,0x5110,0x1df10,0x28
.long 0xab20,0x5120,0x1df20,0x30,0xab30,0x5130,0x1df30,0x38
.long 0xab40,0x5140,0x1df40,0xa0,0xab50,0x5150,0x1df50,0xa8
.long 0xab60,0x5160,0x1df60,0xb0,0xab70,0x5170,0x1df70,0xb8
.long 0x14500,0x7980,0x27900,0x120,0x14510,0x7990,0x27910,0x128
.long 0x14520,0x79a0,0x27920,0x130,0x14530,0x79b0,0x27930,0x138
.long 0x14540,0x79c0,0x27940,0x1a0,0x14550,0x79d0,0x27950,0x1a8
.long 0x14560,0x79e0,0x27960,0x1b0,0x14570,0x79f0,0x27970,0x1b8
.long 0xac00,0xa200,0x1e000,0x40,0xac10,0xa210,0x1e010,0x48
.long 0xac20,0xa220,0x1e020,0x50,0xac30,0xa230,0x1e030,0x58
.long 0xac40,0xa240,0x1e040,0xc0,0xac50,0xa250,0x1e050,0xc8
.long 0xac60,0xa260,0x1e060,0xd0,0xac70,0xa270,0x1e070,0xd8
.long 0x14600,0xca80,0x27a00,0x140,0x14610,0xca90,0x27a10,0x148
.long 0x14620,0xcaa0,0x27a20,0x150,0x14630,0xcab0,0x27a30,0x158
.long 0x14640,0xcac0,0x27a40,0x1c0,0x14650,0xcad0,0x27a50,0x1c8
.long 0x14660,0xcae0,0x27a60,0x1d0,0x14670,0xcaf0,0x27a70,0x1d8
.long 0xad00,0xf300,0x1e100,0x60,0xad10,0xf310,0x1e110,0x68
.long 0xad20,0xf320,0x1e120,0x70,0xad30,0xf330,0x1e130,0x78
.long 0xad40,0xf340,0x1e140,0xe0,0xad50,0xf350,0x1e150,0xe8
.long 0xad60,0xf360,0x1e160,0xf0,0xad70,0xf370,0x1e170,0xf8
.long 0x14700,0x11b80,0x27b00,0x160,0x14710,0x11b90,0x27b10,0x168
.long 0x14720,0x11ba0,0x27b20,0x170,0x14730,0x11bb0,0x27b30,0x178
.long 0x14740,0x11bc0,0x27b40,0x1e0,0x14750,0x11bd0,0x27b50,0x1e8
.long 0x14760,0x11be0,0x27b60,0x1f0,0x14770,0x11bf0,0x27b70,0x1f8
.long 0x4444,0xb200,0x1800,0x1e600,0x4444,0xb210,0x1810,0x1e610
.long 0x4444,0xb220,0x1820,0x1e620,0x4444,0xb230,0x1830,0x1e630
.long 0x4444,0xb240,0x1840,0x1e640,0x4444,0xb250,0x1850,0x1e650
.long 0x4444,0xb260,0x1860,0x1e660,0x4444,0xb270,0x1870,0x1e670
.long 0xeeee,0xb280,0x1880,0x1e680,0xeeee,0xb290,0x1890,0x1e690
.long 0xeeee,0xb2a0,0x18a0,0x1e6a0,0xeeee,0xb2b0,0x18b0,0x1e6b0
.long 0xeeee,0xb2c0,0x18c0,0x1e6c0,0xeeee,0xb2d0,0x18d0,0x1e6d0
.long 0xeeee,0xb2e0,0x18e0,0x1e6e0,0xeeee,0xb2f0,0x18f0,0x1e6f0
.long 0x4444,0xb300,0x1900,0x1e700,0x4444,0xb310,0x1910,0x1e710
.long 0x4444,0xb320,0x1920,0x1e720,0x4444,0xb330,0x1930,0x1e730
.long 0x4444,0xb340,0x1940,0x1e740,0x4444,0xb350,0x1950,0x1e750
.long 0x4444,0xb360,0x1960,0x1e760,0x4444,0xb370,0x1970,0x1e770
.long 0xeeee,0xb380,0x1980,0x1e780,0xeeee,0xb390,0x1990,0x1e790
.long 0xeeee,0xb3a0,0x19a0,0x1e7a0,0xeeee,0xb3b0,0x19b0,0x1e7b0
.long 0xeeee,0xb3c0,0x19c0,0x1e7c0,0xeeee,0xb3d0,0x19d0,0x1e7d0
.long 0xeeee,0xb3e0,0x19e0,0x1e7e0,0xeeee,0xb3f0,0x19f0,0x1e7f0
.long 0x4444,0xb400,0x1a00,0x1e800,0x4444,0xb410,0x1a10,0x1e810
.long 0x4444,0xb420,0x1a20,0x1e820,0x4444,0xb430,0x1a30,0x1e830
.long 0x4444,0xb440,0x1a40,0x1e840,0x4444,0xb450,0x1a50,0x1e850
.long 0x4444,0xb460,0x1a60,0x1e860,0x4444,0xb470,0x1a70,0x1e870
.long 0xeeee,0xb480,0x1a80,0x1e880,0xeeee,0xb490,0x1a90,0x1e890
.long 0xeeee,0xb4a0,0x1aa0,0x1e8a0,0xeeee,0xb4b0,0x1ab0,0x1e8b0
.long 0xeeee,0xb4c0,0x1ac0,0x1e8c0,0xeeee,0xb4d0,0x1ad0,0x1e8d0
.long 0xeeee,0xb4e0,0x1ae0,0x1e8e0,0xeeee,0xb4f0,0x1af0,0x1e8f0
.long 0x4444,0xb500,0x1b00,0x1e900,0x4444,0xb510,0x1b10,0x1e910
.long 0x4444,0xb520,0x1b20,0x1e920,0x4444,0xb530,0x1b30,0x1e930
.long 0x4444,0xb540,0x1b40,0x1e940,0x4444,0xb550,0x1b50,0x1e950
.long 0x4444,0xb560,0x1b60,0x1e960,0x4444,0xb570,0x1b70,0x1e970
.long 0xeeee,0xb580,0x1b80,0x1e980,0xeeee,0xb590,0x1b90,0x1e990
.long 0xeeee,0xb5a0,0x1ba0,0x1e9a0,0xeeee,0xb5b0,0x1bb0,0x1e9b0
.long 0xeeee,0xb5c0,0x1bc0,0x1e9c0,0xeeee,0xb5d0,0x1bd0,0x1e9d0
.long 0xeeee,0xb5e0,0x1be0,0x1e9e0,0xeeee,0xb5f0,0x1bf0,0x1e9f0
.long 0x14c00,0x100,0x0,0x0,0x14c10,0x104,0x4,0x4
.long 0x14c20,0x108,0x40,0x1200,0x14c30,0x10c,0x44,0x1204
.long 0x14c40,0x110,0x400,0x0,0x14c50,0x114,0x404,0x4
.long 0x14c60,0x118,0x440,0x1200,0x14c70,0x11c,0x444,0x1204
.long 0x14c80,0x120,0x800,0x0,0x14c90,0x124,0x804,0x4
.long 0x14ca0,0x128,0x840,0x1200,0x14cb0,0x12c,0x844,0x1204
.long 0x14cc0,0x130,0xc00,0x0,0x14cd0,0x134,0xc04,0x4
.long 0x14ce0,0x138,0xc40,0x1200,0x14cf0,0x13c,0xc44,0x1204
.long 0x14d00,0x140,0x10,0x480,0x14d10,0x144,0x14,0x484
.long 0x14d20,0x148,0x50,0x1680,0x14d30,0x14c,0x54,0x1684
.long 0x14d40,0x150,0x410,0x480,0x14d50,0x154,0x414,0x484
.long 0x14d60,0x158,0x450,0x1680,0x14d70,0x15c,0x454,0x1684
.long 0x14d80,0x160,0x810,0x480,0x14d90,0x164,0x814,0x484
.long 0x14da0,0x168,0x850,0x1680,0x14db0,0x16c,0x854,0x1684
.long 0x14dc0,0x170,0xc10,0x480,0x14dd0,0x174,0xc14,0x484
.long 0x14de0,0x178,0xc50,0x1680,0x14df0,0x17c,0xc54,0x1684
.long 0x14e00,0x180,0x20,0x900,0x14e10,0x184,0x24,0x904
.long 0x14e20,0x188,0x60,0x1b00,0x14e30,0x18c,0x64,0x1b04
.long 0x14e40,0x190,0x420,0x900,0x14e50,0x194,0x424,0x904
.long 0x14e60,0x198,0x460,0x1b00,0x14e70,0x19c,0x464,0x1b04
.long 0x14e80,0x1a0,0x820,0x900,0x14e90,0x1a4,0x824,0x904
.long 0x14ea0,0x1a8,0x860,0x1b00,0x14eb0,0x1ac,0x864,0x1b04
.long 0x14ec0,0x1b0,0xc20,0x900,0x14ed0,0x1b4,0xc24,0x904
.long 0x14ee0,0x1b8,0xc60,0x1b00,0x14ef0,0x1bc,0xc64,0x1b04
.long 0x14f00,0x1c0,0x30,0xd80,0x14f10,0x1c4,0x34,0xd84
.long 0x14f20,0x1c8,0x70,0x1f80,0x14f30,0x1cc,0x74,0x1f84
.long 0x14f40,0x1d0,0x430,0xd80,0x14f50,0x1d4,0x434,0xd84
.long 0x14f60,0x1d8,0x470,0x1f80,0x14f70,0x1dc,0x474,0x1f84
.long 0x14f80,0x1e0,0x830,0xd80,0x14f90,0x1e4,0x834,0xd84
.long 0x14fa0,0x1e8,0x870,0x1f80,0x14fb0,0x1ec,0x874,0x1f84
.long 0x14fc0,0x1f0,0xc30,0xd80,0x14fd0,0x1f4,0xc34,0xd84
.long 0x14fe0,0x1f8,0xc70,0x1f80,0x14ff0,0x1fc,0xc74,0x1f84
.long 0x0,0x40,0x0,0x40,0x10,0x50,0x10,0x50
.long 0x20,0x60,0x20,0x60,0x30,0x70,0x30,0x70
.long 0x40,0x0,0x40,0x0,0x50,0x10,0x50,0x10
.long 0x60,0x20,0x60,0x20,0x70,0x30,0x70,0x30
.long 0x2000,0x2040,0x480,0x4c0,0x2010,0x2050,0x490,0x4d0
.long 0x2020,0x2060,0x4a0,0x4e0,0x2030,0x2070,0x4b0,0x4f0
.long 0x2040,0x2000,0x4c0,0x480,0x2050,0x2010,0x4d0,0x490
.long 0x2060,0x2020,0x4e0,0x4a0,0x2070,0x2030,0x4f0,0x4b0
.long 0x4000,0x4040,0x900,0x940,0x4010,0x4050,0x910,0x950
.long 0x4020,0x4060,0x920,0x960,0x4030,0x4070,0x930,0x970
.long 0x4040,0x4000,0x940,0x900,0x4050,0x4010,0x950,0x910
.long 0x4060,0x4020,0x960,0x920,0x4070,0x4030,0x970,0x930
.long 0x6000,0x6040,0xd80,0xdc0,0x6010,0x6050,0xd90,0xdd0
.long 0x6020,0x6060,0xda0,0xde0,0x6030,0x6070,0xdb0,0xdf0
.long 0x6040,0x6000,0xdc0,0xd80,0x6050,0x6010,0xdd0,0xd90
.long 0x6060,0x6020,0xde0,0xda0,0x6070,0x6030,0xdf0,0xdb0
.long 0x8020,0x8060,0x1200,0x1240,0x8030,0x8070,0x1210,0x1250
.long 0x8000,0x8040,0x1220,0x1260,0x8010,0x8050,0x1230,0x1270
.long 0x8060,0x8020,0x1240,0x1200,0x8070,0x8030,0x1250,0x1210
.long 0x8040,0x8000,0x1260,0x1220,0x8050,0x8010,0x1270,0x1230
.long 0xa020,0xa060,0x1680,0x16c0,0xa030,0xa070,0x1690,0x16d0
.long 0xa000,0xa040,0x16a0,0x16e0,0xa010,0xa050,0x16b0,0x16f0
.long 0xa060,0xa020,0x16c0,0x1680,0xa070,0xa030,0x16d0,0x1690
.long 0xa040,0xa000,0x16e0,0x16a0,0xa050,0xa010,0x16f0,0x16b0
.long 0xc020,0xc060,0x1b00,0x1b40,0xc030,0xc070,0x1b10,0x1b50
.long 0xc000,0xc040,0x1b20,0x1b60,0xc010,0xc050,0x1b30,0x1b70
.long 0xc060,0xc020,0x1b40,0x1b00,0xc070,0xc030,0x1b50,0x1b10
.long 0xc040,0xc000,0x1b60,0x1b20,0xc050,0xc010,0x1b70,0x1b30
.long 0xe020,0xe060,0x1f80,0x1fc0,0xe030,0xe070,0x1f90,0x1fd0
.long 0xe000,0xe040,0x1fa0,0x1fe0,0xe010,0xe050,0x1fb0,0x1ff0
.long 0xe060,0xe020,0x1fc0,0x1f80,0xe070,0xe030,0x1fd0,0x1f90
.long 0xe040,0xe000,0x1fe0,0x1fa0,0xe050,0xe010,0x1ff0,0x1fb0
.long 0x40,0x60,0x40,0x40,0x50,0x70,0x48,0x48
.long 0x60,0x40,0x60,0x50,0x70,0x50,0x68,0x58
.long 0x0,0x20,0x800,0x800,0x10,0x30,0x808,0x808
.long 0x20,0x0,0x820,0x810,0x30,0x10,0x828,0x818
.long 0x4c0,0x4e0,0x260,0x260,0x4d0,0x4f0,0x268,0x268
.long 0x4e0,0x4c0,0x240,0x270,0x4f0,0x4d0,0x248,0x278
.long 0x480,0x4a0,0xa20,0xa20,0x490,0x4b0,0xa28,0xa28
.long 0x4a0,0x480,0xa00,0xa30,0x4b0,0x490,0xa08,0xa38
.long 0x940,0x960,0x140,0x140,0x950,0x970,0x148,0x148
.long 0x960,0x940,0x160,0x150,0x970,0x950,0x168,0x158
.long 0x900,0x920,0x900,0x900,0x910,0x930,0x908,0x908
.long 0x920,0x900,0x920,0x910,0x930,0x910,0x928,0x918
.long 0xdc0,0xde0,0x360,0x360,0xdd0,0xdf0,0x368,0x368
.long 0xde0,0xdc0,0x340,0x370,0xdf0,0xdd0,0x348,0x378
.long 0xd80,0xda0,0xb20,0xb20,0xd90,0xdb0,0xb28,0xb28
.long 0xda0,0xd80,0xb00,0xb30,0xdb0,0xd90,0xb08,0xb38
.long 0x1240,0x1260,0x440,0x440,0x1250,0x1270,0x448,0x448
.long 0x1260,0x1240,0x460,0x450,0x1270,0x1250,0x468,0x458
.long 0x1200,0x1220,0xc00,0xc00,0x1210,0x1230,0xc08,0xc08
.long 0x1220,0x1200,0xc20,0xc10,0x1230,0x1210,0xc28,0xc18
.long 0x16c0,0x16e0,0x660,0x660,0x16d0,0x16f0,0x668,0x668
.long 0x16e0,0x16c0,0x640,0x670,0x16f0,0x16d0,0x648,0x678
.long 0x1680,0x16a0,0xe20,0xe20,0x1690,0x16b0,0xe28,0xe28
.long 0x16a0,0x1680,0xe00,0xe30,0x16b0,0x1690,0xe08,0xe38
.long 0x1b40,0x1b60,0x540,0x540,0x1b50,0x1b70,0x548,0x548
.long 0x1b60,0x1b40,0x560,0x550,0x1b70,0x1b50,0x568,0x558
.long 0x1b00,0x1b20,0xd00,0xd00,0x1b10,0x1b30,0xd08,0xd08
.long 0x1b20,0x1b00,0xd20,0xd10,0x1b30,0x1b10,0xd28,0xd18
.long 0x1fc0,0x1fe0,0x760,0x760,0x1fd0,0x1ff0,0x768,0x768
.long 0x1fe0,0x1fc0,0x740,0x770,0x1ff0,0x1fd0,0x748,0x778
.long 0x1f80,0x1fa0,0xf20,0xf20,0x1f90,0x1fb0,0xf28,0xf28
.long 0x1fa0,0x1f80,0xf00,0xf30,0x1fb0,0x1f90,0xf08,0xf38
.long 0x0,0x1820,0x40,0x40,0x8,0x1828,0x48,0x48
.long 0x10,0x1830,0x60,0x50,0x18,0x1838,0x68,0x58
.long 0x80,0x18a0,0xc0,0xc0,0x88,0x18a8,0xc8,0xc8
.long 0x90,0x18b0,0xe0,0xd0,0x98,0x18b8,0xe8,0xd8
.long 0x40,0xb260,0x400,0x400,0x48,0xb268,0x408,0x408
.long 0x50,0xb270,0x420,0x410,0x58,0xb278,0x428,0x418
.long 0xc0,0xb2e0,0x480,0x480,0xc8,0xb2e8,0x488,0x488
.long 0xd0,0xb2f0,0x4a0,0x490,0xd8,0xb2f8,0x4a8,0x498
.long 0x840,0x2000,0x260,0x260,0x848,0x2008,0x268,0x268
.long 0x850,0x2010,0x240,0x270,0x858,0x2018,0x248,0x278
.long 0x8c0,0x2080,0x2e0,0x2e0,0x8c8,0x2088,0x2e8,0x2e8
.long 0x8d0,0x2090,0x2c0,0x2f0,0x8d8,0x2098,0x2c8,0x2f8
.long 0x800,0xba40,0x620,0x620,0x808,0xba48,0x628,0x628
.long 0x810,0xba50,0x600,0x630,0x818,0xba58,0x608,0x638
.long 0x880,0xbac0,0x6a0,0x6a0,0x888,0xbac8,0x6a8,0x6a8
.long 0x890,0xbad0,0x680,0x6b0,0x898,0xbad8,0x688,0x6b8
.long 0x200,0x1a20,0x840,0x840,0x208,0x1a28,0x848,0x848
.long 0x210,0x1a30,0x860,0x850,0x218,0x1a38,0x868,0x858
.long 0x280,0x1aa0,0x8c0,0x8c0,0x288,0x1aa8,0x8c8,0x8c8
.long 0x290,0x1ab0,0x8e0,0x8d0,0x298,0x1ab8,0x8e8,0x8d8
.long 0x240,0xb460,0xc00,0xc00,0x248,0xb468,0xc08,0xc08
.long 0x250,0xb470,0xc20,0xc10,0x258,0xb478,0xc28,0xc18
.long 0x2c0,0xb4e0,0xc80,0xc80,0x2c8,0xb4e8,0xc88,0xc88
.long 0x2d0,0xb4f0,0xca0,0xc90,0x2d8,0xb4f8,0xca8,0xc98
.long 0xa40,0x2200,0xa60,0xa60,0xa48,0x2208,0xa68,0xa68
.long 0xa50,0x2210,0xa40,0xa70,0xa58,0x2218,0xa48,0xa78
.long 0xac0,0x2280,0xae0,0xae0,0xac8,0x2288,0xae8,0xae8
.long 0xad0,0x2290,0xac0,0xaf0,0xad8,0x2298,0xac8,0xaf8
.long 0xa00,0xbc40,0xe20,0xe20,0xa08,0xbc48,0xe28,0xe28
.long 0xa10,0xbc50,0xe00,0xe30,0xa18,0xbc58,0xe08,0xe38
.long 0xa80,0xbcc0,0xea0,0xea0,0xa88,0xbcc8,0xea8,0xea8
.long 0xa90,0xbcd0,0xe80,0xeb0,0xa98,0xbcd8,0xe88,0xeb8
.long 0x3f80,0x0,0x0,0x0,0x0,0x0,0x3f80,0x0
.long 0x0,0x0,0x0,0x0,0x0,0x0,0x0,0x0
.long 0x3f800000,0x0,0x0,0x0,0x0,0x0,0x3f800000,0x0
.long 0x0,0x0,0x0,0x0,0x0,0x0,0x0,0x0
.long 0x0,0x3f80,0x0,0x0,0x0,0x0,0x0,0x3f80
.long 0x0,0x0,0x0,0x0,0x0,0x0,0x0,0x0
.long 0x0,0x3f800000,0x0,0x0,0x0,0x0,0x0,0x3f800000
.long 0x0,0x0,0x0,0x0,0x0,0x0,0x0,0x0
.long 0x3f80,0x0,0x0,0x0,0x0,0x0,0x3f80,0x0
.long 0x0,0x0,0x0,0x0,0x0,0x0,0x0,0x0
.long 0x3f800000,0x0,0x0,0x0,0x0,0x0,0x3f800000,0x0
.long 0x0,0x0,0x0,0x0,0x0,0x0,0x0,0x0
.long 0x0,0x3f80,0x0,0x0,0x0,0x0,0x0,0x3f80
.long 0x0,0x0,0x0,0x0,0x0,0x0,0x0,0x0
.long 0x0,0x3f800000,0x0,0x0,0x0,0x0,0x0,0x3f800000
.long 0x0,0x0,0x0,0x0,0x0,0x0,0x0,0x0
.long 0x3f80,0x0,0x0,0x0,0x0,0x0,0x3f80,0x0
.long 0x0,0x0,0x0,0x0,0x0,0x0,0x0,0x0
.long 0x3f800000,0x0,0x0,0x0,0x0,0x0,0x3f800000,0x0
.long 0x0,0x0,0x0,0x0,0x0,0x0,0x0,0x0
.long 0x0,0x3f80,0x0,0x0,0x0,0x0,0x0,0x3f80
.long 0x0,0x0,0x0,0x0,0x0,0x0,0x0,0x0
.long 0x0,0x3f800000,0x0,0x0,0x0,0x0,0x0,0x3f800000
.long 0x0,0x0,0x0,0x0,0x0,0x0,0x0,0x0
.long 0x3f80,0x0,0x0,0x0,0x0,0x0,0x3f80,0x0
.long 0x0,0x0,0x0,0x0,0x0,0x0,0x0,0x0
.long 0x3f800000,0x0,0x0,0x0,0x0,0x0,0x3f800000,0x0
.long 0x0,0x0,0x0,0x0,0x0,0x0,0x0,0x0
.long 0x0,0x3f80,0x0,0x0,0x0,0x0,0x0,0x3f80
.long 0x0,0x0,0x0,0x0,0x0,0x0,0x0,0x0
.long 0x0,0x3f800000,0x0,0x0,0x0,0x0,0x0,0x3f800000
.long 0x0,0x0,0x0,0x0,0x0,0x0,0x0,0x0
.long 0xaa00,0x0,0x1de00,0x0,0xaa10,0x10,0x1de10,0x8
.long 0xaa20,0x20,0x1de20,0x10,0xaa30,0x30,0x1de30,0x18
.long 0xaa40,0x40,0x1de40,0x80,0xaa50,0x50,0x1de50,0x88
.long 0xaa60,0x60,0x1de60,0x90,0xaa70,0x70,0x1de70,0x98
.long 0x14400,0x2880,0x27800,0x100,0x14410,0x2890,0x27810,0x108
.long 0x14420,0x28a0,0x27820,0x110,0x14430,0x28b0,0x27830,0x118
.long 0x14440,0x28c0,0x27840,0x180,0x14450,0x28d0,0x27850,0x188
.long 0x14460,0x28e0,0x27860,0x190,0x14470,0x28f0,0x27870,0x198
.long 0xab00,0x5100,0x1df00,0x20,0xab10,0x5110,0x1df10,0x28
.long 0xab20,0x5120,0x1df20,0x30,0xab30,0x5130,0x1df30,0x38
.long 0xab40,0x5140,0x1df40,0xa0,0xab50,0x5150,0x1df50,0xa8
.long 0xab60,0x5160,0x1df60,0xb0,0xab70,0x5170,0x1df70,0xb8
.long 0x14500,0x7980,0x27900,0x120,0x14510,0x7990,0x27910,0x128
.long 0x14520,0x79a0,0x27920,0x130,0x14530,0x79b0,0x27930,0x138
.long 0x14540,0x79c0,0x27940,0x1a0,0x14550,0x79d0,0x27950,0x1a8
.long 0x14560,0x79e0,0x27960,0x1b0,0x14570,0x79f0,0x27970,0x1b8
.long 0xac00,0xa200,0x1e000,0x40,0xac10,0xa210,0x1e010,0x48
.long 0xac20,0xa220,0x1e020,0x50,0xac30,0xa230,0x1e030,0x58
.long 0xac40,0xa240,0x1e040,0xc0,0xac50,0xa250,0x1e050,0xc8
.long 0xac60,0xa260,0x1e060,0xd0,0xac70,0xa270,0x1e070,0xd8
.long 0x14600,0xca80,0x27a00,0x140,0x14610,0xca90,0x27a10,0x148
.long 0x14620,0xcaa0,0x27a20,0x150,0x14630,0xcab0,0x27a30,0x158
.long 0x14640,0xcac0,0x27a40,0x1c0,0x14650,0xcad0,0x27a50,0x1c8
.long 0x14660,0xcae0,0x27a60,0x1d0,0x14670,0xcaf0,0x27a70,0x1d8
.long 0xad00,0xf300,0x1e100,0x60,0xad10,0xf310,0x1e110,0x68
.long 0xad20,0xf320,0x1e120,0x70,0xad30,0xf330,0x1e130,0x78
.long 0xad40,0xf340,0x1e140,0xe0,0xad50,0xf350,0x1e150,0xe8
.long 0xad60,0xf360,0x1e160,0xf0,0xad70,0xf370,0x1e170,0xf8
.long 0x14700,0x11b80,0x27b00,0x160,0x14710,0x11b90,0x27b10,0x168
.long 0x14720,0x11ba0,0x27b20,0x170,0x14730,0x11bb0,0x27b30,0x178
.long 0x14740,0x11bc0,0x27b40,0x1e0,0x14750,0x11bd0,0x27b50,0x1e8
.long 0x14760,0x11be0,0x27b60,0x1f0,0x14770,0x11bf0,0x27b70,0x1f8
.long 0x4444,0x14c00,0x1e600,0x1800,0x4444,0x14c10,0x1e610,0x1810
.long 0x4444,0x14c20,0x1e620,0x1820,0x4444,0x14c30,0x1e630,0x1830
.long 0x4444,0x14c40,0x1e640,0x1840,0x4444,0x14c50,0x1e650,0x1850
.long 0x4444,0x14c60,0x1e660,0x1860,0x4444,0x14c70,0x1e670,0x1870
.long 0xeeee,0x14c80,0x1e680,0x1880,0xeeee,0x14c90,0x1e690,0x1890
.long 0xeeee,0x14ca0,0x1e6a0,0x18a0,0xeeee,0x14cb0,0x1e6b0,0x18b0
.long 0xeeee,0x14cc0,0x1e6c0,0x18c0,0xeeee,0x14cd0,0x1e6d0,0x18d0
.long 0xeeee,0x14ce0,0x1e6e0,0x18e0,0xeeee,0x14cf0,0x1e6f0,0x18f0
.long 0x4444,0x14d00,0x1e700,0x1900,0x4444,0x14d10,0x1e710,0x1910
.long 0x4444,0x14d20,0x1e720,0x1920,0x4444,0x14d30,0x1e730,0x1930
.long 0x4444,0x14d40,0x1e740,0x1940,0x4444,0x14d50,0x1e750,0x1950
.long 0x4444,0x14d60,0x1e760,0x1960,0x4444,0x14d70,0x1e770,0x1970
.long 0xeeee,0x14d80,0x1e780,0x1980,0xeeee,0x14d90,0x1e790,0x1990
.long 0xeeee,0x14da0,0x1e7a0,0x19a0,0xeeee,0x14db0,0x1e7b0,0x19b0
.long 0xeeee,0x14dc0,0x1e7c0,0x19c0,0xeeee,0x14dd0,0x1e7d0,0x19d0
.long 0xeeee,0x14de0,0x1e7e0,0x19e0,0xeeee,0x14df0,0x1e7f0,0x19f0
.long 0x4444,0x14e00,0x1e800,0x1a00,0x4444,0x14e10,0x1e810,0x1a10
.long 0x4444,0x14e20,0x1e820,0x1a20,0x4444,0x14e30,0x1e830,0x1a30
.long 0x4444,0x14e40,0x1e840,0x1a40,0x4444,0x14e50,0x1e850,0x1a50
.long 0x4444,0x14e60,0x1e860,0x1a60,0x4444,0x14e70,0x1e870,0x1a70
.long 0xeeee,0x14e80,0x1e880,0x1a80,0xeeee,0x14e90,0x1e890,0x1a90
.long 0xeeee,0x14ea0,0x1e8a0,0x1aa0,0xeeee,0x14eb0,0x1e8b0,0x1ab0
.long 0xeeee,0x14ec0,0x1e8c0,0x1ac0,0xeeee,0x14ed0,0x1e8d0,0x1ad0
.long 0xeeee,0x14ee0,0x1e8e0,0x1ae0,0xeeee,0x14ef0,0x1e8f0,0x1af0
.long 0x4444,0x14f00,0x1e900,0x1b00,0x4444,0x14f10,0x1e910,0x1b10
.long 0x4444,0x14f20,0x1e920,0x1b20,0x4444,0x14f30,0x1e930,0x1b30
.long 0x4444,0x14f40,0x1e940,0x1b40,0x4444,0x14f50,0x1e950,0x1b50
.long 0x4444,0x14f60,0x1e960,0x1b60,0x4444,0x14f70,0x1e970,0x1b70
.long 0xeeee,0x14f80,0x1e980,0x1b80,0xeeee,0x14f90,0x1e990,0x1b90
.long 0xeeee,0x14fa0,0x1e9a0,0x1ba0,0xeeee,0x14fb0,0x1e9b0,0x1bb0
.long 0xeeee,0x14fc0,0x1e9c0,0x1bc0,0xeeee,0x14fd0,0x1e9d0,0x1bd0
.long 0xeeee,0x14fe0,0x1e9e0,0x1be0,0xeeee,0x14ff0,0x1e9f0,0x1bf0
.long 0xb200,0x200,0x0,0x0,0xb210,0x204,0x4,0x2
.long 0xb220,0x208,0x8,0x4,0xb230,0x20c,0xc,0x6
.long 0xb240,0x210,0x80,0x8,0xb250,0x214,0x84,0xa
.long 0xb260,0x218,0x88,0xc,0xb270,0x21c,0x8c,0xe
.long 0xb280,0x220,0x80000000,0x80000000,0xb290,0x224,0x80000000,0x80000000
.long 0xb2a0,0x228,0x80000000,0x80000000,0xb2b0,0x22c,0x80000000,0x80000000
.long 0xb2c0,0x230,0x80000000,0x80000000,0xb2d0,0x234,0x80000000,0x80000000
.long 0xb2e0,0x238,0x80000000,0x80000000,0xb2f0,0x23c,0x80000000,0x80000000
.long 0xb300,0x240,0x10,0x480,0xb310,0x244,0x14,0x482
.long 0xb320,0x248,0x18,0x484,0xb330,0x24c,0x1c,0x486
.long 0xb340,0x250,0x90,0x488,0xb350,0x254,0x94,0x48a
.long 0xb360,0x258,0x98,0x48c,0xb370,0x25c,0x9c,0x48e
.long 0xb380,0x260,0x80000000,0x80000000,0xb390,0x264,0x80000000,0x80000000
.long 0xb3a0,0x268,0x80000000,0x80000000,0xb3b0,0x26c,0x80000000,0x80000000
.long 0xb3c0,0x270,0x80000000,0x80000000,0xb3d0,0x274,0x80000000,0x80000000
.long 0xb3e0,0x278,0x80000000,0x80000000,0xb3f0,0x27c,0x80000000,0x80000000
.long 0xb400,0x280,0x20,0x900,0xb410,0x284,0x24,0x902
.long 0xb420,0x288,0x28,0x904,0xb430,0x28c,0x2c,0x906
.long 0xb440,0x290,0xa0,0x908,0xb450,0x294,0xa4,0x90a
.long 0xb460,0x298,0xa8,0x90c,0xb470,0x29c,0xac,0x90e
.long 0xb480,0x2a0,0x80000000,0x80000000,0xb490,0x2a4,0x80000000,0x80000000
.long 0xb4a0,0x2a8,0x80000000,0x80000000,0xb4b0,0x2ac,0x80000000,0x80000000
.long 0xb4c0,0x2b0,0x80000000,0x80000000,0xb4d0,0x2b4,0x80000000,0x80000000
.long 0xb4e0,0x2b8,0x80000000,0x80000000,0xb4f0,0x2bc,0x80000000,0x80000000
.long 0xb500,0x2c0,0x30,0xd80,0xb510,0x2c4,0x34,0xd82
.long 0xb520,0x2c8,0x38,0xd84,0xb530,0x2cc,0x3c,0xd86
.long 0xb540,0x2d0,0xb0,0xd88,0xb550,0x2d4,0xb4,0xd8a
.long 0xb560,0x2d8,0xb8,0xd8c,0xb570,0x2dc,0xbc,0xd8e
.long 0xb580,0x2e0,0x80000000,0x80000000,0xb590,0x2e4,0x80000000,0x80000000
.long 0xb5a0,0x2e8,0x80000000,0x80000000,0xb5b0,0x2ec,0x80000000,0x80000000
.long 0xb5c0,0x2f0,0x80000000,0x80000000,0xb5d0,0x2f4,0x80000000,0x80000000
.long 0xb5e0,0x2f8,0x80000000,0x80000000,0xb5f0,0x2fc,0x80000000,0x80000000
.long 0x0,0x40,0x0,0x40,0x10,0x50,0x10,0x50
.long 0x20,0x60,0x20,0x60,0x30,0x70,0x30,0x70
.long 0x40,0x0,0x40,0x0,0x50,0x10,0x50,0x10
.long 0x60,0x20,0x60,0x20,0x70,0x30,0x70,0x30
.long 0x2000,0x2040,0x480,0x4c0,0x2010,0x2050,0x490,0x4d0
.long 0x2020,0x2060,0x4a0,0x4e0,0x2030,0x2070,0x4b0,0x4f0
.long 0x2040,0x2000,0x4c0,0x480,0x2050,0x2010,0x4d0,0x490
.long 0x2060,0x2020,0x4e0,0x4a0,0x2070,0x2030,0x4f0,0x4b0
.long 0x4000,0x4040,0x900,0x940,0x4010,0x4050,0x910,0x950
.long 0x4020,0x4060,0x920,0x960,0x4030,0x4070,0x930,0x970
.long 0x4040,0x4000,0x940,0x900,0x4050,0x4010,0x950,0x910
.long 0x4060,0x4020,0x960,0x920,0x4070,0x4030,0x970,0x930
.long 0x6000,0x6040,0xd80,0xdc0,0x6010,0x6050,0xd90,0xdd0
.long 0x6020,0x6060,0xda0,0xde0,0x6030,0x6070,0xdb0,0xdf0
.long 0x6040,0x6000,0xdc0,0xd80,0x6050,0x6010,0xdd0,0xd90
.long 0x6060,0x6020,0xde0,0xda0,0x6070,0x6030,0xdf0,0xdb0
.long 0x8020,0x8060,0x1200,0x1240,0x8030,0x8070,0x1210,0x1250
.long 0x8000,0x8040,0x1220,0x1260,0x8010,0x8050,0x1230,0x1270
.long 0x8060,0x8020,0x1240,0x1200,0x8070,0x8030,0x1250,0x1210
.long 0x8040,0x8000,0x1260,0x1220,0x8050,0x8010,0x1270,0x1230
.long 0xa020,0xa060,0x1680,0x16c0,0xa030,0xa070,0x1690,0x16d0
.long 0xa000,0xa040,0x16a0,0x16e0,0xa010,0xa050,0x16b0,0x16f0
.long 0xa060,0xa020,0x16c0,0x1680,0xa070,0xa030,0x16d0,0x1690
.long 0xa040,0xa000,0x16e0,0x16a0,0xa050,0xa010,0x16f0,0x16b0
.long 0xc020,0xc060,0x1b00,0x1b40,0xc030,0xc070,0x1b10,0x1b50
.long 0xc000,0xc040,0x1b20,0x1b60,0xc010,0xc050,0x1b30,0x1b70
.long 0xc060,0xc020,0x1b40,0x1b00,0xc070,0xc030,0x1b50,0x1b10
.long 0xc040,0xc000,0x1b60,0x1b20,0xc050,0xc010,0x1b70,0x1b30
.long 0xe020,0xe060,0x1f80,0x1fc0,0xe030,0xe070,0x1f90,0x1fd0
.long 0xe000,0xe040,0x1fa0,0x1fe0,0xe010,0xe050,0x1fb0,0x1ff0
.long 0xe060,0xe020,0x1fc0,0x1f80,0xe070,0xe030,0x1fd0,0x1f90
.long 0xe040,0xe000,0x1fe0,0x1fa0,0xe050,0xe010,0x1ff0,0x1fb0
.long 0x0,0x20,0x0,0x0,0x10,0x30,0x8,0x8
.long 0x20,0x0,0x20,0x10,0x30,0x10,0x28,0x18
.long 0x40,0x60,0x840,0x840,0x50,0x70,0x848,0x848
.long 0x60,0x40,0x860,0x850,0x70,0x50,0x868,0x858
.long 0x480,0x4a0,0x220,0x220,0x490,0x4b0,0x228,0x228
.long 0x4a0,0x480,0x200,0x230,0x4b0,0x490,0x208,0x238
.long 0x4c0,0x4e0,0xa60,0xa60,0x4d0,0x4f0,0xa68,0xa68
.long 0x4e0,0x4c0,0xa40,0xa70,0x4f0,0x4d0,0xa48,0xa78
.long 0x900,0x920,0x100,0x100,0x910,0x930,0x108,0x108
.long 0x920,0x900,0x120,0x110,0x930,0x910,0x128,0x118
.long 0x940,0x960,0x940,0x940,0x950,0x970,0x948,0x948
.long 0x960,0x940,0x960,0x950,0x970,0x950,0x968,0x958
.long 0xd80,0xda0,0x320,0x320,0xd90,0xdb0,0x328,0x328
.long 0xda0,0xd80,0x300,0x330,0xdb0,0xd90,0x308,0x338
.long 0xdc0,0xde0,0xb60,0xb60,0xdd0,0xdf0,0xb68,0xb68
.long 0xde0,0xdc0,0xb40,0xb70,0xdf0,0xdd0,0xb48,0xb78
.long 0x1200,0x1220,0x400,0x400,0x1210,0x1230,0x408,0x408
.long 0x1220,0x1200,0x420,0x410,0x1230,0x1210,0x428,0x418
.long 0x1240,0x1260,0xc40,0xc40,0x1250,0x1270,0xc48,0xc48
.long 0x1260,0x1240,0xc60,0xc50,0x1270,0x1250,0xc68,0xc58
.long 0x1680,0x16a0,0x620,0x620,0x1690,0x16b0,0x628,0x628
.long 0x16a0,0x1680,0x600,0x630,0x16b0,0x1690,0x608,0x638
.long 0x16c0,0x16e0,0xe60,0xe60,0x16d0,0x16f0,0xe68,0xe68
.long 0x16e0,0x16c0,0xe40,0xe70,0x16f0,0x16d0,0xe48,0xe78
.long 0x1b00,0x1b20,0x500,0x500,0x1b10,0x1b30,0x508,0x508
.long 0x1b20,0x1b00,0x520,0x510,0x1b30,0x1b10,0x528,0x518
.long 0x1b40,0x1b60,0xd40,0xd40,0x1b50,0x1b70,0xd48,0xd48
.long 0x1b60,0x1b40,0xd60,0xd50,0x1b70,0x1b50,0xd68,0xd58
.long 0x1f80,0x1fa0,0x720,0x720,0x1f90,0x1fb0,0x728,0x728
.long 0x1fa0,0x1f80,0x700,0x730,0x1fb0,0x1f90,0x708,0x738
.long 0x1fc0,0x1fe0,0xf60,0xf60,0x1fd0,0x1ff0,0xf68,0xf68
.long 0x1fe0,0x1fc0,0xf40,0xf70,0x1ff0,0x1fd0,0xf48,0xf78
.long 0x0,0x1840,0x0,0x0,0x8,0x1848,0x8,0x8
.long 0x10,0x1850,0x20,0x10,0x18,0x1858,0x28,0x18
.long 0x80,0x18c0,0x80,0x80,0x88,0x18c8,0x88,0x88
.long 0x90,0x18d0,0xa0,0x90,0x98,0x18d8,0xa8,0x98
.long 0x40,0xb200,0x440,0x440,0x48,0xb208,0x448,0x448
.long 0x50,0xb210,0x460,0x450,0x58,0xb218,0x468,0x458
.long 0xc0,0xb280,0x4c0,0x4c0,0xc8,0xb288,0x4c8,0x4c8
.long 0xd0,0xb290,0x4e0,0x4d0,0xd8,0xb298,0x4e8,0x4d8
.long 0x840,0x2060,0x220,0x220,0x848,0x2068,0x228,0x228
.long 0x850,0x2070,0x200,0x230,0x858,0x2078,0x208,0x238
.long 0x8c0,0x20e0,0x2a0,0x2a0,0x8c8,0x20e8,0x2a8,0x2a8
.long 0x8d0,0x20f0,0x280,0x2b0,0x8d8,0x20f8,0x288,0x2b8
.long 0x800,0xba20,0x660,0x660,0x808,0xba28,0x668,0x668
.long 0x810,0xba30,0x640,0x670,0x818,0xba38,0x648,0x678
.long 0x880,0xbaa0,0x6e0,0x6e0,0x888,0xbaa8,0x6e8,0x6e8
.long 0x890,0xbab0,0x6c0,0x6f0,0x898,0xbab8,0x6c8,0x6f8
.long 0x200,0x1a40,0x800,0x800,0x208,0x1a48,0x808,0x808
.long 0x210,0x1a50,0x820,0x810,0x218,0x1a58,0x828,0x818
.long 0x280,0x1ac0,0x880,0x880,0x288,0x1ac8,0x888,0x888
.long 0x290,0x1ad0,0x8a0,0x890,0x298,0x1ad8,0x8a8,0x898
.long 0x240,0xb400,0xc40,0xc40,0x248,0xb408,0xc48,0xc48
.long 0x250,0xb410,0xc60,0xc50,0x258,0xb418,0xc68,0xc58
.long 0x2c0,0xb480,0xcc0,0xcc0,0x2c8,0xb488,0xcc8,0xcc8
.long 0x2d0,0xb490,0xce0,0xcd0,0x2d8,0xb498,0xce8,0xcd8
.long 0xa40,0x2260,0xa20,0xa20,0xa48,0x2268,0xa28,0xa28
.long 0xa50,0x2270,0xa00,0xa30,0xa58,0x2278,0xa08,0xa38
.long 0xac0,0x22e0,0xaa0,0xaa0,0xac8,0x22e8,0xaa8,0xaa8
.long 0xad0,0x22f0,0xa80,0xab0,0xad8,0x22f8,0xa88,0xab8
.long 0xa00,0xbc20,0xe60,0xe60,0xa08,0xbc28,0xe68,0xe68
.long 0xa10,0xbc30,0xe40,0xe70,0xa18,0xbc38,0xe48,0xe78
.long 0xa80,0xbca0,0xee0,0xee0,0xa88,0xbca8,0xee8,0xee8
.long 0xa90,0xbcb0,0xec0,0xef0,0xa98,0xbcb8,0xec8,0xef8
.long 0x0,0x0,0x0,0x0,0x0,0x0,0x0,0x0
.long 0x0,0x0,0x0,0x0,0x0,0x0,0x0,0x0
.long 0x0,0x0,0x0,0x0,0x0,0x0,0x0,0x0
.long 0x0,0x0,0x0,0x0,0x0,0x0,0x0,0x0
.long 0x0,0x0,0x0,0x0,0x0,0x0,0x0,0x0
.long 0x0,0x0,0x0,0x0,0x0,0x0,0x0,0x0
.long 0x0,0x0,0x0,0x0,0x0,0x0,0x0,0x0
.long 0x0,0x0,0x0,0x0,0x0,0x0,0x0,0x0
.long 0x0,0x0,0x0,0x0,0x0,0x0,0x0,0x0
.long 0x0,0x0,0x0,0x0,0x0,0x0,0x0,0x0
.long 0x0,0x0,0x0,0x0,0x0,0x0,0x0,0x0
.long 0x0,0x0,0x0,0x0,0x0,0x0,0x0,0x0
.long 0x0,0x0,0x0,0x0,0x0,0x0,0x0,0x0
.long 0x0,0x0,0x0,0x0,0x0,0x0,0x0,0x0
.long 0x0,0x0,0x0,0x0,0x0,0x0,0x0,0x0
.long 0x0,0x0,0x0,0x0,0x0,0x0,0x0,0x0
.long 0x0,0x0,0x0,0x0,0x0,0x0,0x0,0x0
.long 0x0,0x0,0x0,0x0,0x0,0x0,0x0,0x0
.long 0x0,0x0,0x0,0x0,0x0,0x0,0x0,0x0
.long 0x0,0x0,0x0,0x0,0x0,0x0,0x0,0x0
.long 0x0,0x0,0x0,0x0,0x0,0x0,0x0,0x0
.long 0x0,0x0,0x0,0x0,0x0,0x0,0x0,0x0
.long 0x0,0x0,0x0,0x0,0x0,0x0,0x0,0x0
.long 0x0,0x0,0x0,0x0,0x0,0x0,0x0,0x0
.long 0x0,0x0,0x0,0x0,0x0,0x0,0x0,0x0
.long 0x0,0x0,0x0,0x0,0x0,0x0,0x0,0x0
.long 0x0,0x0,0x0,0x0,0x0,0x0,0x0,0x0
.long 0x0,0x0,0x0,0x0,0x0,0x0,0x0,0x0
.long 0x0,0x0,0x0,0x0,0x0,0x0,0x0,0x0
.long 0x0,0x0,0x0,0x0,0x0,0x0,0x0,0x0
.long 0x0,0x0,0x0,0x0,0x0,0x0,0x0,0x0
.long 0x0,0x0,0x0,0x0,0x0,0x0,0x0,0x0
.long 0xaa00,0x0,0x1de00,0x0,0xaa10,0x10,0x1de10,0x8
.long 0xaa20,0x20,0x1de20,0x10,0xaa30,0x30,0x1de30,0x18
.long 0xaa40,0x40,0x1de40,0x80,0xaa50,0x50,0x1de50,0x88
.long 0xaa60,0x60,0x1de60,0x90,0xaa70,0x70,0x1de70,0x98
.long 0x14400,0x2880,0x27800,0x100,0x14410,0x2890,0x27810,0x108
.long 0x14420,0x28a0,0x27820,0x110,0x14430,0x28b0,0x27830,0x118
.long 0x14440,0x28c0,0x27840,0x180,0x14450,0x28d0,0x27850,0x188
.long 0x14460,0x28e0,0x27860,0x190,0x14470,0x28f0,0x27870,0x198
.long 0xab00,0x5100,0x1df00,0x20,0xab10,0x5110,0x1df10,0x28
.long 0xab20,0x5120,0x1df20,0x30,0xab30,0x5130,0x1df30,0x38
.long 0xab40,0x5140,0x1df40,0xa0,0xab50,0x5150,0x1df50,0xa8
.long 0xab60,0x5160,0x1df60,0xb0,0xab70,0x5170,0x1df70,0xb8
.long 0x14500,0x7980,0x27900,0x120,0x14510,0x7990,0x27910,0x128
.long 0x14520,0x79a0,0x27920,0x130,0x14530,0x79b0,0x27930,0x138
.long 0x14540,0x79c0,0x27940,0x1a0,0x14550,0x79d0,0x27950,0x1a8
.long 0x14560,0x79e0,0x27960,0x1b0,0x14570,0x79f0,0x27970,0x1b8
.long 0xac00,0xa200,0x1e000,0x40,0xac10,0xa210,0x1e010,0x48
.long 0xac20,0xa220,0x1e020,0x50,0xac30,0xa230,0x1e030,0x58
.long 0xac40,0xa240,0x1e040,0xc0,0xac50,0xa250,0x1e050,0xc8
.long 0xac60,0xa260,0x1e060,0xd0,0xac70,0xa270,0x1e070,0xd8
.long 0x14600,0xca80,0x27a00,0x140,0x14610,0xca90,0x27a10,0x148
.long 0x14620,0xcaa0,0x27a20,0x150,0x14630,0xcab0,0x27a30,0x158
.long 0x14640,0xcac0,0x27a40,0x1c0,0x14650,0xcad0,0x27a50,0x1c8
.long 0x14660,0xcae0,0x27a60,0x1d0,0x14670,0xcaf0,0x27a70,0x1d8
.long 0xad00,0xf300,0x1e100,0x60,0xad10,0xf310,0x1e110,0x68
.long 0xad20,0xf320,0x1e120,0x70,0xad30,0xf330,0x1e130,0x78
.long 0xad40,0xf340,0x1e140,0xe0,0xad50,0xf350,0x1e150,0xe8
.long 0xad60,0xf360,0x1e160,0xf0,0xad70,0xf370,0x1e170,0xf8
.long 0x14700,0x11b80,0x27b00,0x160,0x14710,0x11b90,0x27b10,0x168
.long 0x14720,0x11ba0,0x27b20,0x170,0x14730,0x11bb0,0x27b30,0x178
.long 0x14740,0x11bc0,0x27b40,0x1e0,0x14750,0x11bd0,0x27b50,0x1e8
.long 0x14760,0x11be0,0x27b60,0x1f0,0x14770,0x11bf0,0x27b70,0x1f8
.long 0x4444,0x1e600,0x14c00,0xb200,0x4444,0x1e610,0x14c10,0xb210
.long 0x4444,0x1e620,0x14c20,0xb220,0x4444,0x1e630,0x14c30,0xb230
.long 0x4444,0x1e640,0x14c40,0xb240,0x4444,0x1e650,0x14c50,0xb250
.long 0x4444,0x1e660,0x14c60,0xb260,0x4444,0x1e670,0x14c70,0xb270
.long 0xeeee,0x1e680,0x14c80,0xb280,0xeeee,0x1e690,0x14c90,0xb290
.long 0xeeee,0x1e6a0,0x14ca0,0xb2a0,0xeeee,0x1e6b0,0x14cb0,0xb2b0
.long 0xeeee,0x1e6c0,0x14cc0,0xb2c0,0xeeee,0x1e6d0,0x14cd0,0xb2d0
.long 0xeeee,0x1e6e0,0x14ce0,0xb2e0,0xeeee,0x1e6f0,0x14cf0,0xb2f0
.long 0x4444,0x1e700,0x14d00,0xb300,0x4444,0x1e710,0x14d10,0xb310
.long 0x4444,0x1e720,0x14d20,0xb320,0x4444,0x1e730,0x14d30,0xb330
.long 0x4444,0x1e740,0x14d40,0xb340,0x4444,0x1e750,0x14d50,0xb350
.long 0x4444,0x1e760,0x14d60,0xb360,0x4444,0x1e770,0x14d70,0xb370
.long 0xeeee,0x1e780,0x14d80,0xb380,0xeeee,0x1e790,0x14d90,0xb390
.long 0xeeee,0x1e7a0,0x14da0,0xb3a0,0xeeee,0x1e7b0,0x14db0,0xb3b0
.long 0xeeee,0x1e7c0,0x14dc0,0xb3c0,0xeeee,0x1e7d0,0x14dd0,0xb3d0
.long 0xeeee,0x1e7e0,0x14de0,0xb3e0,0xeeee,0x1e7f0,0x14df0,0xb3f0
.long 0x4444,0x1e800,0x14e00,0xb400,0x4444,0x1e810,0x14e10,0xb410
.long 0x4444,0x1e820,0x14e20,0xb420,0x4444,0x1e830,0x14e30,0xb430
.long 0x4444,0x1e840,0x14e40,0xb440,0x4444,0x1e850,0x14e50,0xb450
.long 0x4444,0x1e860,0x14e60,0xb460,0x4444,0x1e870,0x14e70,0xb470
.long 0xeeee,0x1e880,0x14e80,0xb480,0xeeee,0x1e890,0x14e90,0xb490
.long 0xeeee,0x1e8a0,0x14ea0,0xb4a0,0xeeee,0x1e8b0,0x14eb0,0xb4b0
.long 0xeeee,0x1e8c0,0x14ec0,0xb4c0,0xeeee,0x1e8d0,0x14ed0,0xb4d0
.long 0xeeee,0x1e8e0,0x14ee0,0xb4e0,0xeeee,0x1e8f0,0x14ef0,0xb4f0
.long 0x4444,0x1e900,0x14f00,0xb500,0x4444,0x1e910,0x14f10,0xb510
.long 0x4444,0x1e920,0x14f20,0xb520,0x4444,0x1e930,0x14f30,0xb530
.long 0x4444,0x1e940,0x14f40,0xb540,0x4444,0x1e950,0x14f50,0xb550
.long 0x4444,0x1e960,0x14f60,0xb560,0x4444,0x1e970,0x14f70,0xb570
.long 0xeeee,0x1e980,0x14f80,0xb580,0xeeee,0x1e990,0x14f90,0xb590
.long 0xeeee,0x1e9a0,0x14fa0,0xb5a0,0xeeee,0x1e9b0,0x14fb0,0xb5b0
.long 0xeeee,0x1e9c0,0x14fc0,0xb5c0,0xeeee,0x1e9d0,0x14fd0,0xb5d0
.long 0xeeee,0x1e9e0,0x14fe0,0xb5e0,0xeeee,0x1e9f0,0x14ff0,0xb5f0
.long 0x1800,0x300,0x80000000,0x0,0x1810,0x304,0x80000000,0x2
.long 0x1820,0x308,0x80000000,0x4,0x1830,0x30c,0x80000000,0x6
.long 0x1840,0x310,0x80000000,0x8,0x1850,0x314,0x80000000,0xa
.long 0x1860,0x318,0x80000000,0xc,0x1870,0x31c,0x80000000,0xe
.long 0x1880,0x320,0x80000000,0x80000000,0x1890,0x324,0x80000000,0x80000000
.long 0x18a0,0x328,0x80000000,0x80000000,0x18b0,0x32c,0x80000000,0x80000000
.long 0x18c0,0x330,0x80000000,0x80000000,0x18d0,0x334,0x80000000,0x80000000
.long 0x18e0,0x338,0x80000000,0x80000000,0x18f0,0x33c,0x80000000,0x80000000
.long 0x1900,0x340,0x80000000,0x480,0x1910,0x344,0x80000000,0x482
.long 0x1920,0x348,0x80000000,0x484,0x1930,0x34c,0x80000000,0x486
.long 0x1940,0x350,0x80000000,0x488,0x1950,0x354,0x80000000,0x48a
.long 0x1960,0x358,0x80000000,0x48c,0x1970,0x35c,0x80000000,0x48e
.long 0x1980,0x360,0x80000000,0x80000000,0x1990,0x364,0x80000000,0x80000000
.long 0x19a0,0x368,0x80000000,0x80000000,0x19b0,0x36c,0x80000000,0x80000000
.long 0x19c0,0x370,0x80000000,0x80000000,0x19d0,0x374,0x80000000,0x80000000
.long 0x19e0,0x378,0x80000000,0x80000000,0x19f0,0x37c,0x80000000,0x80000000
.long 0x1a00,0x380,0x80000000,0x900,0x1a10,0x384,0x80000000,0x902
.long 0x1a20,0x388,0x80000000,0x904,0x1a30,0x38c,0x80000000,0x906
.long 0x1a40,0x390,0x80000000,0x908,0x1a50,0x394,0x80000000,0x90a
.long 0x1a60,0x398,0x80000000,0x90c,0x1a70,0x39c,0x80000000,0x90e
.long 0x1a80,0x3a0,0x80000000,0x80000000,0x1a90,0x3a4,0x80000000,0x80000000
.long 0x1aa0,0x3a8,0x80000000,0x80000000,0x1ab0,0x3ac,0x80000000,0x80000000
.long 0x1ac0,0x3b0,0x80000000,0x80000000,0x1ad0,0x3b4,0x80000000,0x80000000
.long 0x1ae0,0x3b8,0x80000000,0x80000000,0x1af0,0x3bc,0x80000000,0x80000000
.long 0x1b00,0x3c0,0x80000000,0xd80,0x1b10,0x3c4,0x80000000,0xd82
.long 0x1b20,0x3c8,0x80000000,0xd84,0x1b30,0x3cc,0x80000000,0xd86
.long 0x1b40,0x3d0,0x80000000,0xd88,0x1b50,0x3d4,0x80000000,0xd8a
.long 0x1b60,0x3d8,0x80000000,0xd8c,0x1b70,0x3dc,0x80000000,0xd8e
.long 0x1b80,0x3e0,0x80000000,0x80000000,0x1b90,0x3e4,0x80000000,0x80000000
.long 0x1ba0,0x3e8,0x80000000,0x80000000,0x1bb0,0x3ec,0x80000000,0x80000000
.long 0x1bc0,0x3f0,0x80000000,0x80000000,0x1bd0,0x3f4,0x80000000,0x80000000
.long 0x1be0,0x3f8,0x80000000,0x80000000,0x1bf0,0x3fc,0x80000000,0x80000000
.long 0x0,0x40,0x0,0x40,0x10,0x50,0x10,0x50
.long 0x20,0x60,0x20,0x60,0x30,0x70,0x30,0x70
.long 0x40,0x0,0x40,0x0,0x50,0x10,0x50,0x10
.long 0x60,0x20,0x60,0x20,0x70,0x30,0x70,0x30
.long 0x2000,0x2040,0x480,0x4c0,0x2010,0x2050,0x490,0x4d0
.long 0x2020,0x2060,0x4a0,0x4e0,0x2030,0x2070,0x4b0,0x4f0
.long 0x2040,0x2000,0x4c0,0x480,0x2050,0x2010,0x4d0,0x490
.long 0x2060,0x2020,0x4e0,0x4a0,0x2070,0x2030,0x4f0,0x4b0
.long 0x4000,0x4040,0x900,0x940,0x4010,0x4050,0x910,0x950
.long 0x4020,0x4060,0x920,0x960,0x4030,0x4070,0x930,0x970
.long 0x4040,0x4000,0x940,0x900,0x4050,0x4010,0x950,0x910
.long 0x4060,0x4020,0x960,0x920,0x4070,0x4030,0x970,0x930
.long 0x6000,0x6040,0xd80,0xdc0,0x6010,0x6050,0xd90,0xdd0
.long 0x6020,0x6060,0xda0,0xde0,0x6030,0x6070,0xdb0,0xdf0
.long 0x6040,0x6000,0xdc0,0xd80,0x6050,0x6010,0xdd0,0xd90
.long 0x6060,0x6020,0xde0,0xda0,0x6070,0x6030,0xdf0,0xdb0
.long 0x8020,0x8060,0x1200,0x1240,0x8030,0x8070,0x1210,0x1250
.long 0x8000,0x8040,0x1220,0x1260,0x8010,0x8050,0x1230,0x1270
.long 0x8060,0x8020,0x1240,0x1200,0x8070,0x8030,0x1250,0x1210
.long 0x8040,0x8000,0x1260,0x1220,0x8050,0x8010,0x1270,0x1230
.long 0xa020,0xa060,0x1680,0x16c0,0xa030,0xa070,0x1690,0x16d0
.long 0xa000,0xa040,0x16a0,0x16e0,0xa010,0xa050,0x16b0,0x16f0
.long 0xa060,0xa020,0x16c0,0x1680,0xa070,0xa030,0x16d0,0x1690
.long 0xa040,0xa000,0x16e0,0x16a0,0xa050,0xa010,0x16f0,0x16b0
.long 0xc020,0xc060,0x1b00,0x1b40,0xc030,0xc070,0x1b10,0x1b50
.long 0xc000,0xc040,0x1b20,0x1b60,0xc010,0xc050,0x1b30,0x1b70
.long 0xc060,0xc020,0x1b40,0x1b00,0xc070,0xc030,0x1b50,0x1b10
.long 0xc040,0xc000,0x1b60,0x1b20,0xc050,0xc010,0x1b70,0x1b30
.long 0xe020,0xe060,0x1f80,0x1fc0,0xe030,0xe070,0x1f90,0x1fd0
.long 0xe000,0xe040,0x1fa0,0x1fe0,0xe010,0xe050,0x1fb0,0x1ff0
.long 0xe060,0xe020,0x1fc0,0x1f80,0xe070,0xe030,0x1fd0,0x1f90
.long 0xe040,0xe000,0x1fe0,0x1fa0,0xe050,0xe010,0x1ff0,0x1fb0
.long 0x40,0x60,0x40,0x40,0x50,0x70,0x48,0x48
.long 0x60,0x40,0x60,0x50,0x70,0x50,0x68,0x58
.long 0x0,0x20,0x800,0x800,0x10,0x30,0x808,0x808
.long 0x20,0x0,0x820,0x810,0x30,0x10,0x828,0x818
.long 0x4c0,0x4e0,0x260,0x260,0x4d0,0x4f0,0x268,0x268
.long 0x4e0,0x4c0,0x240,0x270,0x4f0,0x4d0,0x248,0x278
.long 0x480,0x4a0,0xa20,0xa20,0x490,0x4b0,0xa28,0xa28
.long 0x4a0,0x480,0xa00,0xa30,0x4b0,0x490,0xa08,0xa38
.long 0x940,0x960,0x140,0x140,0x950,0x970,0x148,0x148
.long 0x960,0x940,0x160,0x150,0x970,0x950,0x168,0x158
.long 0x900,0x920,0x900,0x900,0x910,0x930,0x908,0x908
.long 0x920,0x900,0x920,0x910,0x930,0x910,0x928,0x918
.long 0xdc0,0xde0,0x360,0x360,0xdd0,0xdf0,0x368,0x368
.long 0xde0,0xdc0,0x340,0x370,0xdf0,0xdd0,0x348,0x378
.long 0xd80,0xda0,0xb20,0xb20,0xd90,0xdb0,0xb28,0xb28
.long 0xda0,0xd80,0xb00,0xb30,0xdb0,0xd90,0xb08,0xb38
.long 0x1240,0x1260,0x440,0x440,0x1250,0x1270,0x448,0x448
.long 0x1260,0x1240,0x460,0x450,0x1270,0x1250,0x468,0x458
.long 0x1200,0x1220,0xc00,0xc00,0x1210,0x1230,0xc08,0xc08
.long 0x1220,0x1200,0xc20,0xc10,0x1230,0x1210,0xc28,0xc18
.long 0x16c0,0x16e0,0x660,0x660,0x16d0,0x16f0,0x668,0x668
.long 0x16e0,0x16c0,0x640,0x670,0x16f0,0x16d0,0x648,0x678
.long 0x1680,0x16a0,0xe20,0xe20,0x1690,0x16b0,0xe28,0xe28
.long 0x16a0,0x1680,0xe00,0xe30,0x16b0,0x1690,0xe08,0xe38
.long 0x1b40,0x1b60,0x540,0x540,0x1b50,0x1b70,0x548,0x548
.long 0x1b60,0x1b40,0x560,0x550,0x1b70,0x1b50,0x568,0x558
.long 0x1b00,0x1b20,0xd00,0xd00,0x1b10,0x1b30,0xd08,0xd08
.long 0x1b20,0x1b00,0xd20,0xd10,0x1b30,0x1b10,0xd28,0xd18
.long 0x1fc0,0x1fe0,0x760,0x760,0x1fd0,0x1ff0,0x768,0x768
.long 0x1fe0,0x1fc0,0x740,0x770,0x1ff0,0x1fd0,0x748,0x778
.long 0x1f80,0x1fa0,0xf20,0xf20,0x1f90,0x1fb0,0xf28,0xf28
.long 0x1fa0,0x1f80,0xf00,0xf30,0x1fb0,0x1f90,0xf08,0xf38
.long 0x0,0x1860,0x40,0x40,0x8,0x1868,0x48,0x48
.long 0x10,0x1870,0x60,0x50,0x18,0x1878,0x68,0x58
.long 0x80,0x18e0,0xc0,0xc0,0x88,0x18e8,0xc8,0xc8
.long 0x90,0x18f0,0xe0,0xd0,0x98,0x18f8,0xe8,0xd8
.long 0x40,0xb220,0x400,0x400,0x48,0xb228,0x408,0x408
.long 0x50,0xb230,0x420,0x410,0x58,0xb238,0x428,0x418
.long 0xc0,0xb2a0,0x480,0x480,0xc8,0xb2a8,0x488,0x488
.long 0xd0,0xb2b0,0x4a0,0x490,0xd8,0xb2b8,0x4a8,0x498
.long 0x840,0x2040,0x260,0x260,0x848,0x2048,0x268,0x268
.long 0x850,0x2050,0x240,0x270,0x858,0x2058,0x248,0x278
.long 0x8c0,0x20c0,0x2e0,0x2e0,0x8c8,0x20c8,0x2e8,0x2e8
.long 0x8d0,0x20d0,0x2c0,0x2f0,0x8d8,0x20d8,0x2c8,0x2f8
.long 0x800,0xba00,0x620,0x620,0x808,0xba08,0x628,0x628
.long 0x810,0xba10,0x600,0x630,0x818,0xba18,0x608,0x638
.long 0x880,0xba80,0x6a0,0x6a0,0x888,0xba88,0x6a8,0x6a8
.long 0x890,0xba90,0x680,0x6b0,0x898,0xba98,0x688,0x6b8
.long 0x200,0x1a60,0x840,0x840,0x208,0x1a68,0x848,0x848
.long 0x210,0x1a70,0x860,0x850,0x218,0x1a78,0x868,0x858
.long 0x280,0x1ae0,0x8c0,0x8c0,0x288,0x1ae8,0x8c8,0x8c8
.long 0x290,0x1af0,0x8e0,0x8d0,0x298,0x1af8,0x8e8,0x8d8
.long 0x240,0xb420,0xc00,0xc00,0x248,0xb428,0xc08,0xc08
.long 0x250,0xb430,0xc20,0xc10,0x258,0xb438,0xc28,0xc18
.long 0x2c0,0xb4a0,0xc80,0xc80,0x2c8,0xb4a8,0xc88,0xc88
.long 0x2d0,0xb4b0,0xca0,0xc90,0x2d8,0xb4b8,0xca8,0xc98
.long 0xa40,0x2240,0xa60,0xa60,0xa48,0x2248,0xa68,0xa68
.long 0xa50,0x2250,0xa40,0xa70,0xa58,0x2258,0xa48,0xa78
.long 0xac0,0x22c0,0xae0,0xae0,0xac8,0x22c8,0xae8,0xae8
.long 0xad0,0x22d0,0xac0,0xaf0,0xad8,0x22d8,0xac8,0xaf8
.long 0xa00,0xbc00,0xe20,0xe20,0xa08,0xbc08,0xe28,0xe28
.long 0xa10,0xbc10,0xe00,0xe30,0xa18,0xbc18,0xe08,0xe38
.long 0xa80,0xbc80,0xea0,0xea0,0xa88,0xbc88,0xea8,0xea8
.long 0xa90,0xbc90,0xe80,0xeb0,0xa98,0xbc98,0xe88,0xeb8
.long 0xaa00,0x0,0x1de00,0x0,0xaa10,0x10,0x1de10,0x8
.long 0xaa20,0x20,0x1de20,0x10,0xaa30,0x30,0x1de30,0x18
.long 0xaa40,0x40,0x1de40,0x80,0xaa50,0x50,0x1de50,0x88
.long 0xaa60,0x60,0x1de60,0x90,0xaa70,0x70,0x1de70,0x98
.long 0x14400,0x2880,0x27800,0x100,0x14410,0x2890,0x27810,0x108
.long 0x14420,0x28a0,0x27820,0x110,0x14430,0x28b0,0x27830,0x118
.long 0x14440,0x28c0,0x27840,0x180,0x14450,0x28d0,0x27850,0x188
.long 0x14460,0x28e0,0x27860,0x190,0x14470,0x28f0,0x27870,0x198
.long 0xab00,0x5100,0x1df00,0x20,0xab10,0x5110,0x1df10,0x28
.long 0xab20,0x5120,0x1df20,0x30,0xab30,0x5130,0x1df30,0x38
.long 0xab40,0x5140,0x1df40,0xa0,0xab50,0x5150,0x1df50,0xa8
.long 0xab60,0x5160,0x1df60,0xb0,0xab70,0x5170,0x1df70,0xb8
.long 0x14500,0x7980,0x27900,0x120,0x14510,0x7990,0x27910,0x128
.long 0x14520,0x79a0,0x27920,0x130,0x14530,0x79b0,0x27930,0x138
.long 0x14540,0x79c0,0x27940,0x1a0,0x14550,0x79d0,0x27950,0x1a8
.long 0x14560,0x79e0,0x27960,0x1b0,0x14570,0x79f0,0x27970,0x1b8
.long 0xac00,0xa200,0x1e000,0x40,0xac10,0xa210,0x1e010,0x48
.long 0xac20,0xa220,0x1e020,0x50,0xac30,0xa230,0x1e030,0x58
.long 0xac40,0xa240,0x1e040,0xc0,0xac50,0xa250,0x1e050,0xc8
.long 0xac60,0xa260,0x1e060,0xd0,0xac70,0xa270,0x1e070,0xd8
.long 0x14600,0xca80,0x27a00,0x140,0x14610,0xca90,0x27a10,0x148
.long 0x14620,0xcaa0,0x27a20,0x150,0x14630,0xcab0,0x27a30,0x158
.long 0x14640,0xcac0,0x27a40,0x1c0,0x14650,0xcad0,0x27a50,0x1c8
.long 0x14660,0xcae0,0x27a60,0x1d0,0x14670,0xcaf0,0x27a70,0x1d8
.long 0xad00,0xf300,0x1e100,0x60,0xad10,0xf310,0x1e110,0x68
.long 0xad20,0xf320,0x1e120,0x70,0xad30,0xf330,0x1e130,0x78
.long 0xad40,0xf340,0x1e140,0xe0,0xad50,0xf350,0x1e150,0xe8
.long 0xad60,0xf360,0x1e160,0xf0,0xad70,0xf370,0x1e170,0xf8
.long 0x14700,0x11b80,0x27b00,0x160,0x14710,0x11b90,0x27b10,0x168
.long 0x14720,0x11ba0,0x27b20,0x170,0x14730,0x11bb0,0x27b30,0x178
.long 0x14740,0x11bc0,0x27b40,0x1e0,0x14750,0x11bd0,0x27b50,0x1e8
.long 0x14760,0x11be0,0x27b60,0x1f0,0x14770,0x11bf0,0x27b70,0x1f8
.long 0xaa00,0x0,0x1de00,0x0,0xaa10,0x10,0x1de10,0x8
.long 0xaa20,0x20,0x1de20,0x10,0xaa30,0x30,0x1de30,0x18
.long 0xaa40,0x40,0x1de40,0x80,0xaa50,0x50,0x1de50,0x88
.long 0xaa60,0x60,0x1de60,0x90,0xaa70,0x70,0x1de70,0x98
.long 0x14400,0x2880,0x27800,0x100,0x14410,0x2890,0x27810,0x108
.long 0x14420,0x28a0,0x27820,0x110,0x14430,0x28b0,0x27830,0x118
.long 0x14440,0x28c0,0x27840,0x180,0x14450,0x28d0,0x27850,0x188
.long 0x14460,0x28e0,0x27860,0x190,0x14470,0x28f0,0x27870,0x198
.long 0xab00,0x5100,0x1df00,0x20,0xab10,0x5110,0x1df10,0x28
.long 0xab20,0x5120,0x1df20,0x30,0xab30,0x5130,0x1df30,0x38
.long 0xab40,0x5140,0x1df40,0xa0,0xab50,0x5150,0x1df50,0xa8
.long 0xab60,0x5160,0x1df60,0xb0,0xab70,0x5170,0x1df70,0xb8
.long 0x14500,0x7980,0x27900,0x120,0x14510,0x7990,0x27910,0x128
.long 0x14520,0x79a0,0x27920,0x130,0x14530,0x79b0,0x27930,0x138
.long 0x14540,0x79c0,0x27940,0x1a0,0x14550,0x79d0,0x27950,0x1a8
.long 0x14560,0x79e0,0x27960,0x1b0,0x14570,0x79f0,0x27970,0x1b8
.long 0xac00,0xa200,0x1e000,0x40,0xac10,0xa210,0x1e010,0x48
.long 0xac20,0xa220,0x1e020,0x50,0xac30,0xa230,0x1e030,0x58
.long 0xac40,0xa240,0x1e040,0xc0,0xac50,0xa250,0x1e050,0xc8
.long 0xac60,0xa260,0x1e060,0xd0,0xac70,0xa270,0x1e070,0xd8
.long 0x14600,0xca80,0x27a00,0x140,0x14610,0xca90,0x27a10,0x148
.long 0x14620,0xcaa0,0x27a20,0x150,0x14630,0xcab0,0x27a30,0x158
.long 0x14640,0xcac0,0x27a40,0x1c0,0x14650,0xcad0,0x27a50,0x1c8
.long 0x14660,0xcae0,0x27a60,0x1d0,0x14670,0xcaf0,0x27a70,0x1d8
.long 0xad00,0xf300,0x1e100,0x60,0xad10,0xf310,0x1e110,0x68
.long 0xad20,0xf320,0x1e120,0x70,0xad30,0xf330,0x1e130,0x78
.long 0xad40,0xf340,0x1e140,0xe0,0xad50,0xf350,0x1e150,0xe8
.long 0xad60,0xf360,0x1e160,0xf0,0xad70,0xf370,0x1e170,0xf8
.long 0x14700,0x11b80,0x27b00,0x160,0x14710,0x11b90,0x27b10,0x168
.long 0x14720,0x11ba0,0x27b20,0x170,0x14730,0x11bb0,0x27b30,0x178
.long 0x14740,0x11bc0,0x27b40,0x1e0,0x14750,0x11bd0,0x27b50,0x1e8
.long 0x14760,0x11be0,0x27b60,0x1f0,0x14770,0x11bf0,0x27b70,0x1f8
.size chain_tbl, 28672
.p2align 8
.type role_tbl,@object
role_tbl:
.long 0xff0000,0xff0004,0xff0007,0xff0504,0xff0507,0xff0a04,0xff0a07,0xff0f04
.long 0xff0100,0xff0104,0xff0107,0xff0604,0xff0607,0xff0b04,0xff0b07,0xff1004
.long 0xff0200,0xff0204,0xff0207,0xff0704,0xff0707,0xff0c04,0xff0c07,0xff1104
.long 0xff0300,0xff0304,0xff0307,0xff0804,0xff0807,0xff0d04,0xff0d07,0xff1204
.long 0xff0400,0xff0404,0xff0407,0xff0904,0xff0907,0xff0e04,0xff0e07,0xff1304
.long 0xff0500,0xff0f07,0xff1404,0xff1407,0xff1904,0xff1907,0xff1e04,0xff1e07
.long 0xff0600,0xff1007,0xff1504,0xff1507,0xff1a04,0xff1a07,0xff1f04,0xff1f07
.long 0xff0700,0xff1107,0xff1604,0xff1607,0xff1b04,0xff1b07,0xff2004,0xff2007
.long 0xff0800,0xff1207,0xff1704,0xff1707,0xff1c04,0xff1c07,0xff2104,0xff2107
.long 0xff0900,0xff1307,0xff1804,0xff1807,0xff1d04,0xff1d07,0xff2204,0xff2207
.long 0xff0a00,0xff2304,0xff2307,0xff0001,0xff0101,0xff0201,0xff0301,0xff0401
.long 0xff0b00,0xff2404,0xff2407,0xff0501,0xff0601,0xff0701,0xff0801,0xff0901
.long 0xff0c00,0xff2504,0xff2507,0xff0a01,0xff0b01,0xff0c01,0xff0d01,0xff0e01
.long 0xff0d00,0xff2604,0xff2607,0xff0f01,0xff1001,0xff1101,0xff1201,0xff1301
.long 0xff0e00,0xff2704,0xff2707,0xff1401,0xff1501,0xff1601,0xff1701,0xff1801
.long 0xff0f00,0xff1901,0xff1a01,0xff1b01,0xff1c01,0xff1d01,0xff1e01,0xff1f01
.long 0xff1000,0xff0002,0xff0102,0xff0202,0xff0302,0xff0402,0xff0502,0xff0602
.long 0xff1100,0xff0702,0xff0802,0xff0902,0xff0a02,0xff0b02,0xff0c02,0xff0d02
.long 0xff1200,0xff0e02,0xff0f02,0x1c0003,0x1d0103,0x1e0203,0x1f0303,0x200403
.long 0xff1300,0x210503,0x220603,0x230703,0x240803,0x250903,0x260a03,0x270b03
.long 0xff1400,0x280c03,0x290d03,0x2a0e03,0x2b0f03,0x2c1003,0x2d1103,0x2e1203
.long 0xff1500,0x2f1303,0x301403,0x311503,0x321603,0x331703,0x341803,0x351903
.long 0xff1600,0x361a03,0x371b03,0x381c03,0x391d03,0x3a1e03,0x3b1f03,0xff0006
.long 0xff1700,0xff0106,0xff0206,0xff0306,0xff0406,0xff0506,0xff0606,0xff0706
.long 0xff1800,0xff0806,0xff0906,0xff0a06,0xff0b06,0xff0c06,0xff0d06,0xff0e06
.long 0xff1900,0xff0f06,0xff1006,0xff1106,0xff1206,0xff1306,0xff1406,0xff1506
.long 0xff1a00,0xff1606,0xff1706,0xff1806,0xff1906,0xff1a06,0xff1b06,0xff1c06
.long 0xff1b00,0xff1d06,0xff1e06,0xff1f06,0xff2006,0xff2106,0xff2206,0xff2306
.long 0xff1c00,0x100005,0x110105,0x120205,0x130305,0x140405,0x150505,0x160605
.long 0xff1d00,0x170705,0x180805,0x190905,0x1a0a05,0x1b0b05,0x40008,0x50108
.long 0xff1e00,0x60208,0x70308,0x80408,0x90508,0xa0608,0xb0708,0xc0808
.long 0xff1f00,0xd0908,0xe0a08,0xf0b08,0x9,0x10109,0x20209,0x30309
.long 0x0,0x0,0x0,0x800,0x10,0x8,0x10,0x810
.long 0x20,0x10,0x20,0x820,0x30,0x18,0x30,0x830
.long 0x40,0x140,0x40,0x840,0x50,0x148,0x50,0x850
.long 0x60,0x150,0x60,0x860,0x70,0x158,0x70,0x870
.long 0x80,0x280,0x400,0x880,0x90,0x288,0x410,0x890
.long 0xa0,0x290,0x420,0x8a0,0xb0,0x298,0x430,0x8b0
.long 0xc0,0x3c0,0x440,0x8c0,0xd0,0x3c8,0x450,0x8d0
.long 0xe0,0x3d0,0x460,0x8e0,0xf0,0x3d8,0x470,0x8f0
.long 0x2040,0x20,0x80,0xc00,0x2050,0x28,0x90,0xc10
.long 0x2060,0x30,0xa0,0xc20,0x2070,0x38,0xb0,0xc30
.long 0x2000,0x160,0xc0,0xc40,0x2010,0x168,0xd0,0xc50
.long 0x2020,0x170,0xe0,0xc60,0x2030,0x178,0xf0,0xc70
.long 0x20c0,0x2a0,0x480,0xc80,0x20d0,0x2a8,0x490,0xc90
.long 0x20e0,0x2b0,0x4a0,0xca0,0x20f0,0x2b8,0x4b0,0xcb0
.long 0x2080,0x3e0,0x4c0,0xcc0,0x2090,0x3e8,0x4d0,0xcd0
.long 0x20a0,0x3f0,0x4e0,0xce0,0x20b0,0x3f8,0x4f0,0xcf0
.long 0x4080,0x800,0x100,0x900,0x4090,0x808,0x110,0x910
.long 0x40a0,0x810,0x120,0x920,0x40b0,0x818,0x130,0x930
.long 0x40c0,0x940,0x140,0x940,0x40d0,0x948,0x150,0x950
.long 0x40e0,0x950,0x160,0x960,0x40f0,0x958,0x170,0x970
.long 0x4000,0xa80,0x500,0x980,0x4010,0xa88,0x510,0x990
.long 0x4020,0xa90,0x520,0x9a0,0x4030,0xa98,0x530,0x9b0
.long 0x4040,0xbc0,0x540,0x9c0,0x4050,0xbc8,0x550,0x9d0
.long 0x4060,0xbd0,0x560,0x9e0,0x4070,0xbd8,0x570,0x9f0
.long 0x60c0,0x820,0x180,0xd00,0x60d0,0x828,0x190,0xd10
.long 0x60e0,0x830,0x1a0,0xd20,0x60f0,0x838,0x1b0,0xd30
.long 0x6080,0x960,0x1c0,0xd40,0x6090,0x968,0x1d0,0xd50
.long 0x60a0,0x970,0x1e0,0xd60,0x60b0,0x978,0x1f0,0xd70
.long 0x6040,0xaa0,0x580,0xd80,0x6050,0xaa8,0x590,0xd90
.long 0x6060,0xab0,0x5a0,0xda0,0x6070,0xab8,0x5b0,0xdb0
.long 0x6000,0xbe0,0x5c0,0xdc0,0x6010,0xbe8,0x5d0,0xdd0
.long 0x6020,0xbf0,0x5e0,0xde0,0x6030,0xbf8,0x5f0,0xdf0
.long 0x0,0x400,0x0,0x0,0x4,0x410,0x0,0x0
.long 0x8,0x420,0x0,0x0,0xc,0x430,0x0,0x0
.long 0x0,0x440,0x0,0x0,0x4,0x450,0x0,0x0
.long 0x8,0x460,0x0,0x0,0xc,0x470,0x0,0x0
.long 0x0,0x80,0x0,0x0,0x4,0x90,0x0,0x0
.long 0x8,0xa0,0x0,0x0,0xc,0xb0,0x0,0x0
.long 0x0,0xc0,0x0,0x0,0x4,0xd0,0x0,0x0
.long 0x8,0xe0,0x0,0x0,0xc,0xf0,0x0,0x0
.long 0x0,0x480,0x0,0x0,0x4,0x490,0x0,0x0
.long 0x8,0x4a0,0x0,0x0,0xc,0x4b0,0x0,0x0
.long 0x0,0x4c0,0x0,0x0,0x4,0x4d0,0x0,0x0
.long 0x8,0x4e0,0x0,0x0,0xc,0x4f0,0x0,0x0
.long 0x0,0x180,0x0,0x0,0x4,0x190,0x0,0x0
.long 0x8,0x1a0,0x0,0x0,0xc,0x1b0,0x0,0x0
.long 0x0,0x1c0,0x0,0x0,0x4,0x1d0,0x0,0x0
.long 0x8,0x1e0,0x0,0x0,0xc,0x1f0,0x0,0x0
.long 0x0,0x500,0x0,0x0,0x4,0x510,0x0,0x0
.long 0x8,0x520,0x0,0x0,0xc,0x530,0x0,0x0
.long 0x0,0x540,0x0,0x0,0x4,0x550,0x0,0x0
.long 0x8,0x560,0x0,0x0,0xc,0x570,0x0,0x0
.long 0x0,0x280,0x0,0x0,0x4,0x290,0x0,0x0
.long 0x8,0x2a0,0x0,0x0,0xc,0x2b0,0x0,0x0
.long 0x0,0x2c0,0x0,0x0,0x4,0x2d0,0x0,0x0
.long 0x8,0x2e0,0x0,0x0,0xc,0x2f0,0x0,0x0
.long 0x0,0x580,0x0,0x0,0x4,0x590,0x0,0x0
.long 0x8,0x5a0,0x0,0x0,0xc,0x5b0,0x0,0x0
.long 0x0,0x5c0,0x0,0x0,0x4,0x5d0,0x0,0x0
.long 0x8,0x5e0,0x0,0x0,0xc,0x5f0,0x0,0x0
.long 0x0,0x380,0x0,0x0,0x4,0x390,0x0,0x0
.long 0x8,0x3a0,0x0,0x0,0xc,0x3b0,0x0,0x0
.long 0x0,0x3c0,0x0,0x0,0x4,0x3d0,0x0,0x0
.long 0x8,0x3e0,0x0,0x0,0xc,0x3f0,0x0,0x0
.long 0x0,0x0,0x0,0x2000,0x10,0x8,0x10,0x2010
.long 0x20,0x10,0x20,0x2020,0x30,0x18,0x30,0x2030
.long 0x40,0x140,0x40,0x2040,0x50,0x148,0x50,0x2050
.long 0x60,0x150,0x60,0x2060,0x70,0x158,0x70,0x2070
.long 0x80,0x280,0x80,0x2080,0x90,0x288,0x90,0x2090
.long 0xa0,0x290,0xa0,0x20a0,0xb0,0x298,0xb0,0x20b0
.long 0xc0,0x3c0,0xc0,0x20c0,0xd0,0x3c8,0xd0,0x20d0
.long 0xe0,0x3d0,0xe0,0x20e0,0xf0,0x3d8,0xf0,0x20f0
.long 0x2040,0x20,0x1000,0x3000,0x2050,0x28,0x1010,0x3010
.long 0x2060,0x30,0x1020,0x3020,0x2070,0x38,0x1030,0x3030
.long 0x2000,0x160,0x1040,0x3040,0x2010,0x168,0x1050,0x3050
.long 0x2020,0x170,0x1060,0x3060,0x2030,0x178,0x1070,0x3070
.long 0x20c0,0x2a0,0x1080,0x3080,0x20d0,0x2a8,0x1090,0x3090
.long 0x20e0,0x2b0,0x10a0,0x30a0,0x20f0,0x2b8,0x10b0,0x30b0
.long 0x2080,0x3e0,0x10c0,0x30c0,0x2090,0x3e8,0x10d0,0x30d0
.long 0x20a0,0x3f0,0x10e0,0x30e0,0x20b0,0x3f8,0x10f0,0x30f0
.long 0x4080,0x800,0x100,0x2100,0x4090,0x808,0x110,0x2110
.long 0x40a0,0x810,0x120,0x2120,0x40b0,0x818,0x130,0x2130
.long 0x40c0,0x940,0x140,0x2140,0x40d0,0x948,0x150,0x2150
.long 0x40e0,0x950,0x160,0x2160,0x40f0,0x958,0x170,0x2170
.long 0x4000,0xa80,0x180,0x2180,0x4010,0xa88,0x190,0x2190
.long 0x4020,0xa90,0x1a0,0x21a0,0x4030,0xa98,0x1b0,0x21b0
.long 0x4040,0xbc0,0x1c0,0x21c0,0x4050,0xbc8,0x1d0,0x21d0
.long 0x4060,0xbd0,0x1e0,0x21e0,0x4070,0xbd8,0x1f0,0x21f0
.long 0x60c0,0x820,0x1100,0x3100,0x60d0,0x828,0x1110,0x3110
.long 0x60e0,0x830,0x1120,0x3120,0x60f0,0x838,0x1130,0x3130
.long 0x6080,0x960,0x1140,0x3140,0x6090,0x968,0x1150,0x3150
.long 0x60a0,0x970,0x1160,0x3160,0x60b0,0x978,0x1170,0x3170
.long 0x6040,0xaa0,0x1180,0x3180,0x6050,0xaa8,0x1190,0x3190
.long 0x6060,0xab0,0x11a0,0x31a0,0x6070,0xab8,0x11b0,0x31b0
.long 0x6000,0xbe0,0x11c0,0x31c0,0x6010,0xbe8,0x11d0,0x31d0
.long 0x6020,0xbf0,0x11e0,0x31e0,0x6030,0xbf8,0x11f0,0x31f0
.long 0x0,0x0,0x0,0x0,0x4,0x0,0x0,0x0
.long 0x8,0x0,0x0,0x0,0xc,0x0,0x0,0x0
.long 0x0,0x0,0x0,0x0,0x4,0x0,0x0,0x0
.long 0x8,0x0,0x0,0x0,0xc,0x0,0x0,0x0
.long 0x0,0x0,0x0,0x0,0x4,0x0,0x0,0x0
.long 0x8,0x0,0x0,0x0,0xc,0x0,0x0,0x0
.long 0x0,0x0,0x0,0x0,0x4,0x0,0x0,0x0
.long 0x8,0x0,0x0,0x0,0xc,0x0,0x0,0x0
.long 0x0,0x0,0x0,0x0,0x4,0x0,0x0,0x0
.long 0x8,0x0,0x0,0x0,0xc,0x0,0x0,0x0
.long 0x0,0x0,0x0,0x0,0x4,0x0,0x0,0x0
.long 0x8,0x0,0x0,0x0,0xc,0x0,0x0,0x0
.long 0x0,0x0,0x0,0x0,0x4,0x0,0x0,0x0
.long 0x8,0x0,0x0,0x0,0xc,0x0,0x0,0x0
.long 0x0,0x0,0x0,0x0,0x4,0x0,0x0,0x0
.long 0x8,0x0,0x0,0x0,0xc,0x0,0x0,0x0
.long 0x0,0x0,0x0,0x0,0x4,0x0,0x0,0x0
.long 0x8,0x0,0x0,0x0,0xc,0x0,0x0,0x0
.long 0x0,0x0,0x0,0x0,0x4,0x0,0x0,0x0
.long 0x8,0x0,0x0,0x0,0xc,0x0,0x0,0x0
.long 0x0,0x0,0x0,0x0,0x4,0x0,0x0,0x0
.long 0x8,0x0,0x0,0x0,0xc,0x0,0x0,0x0
.long 0x0,0x0,0x0,0x0,0x4,0x0,0x0,0x0
.long 0x8,0x0,0x0,0x0,0xc,0x0,0x0,0x0
.long 0x0,0x0,0x0,0x0,0x4,0x0,0x0,0x0
.long 0x8,0x0,0x0,0x0,0xc,0x0,0x0,0x0
.long 0x0,0x0,0x0,0x0,0x4,0x0,0x0,0x0
.long 0x8,0x0,0x0,0x0,0xc,0x0,0x0,0x0
.long 0x0,0x0,0x0,0x0,0x4,0x0,0x0,0x0
.long 0x8,0x0,0x0,0x0,0xc,0x0,0x0,0x0
.long 0x0,0x0,0x0,0x0,0x4,0x0,0x0,0x0
.long 0x8,0x0,0x0,0x0,0xc,0x0,0x0,0x0
.long 0x0,0x0,0x0,0x0,0x10,0x8,0x10,0x0
.long 0x20,0x10,0x20,0x0,0x30,0x18,0x30,0x0
.long 0x40,0x140,0x40,0x0,0x50,0x148,0x50,0x0
.long 0x60,0x150,0x60,0x0,0x70,0x158,0x70,0x0
.long 0x80,0x280,0x80,0x0,0x90,0x288,0x90,0x0
.long 0xa0,0x290,0xa0,0x0,0xb0,0x298,0xb0,0x0
.long 0xc0,0x3c0,0xc0,0x0,0xd0,0x3c8,0xd0,0x0
.long 0xe0,0x3d0,0xe0,0x0,0xf0,0x3d8,0xf0,0x0
.long 0x2440,0x20,0x100,0x0,0x2450,0x28,0x110,0x0
.long 0x2460,0x30,0x120,0x0,0x2470,0x38,0x130,0x0
.long 0x2400,0x160,0x140,0x0,0x2410,0x168,0x150,0x0
.long 0x2420,0x170,0x160,0x0,0x2430,0x178,0x170,0x0
.long 0x24c0,0x2a0,0x180,0x0,0x24d0,0x2a8,0x190,0x0
.long 0x24e0,0x2b0,0x1a0,0x0,0x24f0,0x2b8,0x1b0,0x0
.long 0x2480,0x3e0,0x1c0,0x0,0x2490,0x3e8,0x1d0,0x0
.long 0x24a0,0x3f0,0x1e0,0x0,0x24b0,0x3f8,0x1f0,0x0
.long 0x4880,0x400,0x200,0x0,0x4890,0x408,0x210,0x0
.long 0x48a0,0x410,0x220,0x0,0x48b0,0x418,0x230,0x0
.long 0x48c0,0x540,0x240,0x0,0x48d0,0x548,0x250,0x0
.long 0x48e0,0x550,0x260,0x0,0x48f0,0x558,0x270,0x0
.long 0x4800,0x680,0x280,0x0,0x4810,0x688,0x290,0x0
.long 0x4820,0x690,0x2a0,0x0,0x4830,0x698,0x2b0,0x0
.long 0x4840,0x7c0,0x2c0,0x0,0x4850,0x7c8,0x2d0,0x0
.long 0x4860,0x7d0,0x2e0,0x0,0x4870,0x7d8,0x2f0,0x0
.long 0x6cc0,0x420,0x300,0x0,0x6cd0,0x428,0x310,0x0
.long 0x6ce0,0x430,0x320,0x0,0x6cf0,0x438,0x330,0x0
.long 0x6c80,0x560,0x340,0x0,0x6c90,0x568,0x350,0x0
.long 0x6ca0,0x570,0x360,0x0,0x6cb0,0x578,0x370,0x0
.long 0x6c40,0x6a0,0x380,0x0,0x6c50,0x6a8,0x390,0x0
.long 0x6c60,0x6b0,0x3a0,0x0,0x6c70,0x6b8,0x3b0,0x0
.long 0x6c00,0x7e0,0x3c0,0x0,0x6c10,0x7e8,0x3d0,0x0
.long 0x6c20,0x7f0,0x3e0,0x0,0x6c30,0x7f8,0x3f0,0x0
.long 0x0,0x0,0x0,0x0,0x4,0x80,0x0,0x0
.long 0x8,0x100,0x0,0x0,0x80,0x180,0x0,0x0
.long 0x84,0x400,0x0,0x0,0x88,0x480,0x0,0x0
.long 0x100,0x500,0x0,0x0,0x104,0x580,0x0,0x0
.long 0x108,0x800,0x0,0x0,0x180,0x880,0x0,0x0
.long 0x184,0x900,0x0,0x0,0x188,0x980,0x0,0x0
.long 0x200,0xc00,0x0,0x0,0x204,0xc80,0x0,0x0
.long 0x208,0xd00,0x0,0x0,0x280,0xd80,0x0,0x0
.long 0x284,0x1000,0x0,0x0,0x288,0x1080,0x0,0x0
.long 0x300,0x1100,0x0,0x0,0x304,0x1180,0x0,0x0
.long 0x308,0x1400,0x0,0x0,0x380,0x1480,0x0,0x0
.long 0x384,0x1500,0x0,0x0,0x388,0x1580,0x0,0x0
.long 0x400,0x1800,0x0,0x0,0x404,0x1880,0x0,0x0
.long 0x408,0x1900,0x0,0x0,0x480,0x1980,0x0,0x0
.long 0x484,0x1c00,0x0,0x0,0x488,0x1c80,0x0,0x0
.long 0x500,0x1d00,0x0,0x0,0x504,0x1d80,0x0,0x0
.long 0x508,0x2000,0x0,0x0,0x580,0x2080,0x0,0x0
.long 0x584,0x2100,0x0,0x0,0x588,0x2180,0x0,0x0
.long 0x0,0x2000,0x0,0x0,0x4,0x2080,0x0,0x0
.long 0x8,0x2100,0x0,0x0,0x80,0x2180,0x0,0x0
.long 0x84,0x2000,0x0,0x0,0x88,0x2080,0x0,0x0
.long 0x100,0x2100,0x0,0x0,0x104,0x2180,0x0,0x0
.long 0x108,0x2000,0x0,0x0,0x180,0x2080,0x0,0x0
.long 0x184,0x2100,0x0,0x0,0x188,0x2180,0x0,0x0
.long 0x200,0x2000,0x0,0x0,0x204,0x2080,0x0,0x0
.long 0x208,0x2100,0x0,0x0,0x280,0x2180,0x0,0x0
.long 0x284,0x2000,0x0,0x0,0x288,0x2080,0x0,0x0
.long 0x300,0x2100,0x0,0x0,0x304,0x2180,0x0,0x0
.long 0x308,0x2000,0x0,0x0,0x380,0x2080,0x0,0x0
.long 0x384,0x2100,0x0,0x0,0x388,0x2180,0x0,0x0
.long 0x400,0x2000,0x0,0x0,0x404,0x2080,0x0,0x0
.long 0x408,0x2100,0x0,0x0,0x480,0x2180,0x0,0x0
.long 0x0,0x0,0x0,0x0,0x10,0x8,0x10,0x0
.long 0x20,0x10,0x20,0x0,0x30,0x18,0x30,0x0
.long 0x40,0x140,0x40,0x0,0x50,0x148,0x50,0x0
.long 0x60,0x150,0x60,0x0,0x70,0x158,0x70,0x0
.long 0x80,0x280,0x80,0x0,0x90,0x288,0x90,0x0
.long 0xa0,0x290,0xa0,0x0,0xb0,0x298,0xb0,0x0
.long 0xc0,0x3c0,0xc0,0x0,0xd0,0x3c8,0xd0,0x0
.long 0xe0,0x3d0,0xe0,0x0,0xf0,0x3d8,0xf0,0x0
.long 0x4c0,0x20,0x100,0x0,0x4d0,0x28,0x110,0x0
.long 0x4e0,0x30,0x120,0x0,0x4f0,0x38,0x130,0x0
.long 0x480,0x160,0x140,0x0,0x490,0x168,0x150,0x0
.long 0x4a0,0x170,0x160,0x0,0x4b0,0x178,0x170,0x0
.long 0x540,0x2a0,0x180,0x0,0x550,0x2a8,0x190,0x0
.long 0x560,0x2b0,0x1a0,0x0,0x570,0x2b8,0x1b0,0x0
.long 0x500,0x3e0,0x1c0,0x0,0x510,0x3e8,0x1d0,0x0
.long 0x520,0x3f0,0x1e0,0x0,0x530,0x3f8,0x1f0,0x0
.long 0x980,0x400,0x200,0x0,0x990,0x408,0x210,0x0
.long 0x9a0,0x410,0x220,0x0,0x9b0,0x418,0x230,0x0
.long 0x9c0,0x540,0x240,0x0,0x9d0,0x548,0x250,0x0
.long 0x9e0,0x550,0x260,0x0,0x9f0,0x558,0x270,0x0
.long 0x900,0x680,0x280,0x0,0x910,0x688,0x290,0x0
.long 0x920,0x690,0x2a0,0x0,0x930,0x698,0x2b0,0x0
.long 0x940,0x7c0,0x2c0,0x0,0x950,0x7c8,0x2d0,0x0
.long 0x960,0x7d0,0x2e0,0x0,0x970,0x7d8,0x2f0,0x0
.long 0xe40,0x420,0x300,0x0,0xe50,0x428,0x310,0x0
.long 0xe60,0x430,0x320,0x0,0xe70,0x438,0x330,0x0
.long 0xe00,0x560,0x340,0x0,0xe10,0x568,0x350,0x0
.long 0xe20,0x570,0x360,0x0,0xe30,0x578,0x370,0x0
.long 0xdc0,0x6a0,0x380,0x0,0xdd0,0x6a8,0x390,0x0
.long 0xde0,0x6b0,0x3a0,0x0,0xdf0,0x6b8,0x3b0,0x0
.long 0xd80,0x7e0,0x3c0,0x0,0xd90,0x7e8,0x3d0,0x0
.long 0xda0,0x7f0,0x3e0,0x0,0xdb0,0x7f8,0x3f0,0x0
.long 0x0,0x0,0x0,0x0,0x4,0x100,0x0,0x0
.long 0x8,0x400,0x0,0x0,0xc,0x500,0x0,0x0
.long 0x80,0x800,0x0,0x0,0x84,0x900,0x0,0x0
.long 0x88,0xc00,0x0,0x0,0x8c,0xd00,0x0,0x0
.long 0x100,0x1000,0x0,0x0,0x104,0x1100,0x0,0x0
.long 0x108,0x1400,0x0,0x0,0x10c,0x1500,0x0,0x0
.long 0x180,0x1800,0x0,0x0,0x184,0x1900,0x0,0x0
.long 0x188,0x1c00,0x0,0x0,0x18c,0x1d00,0x0,0x0
.long 0x0,0x0,0x0,0x0,0x4,0x100,0x0,0x0
.long 0x8,0x400,0x0,0x0,0xc,0x500,0x0,0x0
.long 0x80,0x800,0x0,0x0,0x84,0x900,0x0,0x0
.long 0x88,0xc00,0x0,0x0,0x8c,0xd00,0x0,0x0
.long 0x100,0x1000,0x0,0x0,0x104,0x1100,0x0,0x0
.long 0x108,0x1400,0x0,0x0,0x10c,0x1500,0x0,0x0
.long 0x180,0x1800,0x0,0x0,0x184,0x1900,0x0,0x0
.long 0x188,0x1c00,0x0,0x0,0x18c,0x1d00,0x0,0x0
.long 0x0,0x0,0x0,0x0,0x4,0x100,0x0,0x0
.long 0x8,0x400,0x0,0x0,0xc,0x500,0x0,0x0
.long 0x80,0x800,0x0,0x0,0x84,0x900,0x0,0x0
.long 0x88,0xc00,0x0,0x0,0x8c,0xd00,0x0,0x0
.long 0x100,0x1000,0x0,0x0,0x104,0x1100,0x0,0x0
.long 0x108,0x1400,0x0,0x0,0x10c,0x1500,0x0,0x0
.long 0x180,0x1800,0x0,0x0,0x184,0x1900,0x0,0x0
.long 0x188,0x1c00,0x0,0x0,0x18c,0x1d00,0x0,0x0
.long 0x0,0x0,0x0,0x0,0x4,0x100,0x0,0x0
.long 0x8,0x400,0x0,0x0,0xc,0x500,0x0,0x0
.long 0x80,0x800,0x0,0x0,0x84,0x900,0x0,0x0
.long 0x88,0xc00,0x0,0x0,0x8c,0xd00,0x0,0x0
.long 0x100,0x1000,0x0,0x0,0x104,0x1100,0x0,0x0
.long 0x108,0x1400,0x0,0x0,0x10c,0x1500,0x0,0x0
.long 0x180,0x1800,0x0,0x0,0x184,0x1900,0x0,0x0
.long 0x188,0x1c00,0x0,0x0,0x18c,0x1d00,0x0,0x0
.long 0x0,0x0,0x0,0x0,0x10,0x8,0x10,0x0
.long 0x20,0x10,0x20,0x0,0x30,0x18,0x30,0x0
.long 0x40,0x140,0x40,0x0,0x50,0x148,0x50,0x0
.long 0x60,0x150,0x60,0x0,0x70,0x158,0x70,0x0
.long 0x80,0x280,0x80,0x0,0x90,0x288,0x90,0x0
.long 0xa0,0x290,0xa0,0x0,0xb0,0x298,0xb0,0x0
.long 0xc0,0x3c0,0xc0,0x0,0xd0,0x3c8,0xd0,0x0
.long 0xe0,0x3d0,0xe0,0x0,0xf0,0x3d8,0xf0,0x0
.long 0x4c0,0x20,0x100,0x0,0x4d0,0x28,0x110,0x0
.long 0x4e0,0x30,0x120,0x0,0x4f0,0x38,0x130,0x0
.long 0x480,0x160,0x140,0x0,0x490,0x168,0x150,0x0
.long 0x4a0,0x170,0x160,0x0,0x4b0,0x178,0x170,0x0
.long 0x540,0x2a0,0x180,0x0,0x550,0x2a8,0x190,0x0
.long 0x560,0x2b0,0x1a0,0x0,0x570,0x2b8,0x1b0,0x0
.long 0x500,0x3e0,0x1c0,0x0,0x510,0x3e8,0x1d0,0x0
.long 0x520,0x3f0,0x1e0,0x0,0x530,0x3f8,0x1f0,0x0
.long 0x980,0x400,0x200,0x0,0x990,0x408,0x210,0x0
.long 0x9a0,0x410,0x220,0x0,0x9b0,0x418,0x230,0x0
.long 0x9c0,0x540,0x240,0x0,0x9d0,0x548,0x250,0x0
.long 0x9e0,0x550,0x260,0x0,0x9f0,0x558,0x270,0x0
.long 0x900,0x680,0x280,0x0,0x910,0x688,0x290,0x0
.long 0x920,0x690,0x2a0,0x0,0x930,0x698,0x2b0,0x0
.long 0x940,0x7c0,0x2c0,0x0,0x950,0x7c8,0x2d0,0x0
.long 0x960,0x7d0,0x2e0,0x0,0x970,0x7d8,0x2f0,0x0
.long 0xe40,0x420,0x300,0x0,0xe50,0x428,0x310,0x0
.long 0xe60,0x430,0x320,0x0,0xe70,0x438,0x330,0x0
.long 0xe00,0x560,0x340,0x0,0xe10,0x568,0x350,0x0
.long 0xe20,0x570,0x360,0x0,0xe30,0x578,0x370,0x0
.long 0xdc0,0x6a0,0x380,0x0,0xdd0,0x6a8,0x390,0x0
.long 0xde0,0x6b0,0x3a0,0x0,0xdf0,0x6b8,0x3b0,0x0
.long 0xd80,0x7e0,0x3c0,0x0,0xd90,0x7e8,0x3d0,0x0
.long 0xda0,0x7f0,0x3e0,0x0,0xdb0,0x7f8,0x3f0,0x0
.long 0x0,0x0,0x0,0x0,0x1,0x400,0x0,0x0
.long 0x2,0x800,0x0,0x0,0x3,0xc00,0x0,0x0
.long 0x4,0x1000,0x0,0x0,0x5,0x1400,0x0,0x0
.long 0x6,0x1800,0x0,0x0,0x7,0x1c00,0x0,0x0
.long 0x8,0x2000,0x0,0x0,0x9,0x2000,0x0,0x0
.long 0xa,0x2000,0x0,0x0,0xb,0x2000,0x0,0x0
.long 0xc,0x2000,0x0,0x0,0xd,0x2000,0x0,0x0
.long 0xe,0x2000,0x0,0x0,0xf,0x2000,0x0,0x0
.long 0x10,0x2000,0x0,0x0,0x11,0x2000,0x0,0x0
.long 0x0,0x2000,0x0,0x0,0x1,0x2000,0x0,0x0
.long 0x2,0x2000,0x0,0x0,0x3,0x2000,0x0,0x0
.long 0x4,0x2000,0x0,0x0,0x5,0x2000,0x0,0x0
.long 0x6,0x2000,0x0,0x0,0x7,0x2000,0x0,0x0
.long 0x8,0x2000,0x0,0x0,0x9,0x2000,0x0,0x0
.long 0xa,0x2000,0x0,0x0,0xb,0x2000,0x0,0x0
.long 0xc,0x2000,0x0,0x0,0xd,0x2000,0x0,0x0
.long 0xe,0x2000,0x0,0x0,0xf,0x2000,0x0,0x0
.long 0x10,0x2000,0x0,0x0,0x11,0x2000,0x0,0x0
.long 0x0,0x2000,0x0,0x0,0x1,0x2000,0x0,0x0
.long 0x2,0x2000,0x0,0x0,0x3,0x2000,0x0,0x0
.long 0x4,0x2000,0x0,0x0,0x5,0x2000,0x0,0x0
.long 0x6,0x2000,0x0,0x0,0x7,0x2000,0x0,0x0
.long 0x8,0x2000,0x0,0x0,0x9,0x2000,0x0,0x0
.long 0xa,0x2000,0x0,0x0,0xb,0x2000,0x0,0x0
.long 0xc,0x2000,0x0,0x0,0xd,0x2000,0x0,0x0
.long 0xe,0x2000,0x0,0x0,0xf,0x2000,0x0,0x0
.long 0x10,0x2000,0x0,0x0,0x11,0x2000,0x0,0x0
.long 0x0,0x2000,0x0,0x0,0x1,0x2000,0x0,0x0
.long 0x2,0x2000,0x0,0x0,0x3,0x2000,0x0,0x0
.long 0x4,0x2000,0x0,0x0,0x5,0x2000,0x0,0x0
.long 0x6,0x2000,0x0,0x0,0x7,0x2000,0x0,0x0
.long 0x8,0x2000,0x0,0x0,0x9,0x2000,0x0,0x0
.long 0x0,0x0,0x0,0x0,0x10,0x1,0x4,0x0
.long 0x20,0x2,0x8,0x0,0x30,0x3,0xc,0x0
.long 0x40,0x4,0x0,0x1,0x50,0x5,0x4,0x1
.long 0x60,0x6,0x8,0x1,0x70,0x7,0xc,0x1
.long 0x80,0x8,0x0,0x0,0x90,0x9,0x4,0x0
.long 0xa0,0xa,0x8,0x0,0xb0,0xb,0xc,0x0
.long 0xc0,0xc,0x0,0x1,0xd0,0xd,0x4,0x1
.long 0xe0,0xe,0x8,0x1,0xf0,0xf,0xc,0x1
.long 0x200,0xfffffffc,0x0,0x0,0x210,0xfffffffd,0x4,0x0
.long 0x220,0xfffffffe,0x8,0x0,0x230,0xffffffff,0xc,0x0
.long 0x240,0x0,0x0,0x1,0x250,0x1,0x4,0x1
.long 0x260,0x2,0x8,0x1,0x270,0x3,0xc,0x1
.long 0x280,0x4,0x0,0x0,0x290,0x5,0x4,0x0
.long 0x2a0,0x6,0x8,0x0,0x2b0,0x7,0xc,0x0
.long 0x2c0,0x8,0x0,0x1,0x2d0,0x9,0x4,0x1
.long 0x2e0,0xa,0x8,0x1,0x2f0,0xb,0xc,0x1
.long 0x400,0xfffffff0,0x0,0x0,0x410,0xfffffff1,0x4,0x0
.long 0x420,0xfffffff2,0x8,0x0,0x430,0xfffffff3,0xc,0x0
.long 0x440,0xfffffff4,0x0,0x1,0x450,0xfffffff5,0x4,0x1
.long 0x460,0xfffffff6,0x8,0x1,0x470,0xfffffff7,0xc,0x1
.long 0x480,0xfffffff8,0x0,0x0,0x490,0xfffffff9,0x4,0x0
.long 0x4a0,0xfffffffa,0x8,0x0,0x4b0,0xfffffffb,0xc,0x0
.long 0x4c0,0xfffffffc,0x0,0x1,0x4d0,0xfffffffd,0x4,0x1
.long 0x4e0,0xfffffffe,0x8,0x1,0x4f0,0xffffffff,0xc,0x1
.long 0x600,0xffffffec,0x0,0x0,0x610,0xffffffed,0x4,0x0
.long 0x620,0xffffffee,0x8,0x0,0x630,0xffffffef,0xc,0x0
.long 0x640,0xfffffff0,0x0,0x1,0x650,0xfffffff1,0x4,0x1
.long 0x660,0xfffffff2,0x8,0x1,0x670,0xfffffff3,0xc,0x1
.long 0x680,0xfffffff4,0x0,0x0,0x690,0xfffffff5,0x4,0x0
.long 0x6a0,0xfffffff6,0x8,0x0,0x6b0,0xfffffff7,0xc,0x0
.long 0x6c0,0xfffffff8,0x0,0x1,0x6d0,0xfffffff9,0x4,0x1
.long 0x6e0,0xfffffffa,0x8,0x1,0x6f0,0xfffffffb,0xc,0x1
.long 0x0,0x400,0x0,0x0,0x8,0x410,0x0,0x0
.long 0x10,0x420,0x0,0x0,0x18,0x430,0x0,0x0
.long 0x20,0x440,0x0,0x0,0x28,0x450,0x0,0x0
.long 0x30,0x460,0x0,0x0,0x38,0x470,0x0,0x0
.long 0x40,0x80,0x0,0x0,0x48,0x90,0x0,0x0
.long 0x50,0xa0,0x0,0x0,0x58,0xb0,0x0,0x0
.long 0x60,0xc0,0x0,0x0,0x68,0xd0,0x0,0x0
.long 0x70,0xe0,0x0,0x0,0x78,0xf0,0x0,0x0
.long 0x80,0x480,0x0,0x0,0x88,0x490,0x0,0x0
.long 0x90,0x4a0,0x0,0x0,0x98,0x4b0,0x0,0x0
.long 0xa0,0x4c0,0x0,0x0,0xa8,0x4d0,0x0,0x0
.long 0xb0,0x4e0,0x0,0x0,0xb8,0x4f0,0x0,0x0
.long 0xc0,0x180,0x0,0x0,0xc8,0x190,0x0,0x0
.long 0xd0,0x1a0,0x0,0x0,0xd8,0x1b0,0x0,0x0
.long 0xe0,0x1c0,0x0,0x0,0xe8,0x1d0,0x0,0x0
.long 0xf0,0x1e0,0x0,0x0,0xf8,0x1f0,0x0,0x0
.long 0x100,0x500,0x0,0x0,0x108,0x510,0x0,0x0
.long 0x110,0x520,0x0,0x0,0x118,0x530,0x0,0x0
.long 0x120,0x540,0x0,0x0,0x128,0x550,0x0,0x0
.long 0x130,0x560,0x0,0x0,0x138,0x570,0x0,0x0
.long 0x140,0x280,0x0,0x0,0x148,0x290,0x0,0x0
.long 0x150,0x2a0,0x0,0x0,0x158,0x2b0,0x0,0x0
.long 0x160,0x2c0,0x0,0x0,0x168,0x2d0,0x0,0x0
.long 0x170,0x2e0,0x0,0x0,0x178,0x2f0,0x0,0x0
.long 0x180,0x580,0x0,0x0,0x188,0x590,0x0,0x0
.long 0x190,0x5a0,0x0,0x0,0x198,0x5b0,0x0,0x0
.long 0x1a0,0x5c0,0x0,0x0,0x1a8,0x5d0,0x0,0x0
.long 0x1b0,0x5e0,0x0,0x0,0x1b8,0x5f0,0x0,0x0
.long 0x1c0,0x380,0x0,0x0,0x1c8,0x390,0x0,0x0
.long 0x1d0,0x3a0,0x0,0x0,0x1d8,0x3b0,0x0,0x0
.long 0x1e0,0x3c0,0x0,0x0,0x1e8,0x3d0,0x0,0x0
.long 0x1f0,0x3e0,0x0,0x0,0x1f8,0x3f0,0x0,0x0
.long 0x0,0x0,0x0,0x0,0x200,0x8,0x10,0x80
.long 0x400,0x20,0x20,0x100,0x600,0x28,0x30,0x180
.long 0x800,0x40,0x40,0x200,0xa00,0x48,0x50,0x280
.long 0xc00,0x60,0x60,0x300,0xe00,0x68,0x70,0x380
.long 0x10,0x480,0x480,0x400,0x210,0x488,0x490,0x480
.long 0x410,0x4a0,0x4a0,0x500,0x610,0x4a8,0x4b0,0x580
.long 0x810,0x4c0,0x4c0,0x600,0xa10,0x4c8,0x4d0,0x680
.long 0xc10,0x4e0,0x4e0,0x700,0xe10,0x4e8,0x4f0,0x780
.long 0x20,0x900,0x900,0x800,0x220,0x908,0x910,0x880
.long 0x420,0x920,0x920,0x900,0x620,0x928,0x930,0x980
.long 0x820,0x940,0x940,0xa00,0xa20,0x948,0x950,0xa80
.long 0xc20,0x960,0x960,0xb00,0xe20,0x968,0x970,0xb80
.long 0x30,0xd80,0xd80,0xc00,0x230,0xd88,0xd90,0xc80
.long 0x430,0xda0,0xda0,0xd00,0x630,0xda8,0xdb0,0xd80
.long 0x830,0xdc0,0xdc0,0xe00,0xa30,0xdc8,0xdd0,0xe80
.long 0xc30,0xde0,0xde0,0xf00,0xe30,0xde8,0xdf0,0xf80
.long 0x40,0x1200,0x1200,0x1000,0x240,0x1208,0x1210,0x1080
.long 0x440,0x1220,0x1220,0x1100,0x640,0x1228,0x1230,0x1180
.long 0x840,0x1240,0x1240,0x1200,0xa40,0x1248,0x1250,0x1280
.long 0xc40,0x1260,0x1260,0x1300,0xe40,0x1268,0x1270,0x1380
.long 0x50,0x1680,0x1680,0x0,0x250,0x1688,0x1690,0x80
.long 0x450,0x16a0,0x16a0,0x100,0x650,0x16a8,0x16b0,0x180
.long 0x850,0x16c0,0x16c0,0x200,0xa50,0x16c8,0x16d0,0x280
.long 0xc50,0x16e0,0x16e0,0x300,0xe50,0x16e8,0x16f0,0x380
.long 0x60,0x1b00,0x1b00,0x400,0x260,0x1b08,0x1b10,0x480
.long 0x460,0x1b20,0x1b20,0x500,0x660,0x1b28,0x1b30,0x580
.long 0x860,0x1b40,0x1b40,0x600,0xa60,0x1b48,0x1b50,0x680
.long 0xc60,0x1b60,0x1b60,0x700,0xe60,0x1b68,0x1b70,0x780
.long 0x70,0x1f80,0x1f80,0x800,0x270,0x1f88,0x1f90,0x880
.long 0x470,0x1fa0,0x1fa0,0x900,0x670,0x1fa8,0x1fb0,0x980
.long 0x870,0x1fc0,0x1fc0,0xa00,0xa70,0x1fc8,0x1fd0,0xa80
.long 0xc70,0x1fe0,0x1fe0,0xb00,0xe70,0x1fe8,0x1ff0,0xb80
.long 0x0,0x0,0x0,0x0,0x8,0x9000,0x0,0x0
.long 0x0,0x12000,0x0,0x0,0x8,0x1b000,0x0,0x0
.long 0x0,0x24000,0x0,0x0,0x8,0x2d000,0x0,0x0
.long 0x0,0x36000,0x0,0x0,0x8,0x3f000,0x0,0x0
.long 0x10,0x400,0x0,0x0,0x18,0x9400,0x0,0x0
.long 0x10,0x12400,0x0,0x0,0x18,0x1b400,0x0,0x0
.long 0x10,0x24400,0x0,0x0,0x18,0x2d400,0x0,0x0
.long 0x10,0x36400,0x0,0x0,0x18,0x3f400,0x0,0x0
.long 0x20,0x800,0x0,0x0,0x28,0x9800,0x0,0x0
.long 0x20,0x12800,0x0,0x0,0x28,0x1b800,0x0,0x0
.long 0x20,0x24800,0x0,0x0,0x28,0x2d800,0x0,0x0
.long 0x20,0x36800,0x0,0x0,0x28,0x3f800,0x0,0x0
.long 0x30,0xc00,0x0,0x0,0x38,0x9c00,0x0,0x0
.long 0x30,0x12c00,0x0,0x0,0x38,0x1bc00,0x0,0x0
.long 0x30,0x24c00,0x0,0x0,0x38,0x2dc00,0x0,0x0
.long 0x30,0x36c00,0x0,0x0,0x38,0x3fc00,0x0,0x0
.long 0x40,0x0,0x0,0x0,0x48,0x9000,0x0,0x0
.long 0x40,0x12000,0x0,0x0,0x48,0x1b000,0x0,0x0
.long 0x40,0x24000,0x0,0x0,0x48,0x2d000,0x0,0x0
.long 0x40,0x36000,0x0,0x0,0x48,0x3f000,0x0,0x0
.long 0x50,0x400,0x0,0x0,0x58,0x9400,0x0,0x0
.long 0x50,0x12400,0x0,0x0,0x58,0x1b400,0x0,0x0
.long 0x50,0x24400,0x0,0x0,0x58,0x2d400,0x0,0x0
.long 0x50,0x36400,0x0,0x0,0x58,0x3f400,0x0,0x0
.long 0x60,0x800,0x0,0x0,0x68,0x9800,0x0,0x0
.long 0x60,0x12800,0x0,0x0,0x68,0x1b800,0x0,0x0
.long 0x60,0x24800,0x0,0x0,0x68,0x2d800,0x0,0x0
.long 0x60,0x36800,0x0,0x0,0x68,0x3f800,0x0,0x0
.long 0x70,0xc00,0x0,0x0,0x78,0x9c00,0x0,0x0
.long 0x70,0x12c00,0x0,0x0,0x78,0x1bc00,0x0,0x0
.long 0x70,0x24c00,0x0,0x0,0x78,0x2dc00,0x0,0x0
.long 0x70,0x36c00,0x0,0x0,0x78,0x3fc00,0x0,0x0
.size role_tbl, 15360

.section .rodata,"a"
.p2align 6
.amdhsa_kernel sequential_preLN__memory_aug_recurrent_mem_tr__glu_gated_bilinear__prompt_kernel
  .amdhsa_next_free_vgpr 512
  .amdhsa_next_free_sgpr 102
  .amdhsa_accum_offset 256
  .amdhsa_group_segment_fixed_size 0
  .amdhsa_kernarg_size 112
  .amdhsa_user_sgpr_count 2
  .amdhsa_user_sgpr_kernarg_segment_ptr 1
  .amdhsa_system_sgpr_workgroup_id_x 1
.end_amdhsa_kernel
```
